```python
import torch

def _softmax(x, axis=-1):
    return torch.softmax(x, dim=axis)
def _gelu(x):
    return torch.nn.functional.gelu(x, approximate="tanh")
def _silu(x):
    return torch.nn.functional.silu(x)
def _sigmoid(x):
    return torch.sigmoid(x)
def _layernorm(x, axis=-1, eps=1e-5):
    m = x.mean(dim=axis, keepdim=True)
    v = x.var(dim=axis, keepdim=True, unbiased=False)
    return (x - m) / torch.sqrt(v + eps)
def _scatter_add(tgt, idx, src, axis=0):
    return tgt.clone().index_add_(axis, idx, src)
def _segment_sum(src, seg, n):
    out = torch.zeros((n,) + src.shape[1:], dtype=src.dtype)
    return out.index_add_(0, seg, src)
def _pad(x, pw):
    flat = tuple(v for pair in reversed(pw) for v in pair)
    return torch.nn.functional.pad(x, flat)

kernel_name = 'standalone__gqa_block_cached__near_ridge'

def setup_inputs():

    _w = (lambda a: (lambda t: t.to(torch.bfloat16) if t.is_floating_point() else t)(torch.as_tensor(a)))
    B, Sq, D = 8, 128, 640
    Hq, Hkv, Sk, Dh = 32, 32, 512, 128
    assert Hq % Hkv == 0, (Hq, Hkv)
    return {
        "x": _w((lambda *s: torch.randn(*s, dtype=torch.bfloat16) * 0.8)(B, Sq, D)),
        "k_cache": _w((lambda *s: torch.randn(*s, dtype=torch.bfloat16) * 0.8)(B, Hkv, Sk, Dh)),
        "v_cache": _w((lambda *s: torch.randn(*s, dtype=torch.bfloat16) * 0.05)(B, Hkv, Sk, Dh)),
        "wq": _w((lambda *s: torch.randn(*s, dtype=torch.bfloat16) * 0.8)(D, Hq * Dh) * (D ** -0.5)),
        "wo": _w((lambda *s: torch.randn(*s, dtype=torch.bfloat16) * 0.05)(Hq * Dh, D) * ((Hq * Dh) ** -0.5)),
    }

def reference(x, k_cache, v_cache, wq, wo):
    B, Sq, D = x.shape
    Hq, Dh = 32, 128
    Hkv = k_cache.shape[1]
    rep = Hq // Hkv
    q = (lambda x, *d: x.permute(*d))((x @ wq).reshape(B, Sq, Hq, Dh), 0, 2, 1, 3)
    k = (lambda x, n, axis: torch.repeat_interleave(x, n, dim=axis))(k_cache, rep, axis=1)
    v = (lambda x, n, axis: torch.repeat_interleave(x, n, dim=axis))(v_cache, rep, axis=1)
    scores = torch.einsum("bhqd,bhkd->bhqk", q, k) * (Dh ** -0.5)
    p = _softmax(scores, axis=-1)
    o = torch.einsum("bhqk,bhkd->bhqd", p, v)
    return (lambda x, *d: x.permute(*d))(o, 0, 2, 1, 3).reshape(B, Sq, Hq * Dh) @ wo
```

```asm
; @launch grid=(256,1,1) block=(256,1,1) lds=163840
.amdgcn_target "amdgcn-amd-amdhsa--gfx950"
.text
.globl standalone__gqa_block_cached__near_ridge_kernel
.p2align 8
.type standalone__gqa_block_cached__near_ridge_kernel,@function
standalone__gqa_block_cached__near_ridge_kernel:
  s_cmp_ge_u32 s2, 256
  s_cbranch_scc1 L_end
  s_load_dwordx16 s[40:55], s[0:1], 0
  s_getpc_b64 s[56:57]
L_pc:
  s_lshr_b32 s58, s2, 3
  s_and_b32 s58, s58, 1
  s_lshl_b32 s58, s58, 8
  v_add_u32 v24, s58, v0
  v_lshlrev_b32 v24, 7, v24
  v_min_u32 v24, L_codeend-L_pc-4, v24
  v_mov_b32 v27, s57
  v_add_co_u32 v26, vcc, s56, v24
  s_nop 1
  v_addc_co_u32 v27, vcc, 0, v27, vcc
  global_load_dword v217, v[26:27], off
  v_lshrrev_b32 v24, 6, v0
  v_and_b32 v0, 63, v0
  v_readfirstlane_b32 s3, v24
  s_and_b32 s4, s2, 7
  s_lshr_b32 s59, s2, 3
  s_and_b32 s5, s59, 3
  s_lshr_b32 s6, s59, 2
  s_lshl_b32 s7, s4, 2
  s_add_u32 s7, s7, s5
  s_lshl_b32 s36, s6, 5
  s_add_u32 s36, s36, s7
  s_lshr_b32 s97, s6, 1
  s_add_u32 s97, s97, s4
  s_add_u32 s97, s97, s5
  s_and_b32 s97, s97, 3
  s_lshl_b32 s97, s97, 15
  s_lshl_b32 s38, s3, 12
  s_mul_i32 s39, s3, 5120
  s_mul_i32 s61, s3, 40960
  s_lshl_b32 s62, s3, 17
  s_mul_i32 s56, s5, 5
  s_lshr_b32 s56, s56, 1
  s_mul_i32 s59, s6, 5
  s_lshr_b32 s59, s59, 2
  s_add_u32 s56, s56, s59
  s_cmp_ge_u32 s56, 10
  s_cselect_b32 s59, 10, 0
  s_sub_u32 s56, s56, s59
  s_lshl_b32 s57, s56, 7
  s_add_u32 s57, s57, s61
  s_lshl_b32 s58, s56, 19
  s_add_u32 s58, s58, s62
  v_lshlrev_b32 v1, 4, v0
  v_lshrrev_b32 v24, 3, v0
  v_lshrrev_b32 v25, 4, v0
  v_and_b32 v26, 7, v0
  v_and_b32 v27, 15, v0
  v_lshrrev_b32 v28, 5, v0
  v_and_b32 v29, 31, v0
  s_movk_i32 s59, 1280
  v_add_u32 v30, 0, v25
  v_and_b32 v30, 7, v30
  v_xor_b32 v30, v26, v30
  v_lshlrev_b32 v30, 4, v30
  v_mad_u32_u24 v30, v24, s59, v30
  v_add_u32 v192, 0, v30
  v_add_u32 v30, 4, v25
  v_and_b32 v30, 7, v30
  v_xor_b32 v30, v26, v30
  v_lshlrev_b32 v30, 4, v30
  v_mad_u32_u24 v30, v24, s59, v30
  v_add_u32 v193, 9216, v30
  v_add_u32 v30, 8, v25
  v_and_b32 v30, 7, v30
  v_xor_b32 v30, v26, v30
  v_lshlrev_b32 v30, 4, v30
  v_mad_u32_u24 v30, v24, s59, v30
  v_add_u32 v194, 18432, v30
  v_add_u32 v30, 12, v25
  v_and_b32 v30, 7, v30
  v_xor_b32 v30, v26, v30
  v_lshlrev_b32 v30, 4, v30
  v_mad_u32_u24 v30, v24, s59, v30
  v_add_u32 v195, 27648, v30
  v_lshlrev_b32 v30, 2, v25
  v_xor_b32 v30, v27, v30
  v_lshlrev_b32 v30, 4, v30
  v_lshl_add_u32 v30, v25, 13, v30
  v_add_u32 v196, 0, v30
  v_add_u32 v197, 31744, v30
  v_add_u32 v198, 63488, v30
  v_add_u32 v199, 95232, v30
  s_waitcnt lgkmcnt(0)
  s_mul_i32 s59, s6, 163840
  s_add_u32 s8, s40, s59
  s_addc_u32 s9, s41, 0
  s_mov_b32 s10, 163840
  s_mov_b32 s11, 0x20000
  s_lshl_b32 s59, s7, 8
  s_add_u32 s20, s46, s59
  s_addc_u32 s21, s47, 0
  s_sub_u32 s22, 5242880, s59
  s_mov_b32 s23, 0x20000
  s_bitcmp1_b32 s6, 0
  s_cbranch_scc1 L_var1
  s_add_u32 m0, s38, 98304
  s_nop 0
  buffer_load_dwordx4 v192, s[8:11], s57 offen offset:0 lds
  buffer_load_dwordx4 v193, s[8:11], s57 offen offset:1024 lds
  buffer_load_dwordx4 v194, s[8:11], s57 offen offset:2048 lds
  buffer_load_dwordx4 v195, s[8:11], s57 offen offset:3072 lds
  s_add_u32 m0, s38, 114688
  s_nop 0
  buffer_load_dwordx4 v196, s[20:23], s58 offen offset:0 lds
  buffer_load_dwordx4 v197, s[20:23], s58 offen offset:1024 lds
  buffer_load_dwordx4 v198, s[20:23], s58 offen offset:2048 lds
  buffer_load_dwordx4 v199, s[20:23], s58 offen offset:3072 lds
  s_add_u32 s56, s56, 1
  s_cmp_eq_u32 s56, 10
  s_cselect_b32 s56, 0, s56
  s_lshl_b32 s57, s56, 7
  s_add_u32 s57, s57, s61
  s_lshl_b32 s58, s56, 19
  s_add_u32 s58, s58, s62
  s_lshl_b32 s59, s36, 17
  s_add_u32 s12, s42, s59
  s_addc_u32 s13, s43, 0
  s_mov_b32 s14, 131072
  s_mov_b32 s15, 0x20000
  s_add_u32 s16, s44, s59
  s_addc_u32 s17, s45, 0
  s_mov_b32 s18, 131072
  s_mov_b32 s19, 0x20000
  s_mul_i32 s59, s4, 655360
  s_mul_i32 s60, s5, 320
  s_add_u32 s59, s59, s60
  s_add_u32 s24, s48, s59
  s_addc_u32 s25, s49, 0
  s_sub_u32 s26, 5242880, s59
  s_mov_b32 s27, 0x20000
  s_mov_b32 s28, s50
  s_mov_b32 s29, s51
  s_mov_b32 s30, 1310720
  s_mov_b32 s31, 0x20000
  s_mov_b32 s32, s54
  s_mov_b32 s33, s55
  s_mov_b32 s34, 0x10000000
  s_mov_b32 s35, 0x20000
  s_lshl_b32 s59, s6, 7
  s_load_dword s37, s[54:55], s59
  s_mov_b64 exec, 0xffff
  s_mov_b32 s59, 40960
  v_mul_u32_u24 v30, s59, v0
  buffer_load_dword v217, v30, s[24:27], 0 offen
  v_lshlrev_b32 v30, 13, v0
  s_mov_b64 exec, 0xffffffff
  s_mul_i32 s59, s5, 5
  s_lshr_b32 s59, s59, 1
  s_lshr_b32 s60, s6, 2
  s_mul_i32 s60, s60, 5
  s_add_u32 s59, s59, s60
  s_add_u32 s59, s59, 4
  s_cmp_ge_u32 s59, 10
  s_cselect_b32 s60, 10, 0
  s_sub_u32 s59, s59, s60
  s_lshl_b32 s59, s59, 6
  s_and_b32 s60, s6, 3
  s_lshl_b32 s60, s60, 4
  s_add_u32 s59, s59, s60
  s_lshl_b32 s59, s59, 13
  s_cmp_eq_u32 s3, 1
  s_cselect_b32 s59, s59, s22
  v_lshrrev_b32 v30, 1, v0
  v_lshlrev_b32 v30, 13, v30
  v_and_b32 v31, 1, v0
  v_lshl_add_u32 v30, v31, 7, v30
  buffer_load_dword v217, v30, s[20:23], s59 offen
  s_mov_b64 exec, -1
  v_add_u32 v30, 0, v25
  v_xor_b32 v30, v27, v30
  v_lshlrev_b32 v30, 4, v30
  v_lshl_add_u32 v2, v25, 8, v30
  v_add_u32 v30, 4, v25
  v_xor_b32 v30, v27, v30
  v_lshlrev_b32 v30, 4, v30
  v_lshl_add_u32 v3, v25, 8, v30
  v_add_u32 v30, 8, v25
  v_xor_b32 v30, v27, v30
  v_lshlrev_b32 v30, 4, v30
  v_lshl_add_u32 v4, v25, 8, v30
  v_add_u32 v30, 12, v25
  v_xor_b32 v30, v27, v30
  v_lshlrev_b32 v30, 4, v30
  v_lshl_add_u32 v5, v25, 8, v30
  v_and_b32 v30, 1, v25
  v_lshlrev_b32 v30, 2, v30
  v_xor_b32 v30, v26, v30
  v_lshlrev_b32 v30, 4, v30
  v_lshl_add_u32 v30, v24, 8, v30
  v_add_u32 v6, 0, v30
  v_add_u32 v7, 1024, v30
  v_add_u32 v8, 2048, v30
  v_add_u32 v9, 3072, v30
  s_movk_i32 s59, 3277
  s_movk_i32 s60, 1280
  v_add_u32 v30, 0, v0
  v_mul_u32_u24 v31, s59, v30
  v_lshrrev_b32 v31, 16, v31
  v_mul_u32_u24 v23, 20, v31
  v_sub_u32 v30, v30, v23
  v_lshlrev_b32 v30, 4, v30
  v_mad_u32_u24 v30, v31, s60, v30
  v_subrev_u32 v10, 0, v30
  v_add_u32 v30, 64, v0
  v_mul_u32_u24 v31, s59, v30
  v_lshrrev_b32 v31, 16, v31
  v_mul_u32_u24 v23, 20, v31
  v_sub_u32 v30, v30, v23
  v_lshlrev_b32 v30, 4, v30
  v_mad_u32_u24 v30, v31, s60, v30
  v_subrev_u32 v11, 1024, v30
  v_add_u32 v30, 128, v0
  v_mul_u32_u24 v31, s59, v30
  v_lshrrev_b32 v31, 16, v31
  v_mul_u32_u24 v23, 20, v31
  v_sub_u32 v30, v30, v23
  v_lshlrev_b32 v30, 4, v30
  v_mad_u32_u24 v30, v31, s60, v30
  v_subrev_u32 v12, 2048, v30
  v_add_u32 v30, 192, v0
  v_mul_u32_u24 v31, s59, v30
  v_lshrrev_b32 v31, 16, v31
  v_mul_u32_u24 v23, 20, v31
  v_sub_u32 v30, v30, v23
  v_lshlrev_b32 v30, 4, v30
  v_mad_u32_u24 v30, v31, s60, v30
  v_subrev_u32 v13, 3072, v30
  v_add_u32 v30, 256, v0
  v_mul_u32_u24 v31, s59, v30
  v_lshrrev_b32 v31, 16, v31
  v_mul_u32_u24 v23, 20, v31
  v_sub_u32 v30, v30, v23
  v_lshlrev_b32 v30, 4, v30
  v_mad_u32_u24 v30, v31, s60, v30
  v_subrev_u32 v14, 0, v30
  v_lshrrev_b32 v30, 1, v29
  v_and_b32 v30, 7, v30
  v_xor_b32 v30, v28, v30
  v_lshlrev_b32 v30, 4, v30
  v_lshl_add_u32 v30, v29, 7, v30
  v_add_u32 v30, s38, v30
  v_xor_b32 v208, 0, v30
  v_add_u32 v200, 98304, v208
  v_xor_b32 v209, 32, v30
  v_add_u32 v201, 98304, v209
  v_xor_b32 v210, 64, v30
  v_add_u32 v202, 98304, v210
  v_xor_b32 v211, 96, v30
  v_add_u32 v203, 98304, v211
  v_lshrrev_b32 v22, 2, v27
  v_and_b32 v23, 1, v25
  v_lshlrev_b32 v23, 5, v23
  v_and_b32 v30, 1, v27
  v_lshl_add_u32 v23, v30, 4, v23
  v_bfe_u32 v30, v27, 1, 1
  v_lshl_add_u32 v23, v30, 3, v23
  v_lshl_add_u32 v30, v28, 3, v22
  v_lshlrev_b32 v30, 8, v30
  v_add_u32 v30, v30, v23
  v_lshl_add_u32 v30, v22, 6, v30
  v_add_u32 v30, 16384, v30
  v_xor_b32 v212, 0, v30
  v_add_u32 v204, 98304, v212
  v_xor_b32 v213, 64, v30
  v_add_u32 v205, 98304, v213
  v_xor_b32 v214, 128, v30
  v_add_u32 v206, 98304, v214
  v_xor_b32 v215, 192, v30
  v_add_u32 v207, 98304, v215
  v_xor_b32 v30, v28, v27
  v_lshlrev_b32 v30, 4, v30
  v_lshl_add_u32 v30, v29, 8, v30
  v_add_u32 v30, 32768, v30
  v_xor_b32 v16, 0, v30
  v_xor_b32 v17, 32, v30
  v_xor_b32 v18, 64, v30
  v_xor_b32 v19, 96, v30
  v_xor_b32 v20, 128, v30
  v_xor_b32 v21, 160, v30
  v_xor_b32 v22, 192, v30
  v_xor_b32 v23, 224, v30
  v_and_b32 v27, 15, v0
  v_lshrrev_b32 v28, 5, v0
  v_lshrrev_b32 v24, 2, v27
  v_bfe_u32 v25, v0, 4, 1
  v_lshl_add_u32 v30, v28, 2, v24
  v_lshlrev_b32 v31, 5, v25
  v_and_b32 v29, 3, v27
  v_lshl_add_u32 v29, v29, 3, v31
  v_lshl_add_u32 v29, v30, 7, v29
  v_bfe_u32 v26, v27, 3, 1
  v_lshl_add_u32 v29, v26, 6, v29
  v_accvgpr_write_b32 a242, v29
  v_xor_b32 v26, 64, v29
  v_accvgpr_write_b32 a243, v26
  v_add_u32 v29, 65536, v29
  v_accvgpr_write_b32 a240, v29
  v_add_u32 v26, 65536, v26
  v_accvgpr_write_b32 a241, v26
  v_and_b32 v29, 1, v27
  v_lshl_add_u32 v31, v29, 4, v31
  v_bfe_u32 v29, v27, 1, 1
  v_lshl_add_u32 v31, v29, 3, v31
  s_movk_i32 s63, 320
  v_mad_u32_u24 v29, v30, s63, v31
  v_accvgpr_write_b32 a244, v29
  v_add_u32 v29, 65536, v29
  v_accvgpr_write_b32 a245, v29
  v_add_u32 v29, 65536, v29
  v_accvgpr_write_b32 a246, v29
  v_bfe_u32 v29, v0, 2, 1
  v_cmp_eq_u32 vcc, v29, v25
  v_mov_b32 v29, 0x3f803f80
  s_nop 0
  v_cndmask_b32 v29, 0, v29, vcc
  v_accvgpr_write_b32 a248, v29
  v_accvgpr_write_b32 a249, v29
  v_accvgpr_write_b32 a250, v29
  v_accvgpr_write_b32 a251, v29
  s_mov_b32 s50, 0xfffefffe
  s_mov_b32 s51, 0x00010001
  s_add_u32 s44, s5, 1
  s_and_b32 s44, s44, 3
  s_and_b32 s68, s36, 0xfc
  s_add_u32 s44, s44, s68
  s_lshl_b32 s44, s44, 2
  s_add_u32 s44, s44, s3
  s_mul_i32 s44, s44, 8448
  s_add_u32 s44, s44, 1048576
  s_add_u32 s47, s44, 4096
  s_add_u32 s45, s5, 2
  s_and_b32 s45, s45, 3
  s_and_b32 s68, s36, 0xfc
  s_add_u32 s45, s45, s68
  s_lshl_b32 s45, s45, 2
  s_add_u32 s45, s45, s3
  s_mul_i32 s45, s45, 8448
  s_add_u32 s45, s45, 1048576
  s_add_u32 s48, s45, 4096
  s_add_u32 s46, s5, 3
  s_and_b32 s46, s46, 3
  s_and_b32 s68, s36, 0xfc
  s_add_u32 s46, s46, s68
  s_lshl_b32 s46, s46, 2
  s_add_u32 s46, s46, s3
  s_mul_i32 s46, s46, 8448
  s_add_u32 s46, s46, 1048576
  s_add_u32 s49, s46, 4096
  v_and_b32 v29, 3, v0
  v_lshlrev_b32 v29, 4, v29
  v_add_u32 v29, 0, v29
  v_lshrrev_b32 v30, 2, v0
  v_mov_b32 v26, s46
  v_mov_b32 v31, s45
  v_cmp_eq_u32 vcc, 1, v30
  s_nop 1
  v_cndmask_b32 v26, v26, v31, vcc
  v_mov_b32 v31, s44
  v_cmp_eq_u32 vcc, 0, v30
  s_nop 1
  v_cndmask_b32 v26, v26, v31, vcc
  v_add_u32 v26, v26, v29
  v_accvgpr_write_b32 a247, v26
  s_movk_i32 s95, 4096
  s_mov_b32 s96, 0x7fff0000
  s_lshl_b32 s69, s36, 2
  s_add_u32 s69, s69, s3
  s_mul_i32 s69, s69, 8448
  s_add_u32 s69, s69, 1048576
  s_lshl_b32 s63, s6, 2
  s_add_u32 s63, s63, s5
  s_lshl_b32 s63, s63, 3
  s_lshl_b32 s40, s3, 1
  s_add_u32 s40, s40, s63
  s_mul_i32 s40, s40, 41216
  s_mul_i32 s41, s4, 5120
  s_add_u32 s40, s40, s41
  s_add_u32 s40, s40, 16777216
  s_add_u32 s41, s40, 41216
  s_add_u32 s42, s40, 4096
  s_add_u32 s43, s41, 4096
  s_add_u32 s52, s63, s4
  s_mul_i32 s52, s52, 41216
  s_add_u32 s52, s52, 16777216
  s_waitcnt lgkmcnt(0)
  s_add_u32 s37, s37, 1
  v_and_b32 v24, 31, v0
  v_lshrrev_b32 v25, 5, v0
  v_bfe_u32 v26, v0, 2, 1
  v_xor_b32 v26, v26, v25
  v_bfe_u32 v27, v0, 4, 1
  v_or_b32 v26, v26, v27
  v_bfe_u32 v27, v0, 3, 1
  v_bfe_u32 v28, v0, 1, 1
  v_lshl_add_u32 v27, v27, 1, v28
  v_lshl_add_u32 v27, v26, 2, v27
  v_and_b32 v28, 1, v0
  v_lshlrev_b32 v28, 4, v28
  v_mov_b32 v29, 0x3f80
  v_lshlrev_b32 v28, v28, v29
  v_cmp_eq_u32 vcc, 0, v27
  s_nop 1
  v_cndmask_b32 v29, 0, v28, vcc
  v_accvgpr_write_b32 a232, v29
  v_cmp_eq_u32 vcc, 1, v27
  s_nop 1
  v_cndmask_b32 v29, 0, v28, vcc
  v_accvgpr_write_b32 a233, v29
  v_cmp_eq_u32 vcc, 2, v27
  s_nop 1
  v_cndmask_b32 v29, 0, v28, vcc
  v_accvgpr_write_b32 a234, v29
  v_cmp_eq_u32 vcc, 3, v27
  s_nop 1
  v_cndmask_b32 v29, 0, v28, vcc
  v_accvgpr_write_b32 a235, v29
  s_lshr_b32 s63, s4, 1
  s_lshl_b32 s63, s63, 5
  s_lshl_b32 s68, s6, 7
  s_add_u32 s63, s63, s68
  v_add_u32 v24, s63, v24
  s_movk_i32 s68, 1280
  v_mul_lo_u32 v24, v24, s68
  v_lshl_add_u32 v24, v25, 4, v24
  s_mul_i32 s63, s5, 320
  s_and_b32 s68, s4, 1
  s_lshl_b32 s68, s68, 5
  s_add_u32 s63, s63, s68
  v_add_u32 v24, s63, v24
  v_accvgpr_write_b32 a236, v24
  v_lshrrev_b32 v26, 2, v0
  s_movk_i32 s68, 5120
  v_mul_u32_u24 v26, s68, v26
  v_and_b32 v27, 3, v0
  v_lshl_add_u32 v26, v27, 4, v26
  v_accvgpr_write_b32 a237, v26
  s_lshl_b32 s54, s3, 10
  s_add_u32 s54, s54, s52
  s_add_u32 s52, s52, 4096
  s_lshl_b32 s55, s3, 6
  s_and_b32 s63, s37, 63
  s_lshl_b32 s63, s63, 2
  s_or_b32 s63, s63, 1
  s_mul_i32 s63, s63, 0x101
  s_bfe_u32 s68, s37, 0x60006
  s_lshl_b32 s68, s68, 2
  s_or_b32 s68, s68, 2
  s_mul_i32 s68, s68, 0x1010000
  s_or_b32 s63, s63, s68
  v_and_b32 v29, 3, v0
  v_lshlrev_b32 v29, 2, v29
  v_lshrrev_b32 v29, v29, s63
  v_lshrrev_b32 v30, 0, v29
  v_and_b32 v30, s51, v30
  v_accvgpr_write_b32 a252, v30
  v_lshrrev_b32 v30, 1, v29
  v_and_b32 v30, s51, v30
  v_accvgpr_write_b32 a253, v30
  v_lshrrev_b32 v30, 2, v29
  v_and_b32 v30, s51, v30
  v_accvgpr_write_b32 a254, v30
  v_lshrrev_b32 v30, 3, v29
  v_and_b32 v30, s51, v30
  v_accvgpr_write_b32 a255, v30
  s_add_u32 m0, s38, 0
  s_nop 0
  buffer_load_dwordx4 v192, s[8:11], s57 offen offset:0 lds
  buffer_load_dwordx4 v193, s[8:11], s57 offen offset:1024 lds
  buffer_load_dwordx4 v194, s[8:11], s57 offen offset:2048 lds
  buffer_load_dwordx4 v195, s[8:11], s57 offen offset:3072 lds
  s_add_u32 m0, s38, 16384
  s_nop 0
  buffer_load_dwordx4 v196, s[20:23], s58 offen offset:0 lds
  buffer_load_dwordx4 v197, s[20:23], s58 offen offset:1024 lds
  buffer_load_dwordx4 v198, s[20:23], s58 offen offset:2048 lds
  buffer_load_dwordx4 v199, s[20:23], s58 offen offset:3072 lds
  s_add_u32 s56, s56, 1
  s_cmp_eq_u32 s56, 10
  s_cselect_b32 s56, 0, s56
  s_lshl_b32 s57, s56, 7
  s_add_u32 s57, s57, s61
  s_lshl_b32 s58, s56, 19
  s_add_u32 s58, s58, s62
  s_cmp_eq_u32 s3, 0
  s_cbranch_scc0 L_noorphv0_
  s_mul_i32 s59, s6, 5
  s_lshr_b32 s59, s59, 2
  s_lshr_b32 s60, s5, 1
  s_mul_i32 s60, s60, 5
  s_add_u32 s59, s59, s60
  s_add_u32 s59, s59, 4
  s_cmp_ge_u32 s59, 10
  s_cselect_b32 s60, 10, 0
  s_sub_u32 s59, s59, s60
  s_lshl_b32 s59, s59, 7
  s_and_b32 s60, s5, 1
  s_mul_i32 s60, s60, 81920
  s_add_u32 s59, s59, s60
  s_movk_i32 s60, 1280
  v_mul_u32_u24 v30, s60, v0
  buffer_load_dword v217, v30, s[8:11], s59 offen
  s_branch L_orphdv0_
L_noorphv0_:
  v_mov_b32 v30, 0
  buffer_load_dword v217, v30, s[8:11], s10 offen
L_orphdv0_:
  s_waitcnt vmcnt(11) lgkmcnt(0)
  s_barrier
  ds_read_b128 a[128:131], v200 offset:0
  ds_read_b64_tr_b16 a[0:1], v204 offset:0
  ds_read_b64_tr_b16 a[2:3], v204 offset:1024
  ds_read_b64_tr_b16 a[4:5], v205 offset:0
  ds_read_b64_tr_b16 a[6:7], v205 offset:1024
  ds_read_b64_tr_b16 a[8:9], v206 offset:0
  ds_read_b64_tr_b16 a[10:11], v206 offset:1024
  ds_read_b64_tr_b16 a[12:13], v207 offset:0
  ds_read_b64_tr_b16 a[14:15], v207 offset:1024
  ds_read_b128 a[132:135], v201 offset:0
  ds_read_b64_tr_b16 a[16:17], v204 offset:4096
  ds_read_b64_tr_b16 a[18:19], v204 offset:5120
  s_waitcnt lgkmcnt(7)
  v_mfma_f32_32x32x16_bf16 v[128:143], a[0:3], a[128:131], 0
  ds_read_b64_tr_b16 a[20:21], v205 offset:4096
  ds_read_b64_tr_b16 a[22:23], v205 offset:5120
  ds_read_b64_tr_b16 a[24:25], v206 offset:4096
  v_mfma_f32_32x32x16_bf16 v[144:159], a[4:7], a[128:131], 0
  ds_read_b64_tr_b16 a[26:27], v206 offset:5120
  ds_read_b64_tr_b16 a[28:29], v207 offset:4096
  ds_read_b64_tr_b16 a[30:31], v207 offset:5120
  s_add_u32 m0, s38, 131072
  s_nop 0
  buffer_load_dwordx4 v192, s[8:11], s57 offen offset:0 lds
  s_waitcnt lgkmcnt(9)
  v_mfma_f32_32x32x16_bf16 v[160:175], a[8:11], a[128:131], 0
  ds_read_b128 a[136:139], v202 offset:0
  ds_read_b64_tr_b16 a[32:33], v204 offset:8192
  ds_read_b64_tr_b16 a[34:35], v204 offset:9216
  buffer_load_dwordx4 v193, s[8:11], s57 offen offset:1024 lds
  v_mfma_f32_32x32x16_bf16 v[176:191], a[12:15], a[128:131], 0
  ds_read_b64_tr_b16 a[36:37], v205 offset:8192
  ds_read_b64_tr_b16 a[38:39], v205 offset:9216
  ds_read_b64_tr_b16 a[40:41], v206 offset:8192
  buffer_load_dwordx4 v194, s[8:11], s57 offen offset:2048 lds
  s_waitcnt lgkmcnt(10)
  v_mfma_f32_32x32x16_bf16 v[128:143], a[16:19], a[132:135], v[128:143]
  ds_read_b64_tr_b16 a[42:43], v206 offset:9216
  ds_read_b64_tr_b16 a[44:45], v207 offset:8192
  ds_read_b64_tr_b16 a[46:47], v207 offset:9216
  buffer_load_dwordx4 v195, s[8:11], s57 offen offset:3072 lds
  v_mfma_f32_32x32x16_bf16 v[144:159], a[20:23], a[132:135], v[144:159]
  ds_read_b128 a[140:143], v203 offset:0
  ds_read_b64_tr_b16 a[48:49], v204 offset:12288
  ds_read_b64_tr_b16 a[50:51], v204 offset:13312
  s_waitcnt lgkmcnt(12)
  v_mfma_f32_32x32x16_bf16 v[160:175], a[24:27], a[132:135], v[160:175]
  ds_read_b64_tr_b16 a[52:53], v205 offset:12288
  ds_read_b64_tr_b16 a[54:55], v205 offset:13312
  ds_read_b64_tr_b16 a[56:57], v206 offset:12288
  s_add_u32 m0, s38, 147456
  s_nop 0
  buffer_load_dwordx4 v196, s[20:23], s58 offen offset:0 lds
  v_mfma_f32_32x32x16_bf16 v[176:191], a[28:31], a[132:135], v[176:191]
  ds_read_b64_tr_b16 a[58:59], v206 offset:13312
  ds_read_b64_tr_b16 a[60:61], v207 offset:12288
  ds_read_b64_tr_b16 a[62:63], v207 offset:13312
  s_waitcnt lgkmcnt(13)
  v_mfma_f32_32x32x16_bf16 v[128:143], a[32:35], a[136:139], v[128:143]
  buffer_load_dwordx4 v197, s[20:23], s58 offen offset:1024 lds
  v_mfma_f32_32x32x16_bf16 v[144:159], a[36:39], a[136:139], v[144:159]
  buffer_load_dwordx4 v198, s[20:23], s58 offen offset:2048 lds
  s_waitcnt lgkmcnt(9)
  v_mfma_f32_32x32x16_bf16 v[160:175], a[40:43], a[136:139], v[160:175]
  buffer_load_dwordx4 v199, s[20:23], s58 offen offset:3072 lds
  v_mfma_f32_32x32x16_bf16 v[176:191], a[44:47], a[136:139], v[176:191]
  s_add_u32 s56, s56, 1
  s_cmp_eq_u32 s56, 10
  s_cselect_b32 s56, 0, s56
  s_lshl_b32 s57, s56, 7
  s_add_u32 s57, s57, s61
  s_lshl_b32 s58, s56, 19
  s_add_u32 s58, s58, s62
  s_add_u32 m0, s38, 65536
  s_add_u32 s59, s97, 0
  s_and_b32 s59, s59, 0x1ffff
  s_add_u32 s59, s59, s38
  buffer_load_dwordx4 v2, s[12:15], s59 offen offset:0 nt lds
  buffer_load_dwordx4 v3, s[12:15], s59 offen offset:1024 nt lds
  buffer_load_dwordx4 v4, s[12:15], s59 offen offset:2048 nt lds
  buffer_load_dwordx4 v5, s[12:15], s59 offen offset:3072 nt lds
  s_add_u32 m0, s38, 81920
  s_add_u32 s59, s97, 16384
  s_and_b32 s59, s59, 0x1ffff
  s_add_u32 s59, s59, s38
  buffer_load_dwordx4 v2, s[12:15], s59 offen offset:0 nt lds
  buffer_load_dwordx4 v3, s[12:15], s59 offen offset:1024 nt lds
  buffer_load_dwordx4 v4, s[12:15], s59 offen offset:2048 nt lds
  buffer_load_dwordx4 v5, s[12:15], s59 offen offset:3072 nt lds
  s_add_u32 m0, s38, 32768
  s_add_u32 s59, s97, 32768
  s_and_b32 s59, s59, 0x1ffff
  s_add_u32 s59, s59, s38
  buffer_load_dwordx4 v2, s[12:15], s59 offen offset:0 nt lds
  buffer_load_dwordx4 v3, s[12:15], s59 offen offset:1024 nt lds
  buffer_load_dwordx4 v4, s[12:15], s59 offen offset:2048 nt lds
  buffer_load_dwordx4 v5, s[12:15], s59 offen offset:3072 nt lds
  s_add_u32 m0, s38, 49152
  s_add_u32 s59, s97, 49152
  s_and_b32 s59, s59, 0x1ffff
  s_add_u32 s59, s59, s38
  buffer_load_dwordx4 v2, s[12:15], s59 offen offset:0 nt lds
  buffer_load_dwordx4 v3, s[12:15], s59 offen offset:1024 nt lds
  buffer_load_dwordx4 v4, s[12:15], s59 offen offset:2048 nt lds
  buffer_load_dwordx4 v5, s[12:15], s59 offen offset:3072 nt lds
  s_add_u32 s59, s97, 65536
  s_and_b32 s59, s59, 0x1ffff
  s_add_u32 s59, s59, s38
  buffer_load_dwordx4 a[160:163], v2, s[12:15], s59 offen offset:0 nt
  buffer_load_dwordx4 a[164:167], v3, s[12:15], s59 offen offset:1024 nt
  buffer_load_dwordx4 a[168:171], v4, s[12:15], s59 offen offset:2048 nt
  buffer_load_dwordx4 a[172:175], v5, s[12:15], s59 offen offset:3072 nt
  s_add_u32 s59, s97, 81920
  s_and_b32 s59, s59, 0x1ffff
  s_add_u32 s59, s59, s38
  buffer_load_dwordx4 a[176:179], v2, s[12:15], s59 offen offset:0 nt
  buffer_load_dwordx4 a[180:183], v3, s[12:15], s59 offen offset:1024 nt
  buffer_load_dwordx4 a[184:187], v4, s[12:15], s59 offen offset:2048 nt
  buffer_load_dwordx4 a[188:191], v5, s[12:15], s59 offen offset:3072 nt
  s_add_u32 s59, s97, 98304
  s_and_b32 s59, s59, 0x1ffff
  s_add_u32 s59, s59, s38
  buffer_load_dwordx4 a[192:195], v2, s[12:15], s59 offen offset:0 nt
  buffer_load_dwordx4 a[196:199], v3, s[12:15], s59 offen offset:1024 nt
  buffer_load_dwordx4 a[200:203], v4, s[12:15], s59 offen offset:2048 nt
  buffer_load_dwordx4 a[204:207], v5, s[12:15], s59 offen offset:3072 nt
  s_waitcnt vmcnt(37) lgkmcnt(0)
  s_barrier
  v_mfma_f32_32x32x16_bf16 v[128:143], a[48:51], a[140:143], v[128:143]
  ds_read_b128 a[144:147], v208 offset:0
  ds_read_b64_tr_b16 a[64:65], v212 offset:0
  ds_read_b64_tr_b16 a[66:67], v212 offset:1024
  v_mfma_f32_32x32x16_bf16 v[144:159], a[52:55], a[140:143], v[144:159]
  ds_read_b64_tr_b16 a[68:69], v213 offset:0
  ds_read_b64_tr_b16 a[70:71], v213 offset:1024
  ds_read_b64_tr_b16 a[72:73], v214 offset:0
  s_add_u32 m0, s38, 98304
  s_nop 0
  buffer_load_dwordx4 v192, s[8:11], s57 offen offset:0 lds
  v_mfma_f32_32x32x16_bf16 v[160:175], a[56:59], a[140:143], v[160:175]
  ds_read_b64_tr_b16 a[74:75], v214 offset:1024
  ds_read_b64_tr_b16 a[76:77], v215 offset:0
  ds_read_b64_tr_b16 a[78:79], v215 offset:1024
  v_mfma_f32_32x32x16_bf16 v[176:191], a[60:63], a[140:143], v[176:191]
  ds_read_b128 a[148:151], v209 offset:0
  ds_read_b64_tr_b16 a[80:81], v212 offset:4096
  ds_read_b64_tr_b16 a[82:83], v212 offset:5120
  buffer_load_dwordx4 v193, s[8:11], s57 offen offset:1024 lds
  s_waitcnt lgkmcnt(7)
  v_mfma_f32_32x32x16_bf16 v[128:143], a[64:67], a[144:147], v[128:143]
  ds_read_b64_tr_b16 a[84:85], v213 offset:4096
  ds_read_b64_tr_b16 a[86:87], v213 offset:5120
  ds_read_b64_tr_b16 a[88:89], v214 offset:4096
  v_mfma_f32_32x32x16_bf16 v[144:159], a[68:71], a[144:147], v[144:159]
  ds_read_b64_tr_b16 a[90:91], v214 offset:5120
  ds_read_b64_tr_b16 a[92:93], v215 offset:4096
  ds_read_b64_tr_b16 a[94:95], v215 offset:5120
  buffer_load_dwordx4 v194, s[8:11], s57 offen offset:2048 lds
  s_waitcnt lgkmcnt(9)
  v_mfma_f32_32x32x16_bf16 v[160:175], a[72:75], a[144:147], v[160:175]
  ds_read_b128 a[152:155], v210 offset:0
  ds_read_b64_tr_b16 a[96:97], v212 offset:8192
  ds_read_b64_tr_b16 a[98:99], v212 offset:9216
  v_mfma_f32_32x32x16_bf16 v[176:191], a[76:79], a[144:147], v[176:191]
  ds_read_b64_tr_b16 a[100:101], v213 offset:8192
  ds_read_b64_tr_b16 a[102:103], v213 offset:9216
  ds_read_b64_tr_b16 a[104:105], v214 offset:8192
  buffer_load_dwordx4 v195, s[8:11], s57 offen offset:3072 lds
  s_waitcnt lgkmcnt(10)
  v_mfma_f32_32x32x16_bf16 v[128:143], a[80:83], a[148:151], v[128:143]
  ds_read_b64_tr_b16 a[106:107], v214 offset:9216
  ds_read_b64_tr_b16 a[108:109], v215 offset:8192
  ds_read_b64_tr_b16 a[110:111], v215 offset:9216
  v_mfma_f32_32x32x16_bf16 v[144:159], a[84:87], a[148:151], v[144:159]
  ds_read_b128 a[156:159], v211 offset:0
  ds_read_b64_tr_b16 a[112:113], v212 offset:12288
  ds_read_b64_tr_b16 a[114:115], v212 offset:13312
  s_add_u32 m0, s38, 114688
  s_nop 0
  buffer_load_dwordx4 v196, s[20:23], s58 offen offset:0 lds
  s_waitcnt lgkmcnt(12)
  v_mfma_f32_32x32x16_bf16 v[160:175], a[88:91], a[148:151], v[160:175]
  ds_read_b64_tr_b16 a[116:117], v213 offset:12288
  ds_read_b64_tr_b16 a[118:119], v213 offset:13312
  ds_read_b64_tr_b16 a[120:121], v214 offset:12288
  v_mfma_f32_32x32x16_bf16 v[176:191], a[92:95], a[148:151], v[176:191]
  ds_read_b64_tr_b16 a[122:123], v214 offset:13312
  ds_read_b64_tr_b16 a[124:125], v215 offset:12288
  ds_read_b64_tr_b16 a[126:127], v215 offset:13312
  buffer_load_dwordx4 v197, s[20:23], s58 offen offset:1024 lds
  s_waitcnt lgkmcnt(13)
  v_mfma_f32_32x32x16_bf16 v[128:143], a[96:99], a[152:155], v[128:143]
  v_mfma_f32_32x32x16_bf16 v[144:159], a[100:103], a[152:155], v[144:159]
  buffer_load_dwordx4 v198, s[20:23], s58 offen offset:2048 lds
  s_waitcnt lgkmcnt(9)
  v_mfma_f32_32x32x16_bf16 v[160:175], a[104:107], a[152:155], v[160:175]
  buffer_load_dwordx4 v199, s[20:23], s58 offen offset:3072 lds
  v_mfma_f32_32x32x16_bf16 v[176:191], a[108:111], a[152:155], v[176:191]
  s_add_u32 s56, s56, 1
  s_cmp_eq_u32 s56, 10
  s_cselect_b32 s56, 0, s56
  s_lshl_b32 s57, s56, 7
  s_add_u32 s57, s57, s61
  s_lshl_b32 s58, s56, 19
  s_add_u32 s58, s58, s62
  s_waitcnt vmcnt(36) lgkmcnt(0)
  s_barrier
  v_mfma_f32_32x32x16_bf16 v[128:143], a[112:115], a[156:159], v[128:143]
  ds_read_b128 a[128:131], v200 offset:32768
  ds_read_b64_tr_b16 a[0:1], v204 offset:32768
  ds_read_b64_tr_b16 a[2:3], v204 offset:33792
  v_mfma_f32_32x32x16_bf16 v[144:159], a[116:119], a[156:159], v[144:159]
  ds_read_b64_tr_b16 a[4:5], v205 offset:32768
  ds_read_b64_tr_b16 a[6:7], v205 offset:33792
  ds_read_b64_tr_b16 a[8:9], v206 offset:32768
  s_add_u32 m0, s38, 0
  s_nop 0
  buffer_load_dwordx4 v192, s[8:11], s57 offen offset:0 lds
  v_mfma_f32_32x32x16_bf16 v[160:175], a[120:123], a[156:159], v[160:175]
  ds_read_b64_tr_b16 a[10:11], v206 offset:33792
  ds_read_b64_tr_b16 a[12:13], v207 offset:32768
  ds_read_b64_tr_b16 a[14:15], v207 offset:33792
  v_mfma_f32_32x32x16_bf16 v[176:191], a[124:127], a[156:159], v[176:191]
  ds_read_b128 a[132:135], v201 offset:32768
  ds_read_b64_tr_b16 a[16:17], v204 offset:36864
  ds_read_b64_tr_b16 a[18:19], v204 offset:37888
  buffer_load_dwordx4 v193, s[8:11], s57 offen offset:1024 lds
  s_waitcnt lgkmcnt(7)
  v_mfma_f32_32x32x16_bf16 v[128:143], a[0:3], a[128:131], v[128:143]
  ds_read_b64_tr_b16 a[20:21], v205 offset:36864
  ds_read_b64_tr_b16 a[22:23], v205 offset:37888
  ds_read_b64_tr_b16 a[24:25], v206 offset:36864
  v_mfma_f32_32x32x16_bf16 v[144:159], a[4:7], a[128:131], v[144:159]
  ds_read_b64_tr_b16 a[26:27], v206 offset:37888
  ds_read_b64_tr_b16 a[28:29], v207 offset:36864
  ds_read_b64_tr_b16 a[30:31], v207 offset:37888
  buffer_load_dwordx4 v194, s[8:11], s57 offen offset:2048 lds
  s_waitcnt lgkmcnt(9)
  v_mfma_f32_32x32x16_bf16 v[160:175], a[8:11], a[128:131], v[160:175]
  ds_read_b128 a[136:139], v202 offset:32768
  ds_read_b64_tr_b16 a[32:33], v204 offset:40960
  ds_read_b64_tr_b16 a[34:35], v204 offset:41984
  v_mfma_f32_32x32x16_bf16 v[176:191], a[12:15], a[128:131], v[176:191]
  ds_read_b64_tr_b16 a[36:37], v205 offset:40960
  ds_read_b64_tr_b16 a[38:39], v205 offset:41984
  ds_read_b64_tr_b16 a[40:41], v206 offset:40960
  buffer_load_dwordx4 v195, s[8:11], s57 offen offset:3072 lds
  s_waitcnt lgkmcnt(10)
  v_mfma_f32_32x32x16_bf16 v[128:143], a[16:19], a[132:135], v[128:143]
  ds_read_b64_tr_b16 a[42:43], v206 offset:41984
  ds_read_b64_tr_b16 a[44:45], v207 offset:40960
  ds_read_b64_tr_b16 a[46:47], v207 offset:41984
  v_mfma_f32_32x32x16_bf16 v[144:159], a[20:23], a[132:135], v[144:159]
  ds_read_b128 a[140:143], v203 offset:32768
  ds_read_b64_tr_b16 a[48:49], v204 offset:45056
  ds_read_b64_tr_b16 a[50:51], v204 offset:46080
  s_add_u32 m0, s38, 16384
  s_nop 0
  buffer_load_dwordx4 v196, s[20:23], s58 offen offset:0 lds
  s_waitcnt lgkmcnt(12)
  v_mfma_f32_32x32x16_bf16 v[160:175], a[24:27], a[132:135], v[160:175]
  ds_read_b64_tr_b16 a[52:53], v205 offset:45056
  ds_read_b64_tr_b16 a[54:55], v205 offset:46080
  ds_read_b64_tr_b16 a[56:57], v206 offset:45056
  v_mfma_f32_32x32x16_bf16 v[176:191], a[28:31], a[132:135], v[176:191]
  ds_read_b64_tr_b16 a[58:59], v206 offset:46080
  ds_read_b64_tr_b16 a[60:61], v207 offset:45056
  ds_read_b64_tr_b16 a[62:63], v207 offset:46080
  buffer_load_dwordx4 v197, s[20:23], s58 offen offset:1024 lds
  s_waitcnt lgkmcnt(13)
  v_mfma_f32_32x32x16_bf16 v[128:143], a[32:35], a[136:139], v[128:143]
  v_mfma_f32_32x32x16_bf16 v[144:159], a[36:39], a[136:139], v[144:159]
  buffer_load_dwordx4 v198, s[20:23], s58 offen offset:2048 lds
  s_waitcnt lgkmcnt(9)
  v_mfma_f32_32x32x16_bf16 v[160:175], a[40:43], a[136:139], v[160:175]
  buffer_load_dwordx4 v199, s[20:23], s58 offen offset:3072 lds
  v_mfma_f32_32x32x16_bf16 v[176:191], a[44:47], a[136:139], v[176:191]
  s_add_u32 s56, s56, 1
  s_cmp_eq_u32 s56, 10
  s_cselect_b32 s56, 0, s56
  s_lshl_b32 s57, s56, 7
  s_add_u32 s57, s57, s61
  s_lshl_b32 s58, s56, 19
  s_add_u32 s58, s58, s62
  s_waitcnt vmcnt(8) lgkmcnt(0)
  s_barrier
  v_mfma_f32_32x32x16_bf16 v[128:143], a[48:51], a[140:143], v[128:143]
  ds_read_b128 a[144:147], v200 offset:0
  ds_read_b64_tr_b16 a[64:65], v204 offset:0
  ds_read_b64_tr_b16 a[66:67], v204 offset:1024
  v_mfma_f32_32x32x16_bf16 v[144:159], a[52:55], a[140:143], v[144:159]
  ds_read_b64_tr_b16 a[68:69], v205 offset:0
  ds_read_b64_tr_b16 a[70:71], v205 offset:1024
  ds_read_b64_tr_b16 a[72:73], v206 offset:0
  s_add_u32 m0, s38, 131072
  s_nop 0
  buffer_load_dwordx4 v192, s[8:11], s57 offen offset:0 lds
  v_mfma_f32_32x32x16_bf16 v[160:175], a[56:59], a[140:143], v[160:175]
  ds_read_b64_tr_b16 a[74:75], v206 offset:1024
  ds_read_b64_tr_b16 a[76:77], v207 offset:0
  ds_read_b64_tr_b16 a[78:79], v207 offset:1024
  v_mfma_f32_32x32x16_bf16 v[176:191], a[60:63], a[140:143], v[176:191]
  ds_read_b128 a[148:151], v201 offset:0
  ds_read_b64_tr_b16 a[80:81], v204 offset:4096
  ds_read_b64_tr_b16 a[82:83], v204 offset:5120
  buffer_load_dwordx4 v193, s[8:11], s57 offen offset:1024 lds
  s_waitcnt lgkmcnt(7)
  v_mfma_f32_32x32x16_bf16 v[128:143], a[64:67], a[144:147], v[128:143]
  ds_read_b64_tr_b16 a[84:85], v205 offset:4096
  ds_read_b64_tr_b16 a[86:87], v205 offset:5120
  ds_read_b64_tr_b16 a[88:89], v206 offset:4096
  v_mfma_f32_32x32x16_bf16 v[144:159], a[68:71], a[144:147], v[144:159]
  ds_read_b64_tr_b16 a[90:91], v206 offset:5120
  ds_read_b64_tr_b16 a[92:93], v207 offset:4096
  ds_read_b64_tr_b16 a[94:95], v207 offset:5120
  buffer_load_dwordx4 v194, s[8:11], s57 offen offset:2048 lds
  s_waitcnt lgkmcnt(9)
  v_mfma_f32_32x32x16_bf16 v[160:175], a[72:75], a[144:147], v[160:175]
  ds_read_b128 a[152:155], v202 offset:0
  ds_read_b64_tr_b16 a[96:97], v204 offset:8192
  ds_read_b64_tr_b16 a[98:99], v204 offset:9216
  v_mfma_f32_32x32x16_bf16 v[176:191], a[76:79], a[144:147], v[176:191]
  ds_read_b64_tr_b16 a[100:101], v205 offset:8192
  ds_read_b64_tr_b16 a[102:103], v205 offset:9216
  ds_read_b64_tr_b16 a[104:105], v206 offset:8192
  buffer_load_dwordx4 v195, s[8:11], s57 offen offset:3072 lds
  s_waitcnt lgkmcnt(10)
  v_mfma_f32_32x32x16_bf16 v[128:143], a[80:83], a[148:151], v[128:143]
  ds_read_b64_tr_b16 a[106:107], v206 offset:9216
  ds_read_b64_tr_b16 a[108:109], v207 offset:8192
  ds_read_b64_tr_b16 a[110:111], v207 offset:9216
  v_mfma_f32_32x32x16_bf16 v[144:159], a[84:87], a[148:151], v[144:159]
  ds_read_b128 a[156:159], v203 offset:0
  ds_read_b64_tr_b16 a[112:113], v204 offset:12288
  ds_read_b64_tr_b16 a[114:115], v204 offset:13312
  s_add_u32 m0, s38, 147456
  s_nop 0
  buffer_load_dwordx4 v196, s[20:23], s58 offen offset:0 lds
  s_waitcnt lgkmcnt(12)
  v_mfma_f32_32x32x16_bf16 v[160:175], a[88:91], a[148:151], v[160:175]
  ds_read_b64_tr_b16 a[116:117], v205 offset:12288
  ds_read_b64_tr_b16 a[118:119], v205 offset:13312
  ds_read_b64_tr_b16 a[120:121], v206 offset:12288
  v_mfma_f32_32x32x16_bf16 v[176:191], a[92:95], a[148:151], v[176:191]
  ds_read_b64_tr_b16 a[122:123], v206 offset:13312
  ds_read_b64_tr_b16 a[124:125], v207 offset:12288
  ds_read_b64_tr_b16 a[126:127], v207 offset:13312
  buffer_load_dwordx4 v197, s[20:23], s58 offen offset:1024 lds
  s_waitcnt lgkmcnt(13)
  v_mfma_f32_32x32x16_bf16 v[128:143], a[96:99], a[152:155], v[128:143]
  v_mfma_f32_32x32x16_bf16 v[144:159], a[100:103], a[152:155], v[144:159]
  buffer_load_dwordx4 v198, s[20:23], s58 offen offset:2048 lds
  s_waitcnt lgkmcnt(9)
  v_mfma_f32_32x32x16_bf16 v[160:175], a[104:107], a[152:155], v[160:175]
  buffer_load_dwordx4 v199, s[20:23], s58 offen offset:3072 lds
  v_mfma_f32_32x32x16_bf16 v[176:191], a[108:111], a[152:155], v[176:191]
  s_add_u32 s56, s56, 1
  s_cmp_eq_u32 s56, 10
  s_cselect_b32 s56, 0, s56
  s_lshl_b32 s57, s56, 7
  s_add_u32 s57, s57, s61
  s_lshl_b32 s58, s56, 19
  s_add_u32 s58, s58, s62
  s_waitcnt vmcnt(8) lgkmcnt(0)
  s_barrier
  v_mfma_f32_32x32x16_bf16 v[128:143], a[112:115], a[156:159], v[128:143]
  ds_read_b128 a[128:131], v208 offset:0
  ds_read_b64_tr_b16 a[0:1], v212 offset:0
  ds_read_b64_tr_b16 a[2:3], v212 offset:1024
  v_mfma_f32_32x32x16_bf16 v[144:159], a[116:119], a[156:159], v[144:159]
  ds_read_b64_tr_b16 a[4:5], v213 offset:0
  ds_read_b64_tr_b16 a[6:7], v213 offset:1024
  ds_read_b64_tr_b16 a[8:9], v214 offset:0
  s_add_u32 m0, s38, 98304
  s_nop 0
  buffer_load_dwordx4 v192, s[8:11], s57 offen offset:0 lds
  v_mfma_f32_32x32x16_bf16 v[160:175], a[120:123], a[156:159], v[160:175]
  ds_read_b64_tr_b16 a[10:11], v214 offset:1024
  ds_read_b64_tr_b16 a[12:13], v215 offset:0
  ds_read_b64_tr_b16 a[14:15], v215 offset:1024
  v_mfma_f32_32x32x16_bf16 v[176:191], a[124:127], a[156:159], v[176:191]
  ds_read_b128 a[132:135], v209 offset:0
  ds_read_b64_tr_b16 a[16:17], v212 offset:4096
  ds_read_b64_tr_b16 a[18:19], v212 offset:5120
  buffer_load_dwordx4 v193, s[8:11], s57 offen offset:1024 lds
  s_waitcnt lgkmcnt(7)
  v_mfma_f32_32x32x16_bf16 v[128:143], a[0:3], a[128:131], v[128:143]
  ds_read_b64_tr_b16 a[20:21], v213 offset:4096
  ds_read_b64_tr_b16 a[22:23], v213 offset:5120
  ds_read_b64_tr_b16 a[24:25], v214 offset:4096
  v_mfma_f32_32x32x16_bf16 v[144:159], a[4:7], a[128:131], v[144:159]
  ds_read_b64_tr_b16 a[26:27], v214 offset:5120
  ds_read_b64_tr_b16 a[28:29], v215 offset:4096
  ds_read_b64_tr_b16 a[30:31], v215 offset:5120
  buffer_load_dwordx4 v194, s[8:11], s57 offen offset:2048 lds
  s_waitcnt lgkmcnt(9)
  v_mfma_f32_32x32x16_bf16 v[160:175], a[8:11], a[128:131], v[160:175]
  ds_read_b128 a[136:139], v210 offset:0
  ds_read_b64_tr_b16 a[32:33], v212 offset:8192
  ds_read_b64_tr_b16 a[34:35], v212 offset:9216
  v_mfma_f32_32x32x16_bf16 v[176:191], a[12:15], a[128:131], v[176:191]
  ds_read_b64_tr_b16 a[36:37], v213 offset:8192
  ds_read_b64_tr_b16 a[38:39], v213 offset:9216
  ds_read_b64_tr_b16 a[40:41], v214 offset:8192
  buffer_load_dwordx4 v195, s[8:11], s57 offen offset:3072 lds
  s_waitcnt lgkmcnt(10)
  v_mfma_f32_32x32x16_bf16 v[128:143], a[16:19], a[132:135], v[128:143]
  ds_read_b64_tr_b16 a[42:43], v214 offset:9216
  ds_read_b64_tr_b16 a[44:45], v215 offset:8192
  ds_read_b64_tr_b16 a[46:47], v215 offset:9216
  v_mfma_f32_32x32x16_bf16 v[144:159], a[20:23], a[132:135], v[144:159]
  ds_read_b128 a[140:143], v211 offset:0
  ds_read_b64_tr_b16 a[48:49], v212 offset:12288
  ds_read_b64_tr_b16 a[50:51], v212 offset:13312
  s_add_u32 m0, s38, 114688
  s_nop 0
  buffer_load_dwordx4 v196, s[20:23], s58 offen offset:0 lds
  s_waitcnt lgkmcnt(12)
  v_mfma_f32_32x32x16_bf16 v[160:175], a[24:27], a[132:135], v[160:175]
  ds_read_b64_tr_b16 a[52:53], v213 offset:12288
  ds_read_b64_tr_b16 a[54:55], v213 offset:13312
  ds_read_b64_tr_b16 a[56:57], v214 offset:12288
  v_mfma_f32_32x32x16_bf16 v[176:191], a[28:31], a[132:135], v[176:191]
  ds_read_b64_tr_b16 a[58:59], v214 offset:13312
  ds_read_b64_tr_b16 a[60:61], v215 offset:12288
  ds_read_b64_tr_b16 a[62:63], v215 offset:13312
  buffer_load_dwordx4 v197, s[20:23], s58 offen offset:1024 lds
  s_waitcnt lgkmcnt(13)
  v_mfma_f32_32x32x16_bf16 v[128:143], a[32:35], a[136:139], v[128:143]
  v_mfma_f32_32x32x16_bf16 v[144:159], a[36:39], a[136:139], v[144:159]
  buffer_load_dwordx4 v198, s[20:23], s58 offen offset:2048 lds
  s_waitcnt lgkmcnt(9)
  v_mfma_f32_32x32x16_bf16 v[160:175], a[40:43], a[136:139], v[160:175]
  buffer_load_dwordx4 v199, s[20:23], s58 offen offset:3072 lds
  v_mfma_f32_32x32x16_bf16 v[176:191], a[44:47], a[136:139], v[176:191]
  s_add_u32 s56, s56, 1
  s_cmp_eq_u32 s56, 10
  s_cselect_b32 s56, 0, s56
  s_lshl_b32 s57, s56, 7
  s_add_u32 s57, s57, s61
  s_lshl_b32 s58, s56, 19
  s_add_u32 s58, s58, s62
  s_waitcnt vmcnt(8) lgkmcnt(0)
  s_barrier
  v_mfma_f32_32x32x16_bf16 v[128:143], a[48:51], a[140:143], v[128:143]
  ds_read_b128 a[144:147], v200 offset:32768
  ds_read_b64_tr_b16 a[64:65], v204 offset:32768
  ds_read_b64_tr_b16 a[66:67], v204 offset:33792
  v_mfma_f32_32x32x16_bf16 v[144:159], a[52:55], a[140:143], v[144:159]
  ds_read_b64_tr_b16 a[68:69], v205 offset:32768
  ds_read_b64_tr_b16 a[70:71], v205 offset:33792
  ds_read_b64_tr_b16 a[72:73], v206 offset:32768
  s_add_u32 m0, s38, 0
  s_nop 0
  buffer_load_dwordx4 v192, s[8:11], s57 offen offset:0 lds
  v_mfma_f32_32x32x16_bf16 v[160:175], a[56:59], a[140:143], v[160:175]
  ds_read_b64_tr_b16 a[74:75], v206 offset:33792
  ds_read_b64_tr_b16 a[76:77], v207 offset:32768
  ds_read_b64_tr_b16 a[78:79], v207 offset:33792
  v_mfma_f32_32x32x16_bf16 v[176:191], a[60:63], a[140:143], v[176:191]
  ds_read_b128 a[148:151], v201 offset:32768
  ds_read_b64_tr_b16 a[80:81], v204 offset:36864
  ds_read_b64_tr_b16 a[82:83], v204 offset:37888
  buffer_load_dwordx4 v193, s[8:11], s57 offen offset:1024 lds
  s_waitcnt lgkmcnt(7)
  v_mfma_f32_32x32x16_bf16 v[128:143], a[64:67], a[144:147], v[128:143]
  ds_read_b64_tr_b16 a[84:85], v205 offset:36864
  ds_read_b64_tr_b16 a[86:87], v205 offset:37888
  ds_read_b64_tr_b16 a[88:89], v206 offset:36864
  v_mfma_f32_32x32x16_bf16 v[144:159], a[68:71], a[144:147], v[144:159]
  ds_read_b64_tr_b16 a[90:91], v206 offset:37888
  ds_read_b64_tr_b16 a[92:93], v207 offset:36864
  ds_read_b64_tr_b16 a[94:95], v207 offset:37888
  buffer_load_dwordx4 v194, s[8:11], s57 offen offset:2048 lds
  s_waitcnt lgkmcnt(9)
  v_mfma_f32_32x32x16_bf16 v[160:175], a[72:75], a[144:147], v[160:175]
  ds_read_b128 a[152:155], v202 offset:32768
  ds_read_b64_tr_b16 a[96:97], v204 offset:40960
  ds_read_b64_tr_b16 a[98:99], v204 offset:41984
  v_mfma_f32_32x32x16_bf16 v[176:191], a[76:79], a[144:147], v[176:191]
  ds_read_b64_tr_b16 a[100:101], v205 offset:40960
  ds_read_b64_tr_b16 a[102:103], v205 offset:41984
  ds_read_b64_tr_b16 a[104:105], v206 offset:40960
  buffer_load_dwordx4 v195, s[8:11], s57 offen offset:3072 lds
  s_waitcnt lgkmcnt(10)
  v_mfma_f32_32x32x16_bf16 v[128:143], a[80:83], a[148:151], v[128:143]
  ds_read_b64_tr_b16 a[106:107], v206 offset:41984
  ds_read_b64_tr_b16 a[108:109], v207 offset:40960
  ds_read_b64_tr_b16 a[110:111], v207 offset:41984
  v_mfma_f32_32x32x16_bf16 v[144:159], a[84:87], a[148:151], v[144:159]
  ds_read_b128 a[156:159], v203 offset:32768
  ds_read_b64_tr_b16 a[112:113], v204 offset:45056
  ds_read_b64_tr_b16 a[114:115], v204 offset:46080
  s_add_u32 m0, s38, 16384
  s_nop 0
  buffer_load_dwordx4 v196, s[20:23], s58 offen offset:0 lds
  s_waitcnt lgkmcnt(12)
  v_mfma_f32_32x32x16_bf16 v[160:175], a[88:91], a[148:151], v[160:175]
  ds_read_b64_tr_b16 a[116:117], v205 offset:45056
  ds_read_b64_tr_b16 a[118:119], v205 offset:46080
  ds_read_b64_tr_b16 a[120:121], v206 offset:45056
  v_mfma_f32_32x32x16_bf16 v[176:191], a[92:95], a[148:151], v[176:191]
  ds_read_b64_tr_b16 a[122:123], v206 offset:46080
  ds_read_b64_tr_b16 a[124:125], v207 offset:45056
  ds_read_b64_tr_b16 a[126:127], v207 offset:46080
  buffer_load_dwordx4 v197, s[20:23], s58 offen offset:1024 lds
  s_waitcnt lgkmcnt(13)
  v_mfma_f32_32x32x16_bf16 v[128:143], a[96:99], a[152:155], v[128:143]
  v_mfma_f32_32x32x16_bf16 v[144:159], a[100:103], a[152:155], v[144:159]
  buffer_load_dwordx4 v198, s[20:23], s58 offen offset:2048 lds
  s_waitcnt lgkmcnt(9)
  v_mfma_f32_32x32x16_bf16 v[160:175], a[104:107], a[152:155], v[160:175]
  buffer_load_dwordx4 v199, s[20:23], s58 offen offset:3072 lds
  v_mfma_f32_32x32x16_bf16 v[176:191], a[108:111], a[152:155], v[176:191]
  s_add_u32 s56, s56, 1
  s_cmp_eq_u32 s56, 10
  s_cselect_b32 s56, 0, s56
  s_lshl_b32 s57, s56, 7
  s_add_u32 s57, s57, s61
  s_lshl_b32 s58, s56, 19
  s_add_u32 s58, s58, s62
  s_waitcnt vmcnt(8) lgkmcnt(0)
  s_barrier
  v_mfma_f32_32x32x16_bf16 v[128:143], a[112:115], a[156:159], v[128:143]
  ds_read_b128 a[128:131], v200 offset:0
  ds_read_b64_tr_b16 a[0:1], v204 offset:0
  ds_read_b64_tr_b16 a[2:3], v204 offset:1024
  v_mfma_f32_32x32x16_bf16 v[144:159], a[116:119], a[156:159], v[144:159]
  ds_read_b64_tr_b16 a[4:5], v205 offset:0
  ds_read_b64_tr_b16 a[6:7], v205 offset:1024
  ds_read_b64_tr_b16 a[8:9], v206 offset:0
  s_add_u32 m0, s38, 131072
  s_nop 0
  buffer_load_dwordx4 v192, s[8:11], s57 offen offset:0 lds
  v_mfma_f32_32x32x16_bf16 v[160:175], a[120:123], a[156:159], v[160:175]
  ds_read_b64_tr_b16 a[10:11], v206 offset:1024
  ds_read_b64_tr_b16 a[12:13], v207 offset:0
  ds_read_b64_tr_b16 a[14:15], v207 offset:1024
  v_mfma_f32_32x32x16_bf16 v[176:191], a[124:127], a[156:159], v[176:191]
  ds_read_b128 a[132:135], v201 offset:0
  ds_read_b64_tr_b16 a[16:17], v204 offset:4096
  ds_read_b64_tr_b16 a[18:19], v204 offset:5120
  buffer_load_dwordx4 v193, s[8:11], s57 offen offset:1024 lds
  s_waitcnt lgkmcnt(7)
  v_mfma_f32_32x32x16_bf16 v[128:143], a[0:3], a[128:131], v[128:143]
  ds_read_b64_tr_b16 a[20:21], v205 offset:4096
  ds_read_b64_tr_b16 a[22:23], v205 offset:5120
  ds_read_b64_tr_b16 a[24:25], v206 offset:4096
  v_mfma_f32_32x32x16_bf16 v[144:159], a[4:7], a[128:131], v[144:159]
  ds_read_b64_tr_b16 a[26:27], v206 offset:5120
  ds_read_b64_tr_b16 a[28:29], v207 offset:4096
  ds_read_b64_tr_b16 a[30:31], v207 offset:5120
  buffer_load_dwordx4 v194, s[8:11], s57 offen offset:2048 lds
  s_waitcnt lgkmcnt(9)
  v_mfma_f32_32x32x16_bf16 v[160:175], a[8:11], a[128:131], v[160:175]
  ds_read_b128 a[136:139], v202 offset:0
  ds_read_b64_tr_b16 a[32:33], v204 offset:8192
  ds_read_b64_tr_b16 a[34:35], v204 offset:9216
  v_mfma_f32_32x32x16_bf16 v[176:191], a[12:15], a[128:131], v[176:191]
  ds_read_b64_tr_b16 a[36:37], v205 offset:8192
  ds_read_b64_tr_b16 a[38:39], v205 offset:9216
  ds_read_b64_tr_b16 a[40:41], v206 offset:8192
  buffer_load_dwordx4 v195, s[8:11], s57 offen offset:3072 lds
  s_waitcnt lgkmcnt(10)
  v_mfma_f32_32x32x16_bf16 v[128:143], a[16:19], a[132:135], v[128:143]
  ds_read_b64_tr_b16 a[42:43], v206 offset:9216
  ds_read_b64_tr_b16 a[44:45], v207 offset:8192
  ds_read_b64_tr_b16 a[46:47], v207 offset:9216
  v_mfma_f32_32x32x16_bf16 v[144:159], a[20:23], a[132:135], v[144:159]
  ds_read_b128 a[140:143], v203 offset:0
  ds_read_b64_tr_b16 a[48:49], v204 offset:12288
  ds_read_b64_tr_b16 a[50:51], v204 offset:13312
  s_add_u32 m0, s38, 147456
  s_nop 0
  buffer_load_dwordx4 v196, s[20:23], s58 offen offset:0 lds
  s_waitcnt lgkmcnt(12)
  v_mfma_f32_32x32x16_bf16 v[160:175], a[24:27], a[132:135], v[160:175]
  ds_read_b64_tr_b16 a[52:53], v205 offset:12288
  ds_read_b64_tr_b16 a[54:55], v205 offset:13312
  ds_read_b64_tr_b16 a[56:57], v206 offset:12288
  v_mfma_f32_32x32x16_bf16 v[176:191], a[28:31], a[132:135], v[176:191]
  ds_read_b64_tr_b16 a[58:59], v206 offset:13312
  ds_read_b64_tr_b16 a[60:61], v207 offset:12288
  ds_read_b64_tr_b16 a[62:63], v207 offset:13312
  buffer_load_dwordx4 v197, s[20:23], s58 offen offset:1024 lds
  s_waitcnt lgkmcnt(13)
  v_mfma_f32_32x32x16_bf16 v[128:143], a[32:35], a[136:139], v[128:143]
  v_mfma_f32_32x32x16_bf16 v[144:159], a[36:39], a[136:139], v[144:159]
  buffer_load_dwordx4 v198, s[20:23], s58 offen offset:2048 lds
  s_waitcnt lgkmcnt(9)
  v_mfma_f32_32x32x16_bf16 v[160:175], a[40:43], a[136:139], v[160:175]
  buffer_load_dwordx4 v199, s[20:23], s58 offen offset:3072 lds
  v_mfma_f32_32x32x16_bf16 v[176:191], a[44:47], a[136:139], v[176:191]
  s_add_u32 s56, s56, 1
  s_cmp_eq_u32 s56, 10
  s_cselect_b32 s56, 0, s56
  s_lshl_b32 s57, s56, 7
  s_add_u32 s57, s57, s61
  s_lshl_b32 s58, s56, 19
  s_add_u32 s58, s58, s62
  s_waitcnt vmcnt(8) lgkmcnt(0)
  s_barrier
  v_mfma_f32_32x32x16_bf16 v[128:143], a[48:51], a[140:143], v[128:143]
  ds_read_b128 a[144:147], v208 offset:0
  ds_read_b64_tr_b16 a[64:65], v212 offset:0
  ds_read_b64_tr_b16 a[66:67], v212 offset:1024
  v_mfma_f32_32x32x16_bf16 v[144:159], a[52:55], a[140:143], v[144:159]
  ds_read_b64_tr_b16 a[68:69], v213 offset:0
  ds_read_b64_tr_b16 a[70:71], v213 offset:1024
  ds_read_b64_tr_b16 a[72:73], v214 offset:0
  s_add_u32 m0, s38, 98304
  s_nop 0
  buffer_load_dwordx4 v192, s[8:11], s57 offen offset:0 lds
  v_mfma_f32_32x32x16_bf16 v[160:175], a[56:59], a[140:143], v[160:175]
  ds_read_b64_tr_b16 a[74:75], v214 offset:1024
  ds_read_b64_tr_b16 a[76:77], v215 offset:0
  ds_read_b64_tr_b16 a[78:79], v215 offset:1024
  v_mfma_f32_32x32x16_bf16 v[176:191], a[60:63], a[140:143], v[176:191]
  ds_read_b128 a[148:151], v209 offset:0
  ds_read_b64_tr_b16 a[80:81], v212 offset:4096
  ds_read_b64_tr_b16 a[82:83], v212 offset:5120
  buffer_load_dwordx4 v193, s[8:11], s57 offen offset:1024 lds
  s_waitcnt lgkmcnt(7)
  v_mfma_f32_32x32x16_bf16 v[128:143], a[64:67], a[144:147], v[128:143]
  ds_read_b64_tr_b16 a[84:85], v213 offset:4096
  ds_read_b64_tr_b16 a[86:87], v213 offset:5120
  ds_read_b64_tr_b16 a[88:89], v214 offset:4096
  v_mfma_f32_32x32x16_bf16 v[144:159], a[68:71], a[144:147], v[144:159]
  ds_read_b64_tr_b16 a[90:91], v214 offset:5120
  ds_read_b64_tr_b16 a[92:93], v215 offset:4096
  ds_read_b64_tr_b16 a[94:95], v215 offset:5120
  buffer_load_dwordx4 v194, s[8:11], s57 offen offset:2048 lds
  s_waitcnt lgkmcnt(9)
  v_mfma_f32_32x32x16_bf16 v[160:175], a[72:75], a[144:147], v[160:175]
  ds_read_b128 a[152:155], v210 offset:0
  ds_read_b64_tr_b16 a[96:97], v212 offset:8192
  ds_read_b64_tr_b16 a[98:99], v212 offset:9216
  v_mfma_f32_32x32x16_bf16 v[176:191], a[76:79], a[144:147], v[176:191]
  ds_read_b64_tr_b16 a[100:101], v213 offset:8192
  ds_read_b64_tr_b16 a[102:103], v213 offset:9216
  ds_read_b64_tr_b16 a[104:105], v214 offset:8192
  buffer_load_dwordx4 v195, s[8:11], s57 offen offset:3072 lds
  s_waitcnt lgkmcnt(10)
  v_mfma_f32_32x32x16_bf16 v[128:143], a[80:83], a[148:151], v[128:143]
  ds_read_b64_tr_b16 a[106:107], v214 offset:9216
  ds_read_b64_tr_b16 a[108:109], v215 offset:8192
  ds_read_b64_tr_b16 a[110:111], v215 offset:9216
  v_mfma_f32_32x32x16_bf16 v[144:159], a[84:87], a[148:151], v[144:159]
  ds_read_b128 a[156:159], v211 offset:0
  ds_read_b64_tr_b16 a[112:113], v212 offset:12288
  ds_read_b64_tr_b16 a[114:115], v212 offset:13312
  s_add_u32 m0, s38, 114688
  s_nop 0
  buffer_load_dwordx4 v196, s[20:23], s58 offen offset:0 lds
  s_waitcnt lgkmcnt(12)
  v_mfma_f32_32x32x16_bf16 v[160:175], a[88:91], a[148:151], v[160:175]
  ds_read_b64_tr_b16 a[116:117], v213 offset:12288
  ds_read_b64_tr_b16 a[118:119], v213 offset:13312
  ds_read_b64_tr_b16 a[120:121], v214 offset:12288
  v_mfma_f32_32x32x16_bf16 v[176:191], a[92:95], a[148:151], v[176:191]
  ds_read_b64_tr_b16 a[122:123], v214 offset:13312
  ds_read_b64_tr_b16 a[124:125], v215 offset:12288
  ds_read_b64_tr_b16 a[126:127], v215 offset:13312
  buffer_load_dwordx4 v197, s[20:23], s58 offen offset:1024 lds
  s_waitcnt lgkmcnt(13)
  v_mfma_f32_32x32x16_bf16 v[128:143], a[96:99], a[152:155], v[128:143]
  v_mfma_f32_32x32x16_bf16 v[144:159], a[100:103], a[152:155], v[144:159]
  buffer_load_dwordx4 v198, s[20:23], s58 offen offset:2048 lds
  s_waitcnt lgkmcnt(9)
  v_mfma_f32_32x32x16_bf16 v[160:175], a[104:107], a[152:155], v[160:175]
  buffer_load_dwordx4 v199, s[20:23], s58 offen offset:3072 lds
  v_mfma_f32_32x32x16_bf16 v[176:191], a[108:111], a[152:155], v[176:191]
  s_waitcnt vmcnt(8) lgkmcnt(0)
  s_barrier
  v_mfma_f32_32x32x16_bf16 v[128:143], a[112:115], a[156:159], v[128:143]
  ds_read_b128 a[128:131], v200 offset:32768
  ds_read_b64_tr_b16 a[0:1], v204 offset:32768
  ds_read_b64_tr_b16 a[2:3], v204 offset:33792
  v_mfma_f32_32x32x16_bf16 v[144:159], a[116:119], a[156:159], v[144:159]
  ds_read_b64_tr_b16 a[4:5], v205 offset:32768
  ds_read_b64_tr_b16 a[6:7], v205 offset:33792
  ds_read_b64_tr_b16 a[8:9], v206 offset:32768
  v_add_u32 v216, s38, v1
  v_add_u32 v216, 0, v216
  ds_write_b128 v216, a[160:163] offset:0
  v_mfma_f32_32x32x16_bf16 v[160:175], a[120:123], a[156:159], v[160:175]
  ds_read_b64_tr_b16 a[10:11], v206 offset:33792
  ds_read_b64_tr_b16 a[12:13], v207 offset:32768
  ds_read_b64_tr_b16 a[14:15], v207 offset:33792
  v_mfma_f32_32x32x16_bf16 v[176:191], a[124:127], a[156:159], v[176:191]
  ds_read_b128 a[132:135], v201 offset:32768
  ds_read_b64_tr_b16 a[16:17], v204 offset:36864
  ds_read_b64_tr_b16 a[18:19], v204 offset:37888
  ds_write_b128 v216, a[164:167] offset:1024
  s_waitcnt lgkmcnt(9)
  v_mfma_f32_32x32x16_bf16 v[128:143], a[0:3], a[128:131], v[128:143]
  ds_read_b64_tr_b16 a[20:21], v205 offset:36864
  ds_read_b64_tr_b16 a[22:23], v205 offset:37888
  ds_read_b64_tr_b16 a[24:25], v206 offset:36864
  v_mfma_f32_32x32x16_bf16 v[144:159], a[4:7], a[128:131], v[144:159]
  ds_read_b64_tr_b16 a[26:27], v206 offset:37888
  ds_read_b64_tr_b16 a[28:29], v207 offset:36864
  ds_read_b64_tr_b16 a[30:31], v207 offset:37888
  ds_write_b128 v216, a[168:171] offset:2048
  s_waitcnt lgkmcnt(11)
  v_mfma_f32_32x32x16_bf16 v[160:175], a[8:11], a[128:131], v[160:175]
  ds_read_b128 a[136:139], v202 offset:32768
  ds_read_b64_tr_b16 a[32:33], v204 offset:40960
  ds_read_b64_tr_b16 a[34:35], v204 offset:41984
  v_mfma_f32_32x32x16_bf16 v[176:191], a[12:15], a[128:131], v[176:191]
  ds_read_b64_tr_b16 a[36:37], v205 offset:40960
  ds_read_b64_tr_b16 a[38:39], v205 offset:41984
  ds_read_b64_tr_b16 a[40:41], v206 offset:40960
  ds_write_b128 v216, a[172:175] offset:3072
  s_waitcnt lgkmcnt(12)
  v_mfma_f32_32x32x16_bf16 v[128:143], a[16:19], a[132:135], v[128:143]
  ds_read_b64_tr_b16 a[42:43], v206 offset:41984
  ds_read_b64_tr_b16 a[44:45], v207 offset:40960
  ds_read_b64_tr_b16 a[46:47], v207 offset:41984
  v_mfma_f32_32x32x16_bf16 v[144:159], a[20:23], a[132:135], v[144:159]
  ds_read_b128 a[140:143], v203 offset:32768
  ds_read_b64_tr_b16 a[48:49], v204 offset:45056
  ds_read_b64_tr_b16 a[50:51], v204 offset:46080
  v_add_u32 v216, s38, v1
  v_add_u32 v216, 16384, v216
  ds_write_b128 v216, a[176:179] offset:0
  s_waitcnt lgkmcnt(15)
  v_mfma_f32_32x32x16_bf16 v[160:175], a[24:27], a[132:135], v[160:175]
  ds_read_b64_tr_b16 a[52:53], v205 offset:45056
  ds_read_b64_tr_b16 a[54:55], v205 offset:46080
  ds_read_b64_tr_b16 a[56:57], v206 offset:45056
  v_mfma_f32_32x32x16_bf16 v[176:191], a[28:31], a[132:135], v[176:191]
  ds_read_b64_tr_b16 a[58:59], v206 offset:46080
  ds_read_b64_tr_b16 a[60:61], v207 offset:45056
  ds_read_b64_tr_b16 a[62:63], v207 offset:46080
  ds_write_b128 v216, a[180:183] offset:1024
  s_waitcnt lgkmcnt(15)
  v_mfma_f32_32x32x16_bf16 v[128:143], a[32:35], a[136:139], v[128:143]
  v_mfma_f32_32x32x16_bf16 v[144:159], a[36:39], a[136:139], v[144:159]
  ds_write_b128 v216, a[184:187] offset:2048
  s_waitcnt lgkmcnt(12)
  v_mfma_f32_32x32x16_bf16 v[160:175], a[40:43], a[136:139], v[160:175]
  ds_write_b128 v216, a[188:191] offset:3072
  v_mfma_f32_32x32x16_bf16 v[176:191], a[44:47], a[136:139], v[176:191]
  s_waitcnt vmcnt(0) lgkmcnt(0)
  s_barrier
  v_mfma_f32_32x32x16_bf16 v[128:143], a[48:51], a[140:143], v[128:143]
  ds_read_b128 a[144:147], v200 offset:0
  ds_read_b64_tr_b16 a[64:65], v204 offset:0
  ds_read_b64_tr_b16 a[66:67], v204 offset:1024
  v_mfma_f32_32x32x16_bf16 v[144:159], a[52:55], a[140:143], v[144:159]
  ds_read_b64_tr_b16 a[68:69], v205 offset:0
  ds_read_b64_tr_b16 a[70:71], v205 offset:1024
  ds_read_b64_tr_b16 a[72:73], v206 offset:0
  v_add_u32 v216, s38, v1
  v_add_u32 v216, 131072, v216
  ds_write_b128 v216, a[192:195] offset:0
  v_mfma_f32_32x32x16_bf16 v[160:175], a[56:59], a[140:143], v[160:175]
  ds_read_b64_tr_b16 a[74:75], v206 offset:1024
  ds_read_b64_tr_b16 a[76:77], v207 offset:0
  ds_read_b64_tr_b16 a[78:79], v207 offset:1024
  v_mfma_f32_32x32x16_bf16 v[176:191], a[60:63], a[140:143], v[176:191]
  ds_read_b128 a[148:151], v201 offset:0
  ds_read_b64_tr_b16 a[80:81], v204 offset:4096
  ds_read_b64_tr_b16 a[82:83], v204 offset:5120
  ds_write_b128 v216, a[196:199] offset:1024
  s_waitcnt lgkmcnt(9)
  v_mfma_f32_32x32x16_bf16 v[128:143], a[64:67], a[144:147], v[128:143]
  ds_read_b64_tr_b16 a[84:85], v205 offset:4096
  ds_read_b64_tr_b16 a[86:87], v205 offset:5120
  ds_read_b64_tr_b16 a[88:89], v206 offset:4096
  v_mfma_f32_32x32x16_bf16 v[144:159], a[68:71], a[144:147], v[144:159]
  ds_read_b64_tr_b16 a[90:91], v206 offset:5120
  ds_read_b64_tr_b16 a[92:93], v207 offset:4096
  ds_read_b64_tr_b16 a[94:95], v207 offset:5120
  ds_write_b128 v216, a[200:203] offset:2048
  s_waitcnt lgkmcnt(11)
  v_mfma_f32_32x32x16_bf16 v[160:175], a[72:75], a[144:147], v[160:175]
  ds_read_b128 a[152:155], v202 offset:0
  ds_read_b64_tr_b16 a[96:97], v204 offset:8192
  ds_read_b64_tr_b16 a[98:99], v204 offset:9216
  v_mfma_f32_32x32x16_bf16 v[176:191], a[76:79], a[144:147], v[176:191]
  ds_read_b64_tr_b16 a[100:101], v205 offset:8192
  ds_read_b64_tr_b16 a[102:103], v205 offset:9216
  ds_read_b64_tr_b16 a[104:105], v206 offset:8192
  ds_write_b128 v216, a[204:207] offset:3072
  s_waitcnt lgkmcnt(12)
  v_mfma_f32_32x32x16_bf16 v[128:143], a[80:83], a[148:151], v[128:143]
  ds_read_b64_tr_b16 a[106:107], v206 offset:9216
  ds_read_b64_tr_b16 a[108:109], v207 offset:8192
  ds_read_b64_tr_b16 a[110:111], v207 offset:9216
  v_mfma_f32_32x32x16_bf16 v[144:159], a[84:87], a[148:151], v[144:159]
  ds_read_b128 a[156:159], v203 offset:0
  ds_read_b64_tr_b16 a[112:113], v204 offset:12288
  ds_read_b64_tr_b16 a[114:115], v204 offset:13312
  s_add_u32 m0, s38, 147456
  s_add_u32 s59, s97, 114688
  s_and_b32 s59, s59, 0x1ffff
  s_add_u32 s59, s59, s38
  buffer_load_dwordx4 v2, s[12:15], s59 offen offset:0 nt lds
  s_waitcnt lgkmcnt(14)
  v_mfma_f32_32x32x16_bf16 v[160:175], a[88:91], a[148:151], v[160:175]
  ds_read_b64_tr_b16 a[116:117], v205 offset:12288
  ds_read_b64_tr_b16 a[118:119], v205 offset:13312
  ds_read_b64_tr_b16 a[120:121], v206 offset:12288
  v_mfma_f32_32x32x16_bf16 v[176:191], a[92:95], a[148:151], v[176:191]
  ds_read_b64_tr_b16 a[122:123], v206 offset:13312
  ds_read_b64_tr_b16 a[124:125], v207 offset:12288
  ds_read_b64_tr_b16 a[126:127], v207 offset:13312
  buffer_load_dwordx4 v3, s[12:15], s59 offen offset:1024 nt lds
  s_waitcnt lgkmcnt(14)
  v_mfma_f32_32x32x16_bf16 v[128:143], a[96:99], a[152:155], v[128:143]
  v_mfma_f32_32x32x16_bf16 v[144:159], a[100:103], a[152:155], v[144:159]
  buffer_load_dwordx4 v4, s[12:15], s59 offen offset:2048 nt lds
  s_waitcnt lgkmcnt(9)
  v_mfma_f32_32x32x16_bf16 v[160:175], a[104:107], a[152:155], v[160:175]
  buffer_load_dwordx4 v5, s[12:15], s59 offen offset:3072 nt lds
  v_mfma_f32_32x32x16_bf16 v[176:191], a[108:111], a[152:155], v[176:191]
  s_waitcnt lgkmcnt(0)
  s_barrier
  v_mfma_f32_32x32x16_bf16 v[128:143], a[112:115], a[156:159], v[128:143]
  ds_read_b128 a[0:3], v16 offset:32768
  ds_read_b128 a[4:7], v17 offset:32768
  ds_read_b128 a[8:11], v18 offset:32768
  v_mfma_f32_32x32x16_bf16 v[144:159], a[116:119], a[156:159], v[144:159]
  ds_read_b128 a[12:15], v19 offset:32768
  ds_read_b128 a[16:19], v20 offset:32768
  ds_read_b128 a[20:23], v21 offset:32768
  v_mfma_f32_32x32x16_bf16 v[160:175], a[120:123], a[156:159], v[160:175]
  ds_read_b128 a[24:27], v22 offset:32768
  ds_read_b128 a[28:31], v23 offset:32768
  v_mfma_f32_32x32x16_bf16 v[176:191], a[124:127], a[156:159], v[176:191]
  s_mov_b32 s63, 0x3e0293ee
  s_nop 9
  v_mul_f32 v128, s63, v128
  v_mul_f32 v129, s63, v129
  v_mul_f32 v130, s63, v130
  v_mul_f32 v131, s63, v131
  v_mul_f32 v132, s63, v132
  v_mul_f32 v133, s63, v133
  v_mul_f32 v134, s63, v134
  v_mul_f32 v135, s63, v135
  v_cvt_pk_bf16_f32 v32, v128, v129
  v_cvt_pk_bf16_f32 v33, v130, v131
  v_cvt_pk_bf16_f32 v34, v132, v133
  v_cvt_pk_bf16_f32 v35, v134, v135
  v_mul_f32 v136, s63, v136
  v_mul_f32 v137, s63, v137
  v_mul_f32 v138, s63, v138
  v_mul_f32 v139, s63, v139
  v_mul_f32 v140, s63, v140
  v_mul_f32 v141, s63, v141
  v_mul_f32 v142, s63, v142
  v_mul_f32 v143, s63, v143
  v_cvt_pk_bf16_f32 v36, v136, v137
  v_cvt_pk_bf16_f32 v37, v138, v139
  s_mov_b32 s67, 0x40004000
  s_waitcnt lgkmcnt(0)
  v_mfma_f32_32x32x16_bf16 v[64:79], a[0:3], v[32:35], 0
  v_cvt_pk_bf16_f32 v38, v140, v141
  v_cvt_pk_bf16_f32 v39, v142, v143
  v_mul_f32 v144, s63, v144
  v_mul_f32 v145, s63, v145
  v_mul_f32 v146, s63, v146
  v_mul_f32 v147, s63, v147
  v_mul_f32 v148, s63, v148
  v_mul_f32 v149, s63, v149
  v_mul_f32 v150, s63, v150
  v_mul_f32 v151, s63, v151
  v_cvt_pk_bf16_f32 v40, v144, v145
  v_cvt_pk_bf16_f32 v41, v146, v147
  ds_read_b128 a[32:35], v16 offset:40960
  ds_read_b128 a[36:39], v17 offset:40960
  ds_read_b128 a[40:43], v18 offset:40960
  ds_read_b128 a[44:47], v19 offset:40960
  s_add_u32 m0, s38, 98304
  s_add_u32 s59, s97, 0
  s_and_b32 s59, s59, 0x1ffff
  s_lshl1_add_u32 s59, s38, s59
  buffer_load_dwordx4 v6, s[16:19], s59 offen offset:0 nt lds
  v_mfma_f32_32x32x16_bf16 v[64:79], a[4:7], v[36:39], v[64:79]
  v_cvt_pk_bf16_f32 v42, v148, v149
  v_cvt_pk_bf16_f32 v43, v150, v151
  v_mul_f32 v152, s63, v152
  v_mul_f32 v153, s63, v153
  v_mul_f32 v154, s63, v154
  v_mul_f32 v155, s63, v155
  v_mul_f32 v156, s63, v156
  v_mul_f32 v157, s63, v157
  v_mul_f32 v158, s63, v158
  v_mul_f32 v159, s63, v159
  v_cvt_pk_bf16_f32 v44, v152, v153
  v_cvt_pk_bf16_f32 v45, v154, v155
  ds_read_b128 a[48:51], v20 offset:40960
  ds_read_b128 a[52:55], v21 offset:40960
  ds_read_b128 a[56:59], v22 offset:40960
  ds_read_b128 a[60:63], v23 offset:40960
  buffer_load_dwordx4 v7, s[16:19], s59 offen offset:1024 nt lds
  v_mfma_f32_32x32x16_bf16 v[64:79], a[8:11], v[40:43], v[64:79]
  v_cvt_pk_bf16_f32 v46, v156, v157
  v_cvt_pk_bf16_f32 v47, v158, v159
  v_mul_f32 v160, s63, v160
  v_mul_f32 v161, s63, v161
  v_mul_f32 v162, s63, v162
  v_mul_f32 v163, s63, v163
  v_mul_f32 v164, s63, v164
  v_mul_f32 v165, s63, v165
  v_mul_f32 v166, s63, v166
  v_mul_f32 v167, s63, v167
  v_cvt_pk_bf16_f32 v48, v160, v161
  v_cvt_pk_bf16_f32 v49, v162, v163
  v_mfma_f32_32x32x16_bf16 v[64:79], a[12:15], v[44:47], v[64:79]
  v_cvt_pk_bf16_f32 v50, v164, v165
  v_cvt_pk_bf16_f32 v51, v166, v167
  v_mul_f32 v168, s63, v168
  v_mul_f32 v169, s63, v169
  v_mul_f32 v170, s63, v170
  v_mul_f32 v171, s63, v171
  v_mul_f32 v172, s63, v172
  v_mul_f32 v173, s63, v173
  v_mul_f32 v174, s63, v174
  v_mul_f32 v175, s63, v175
  v_cvt_pk_bf16_f32 v52, v168, v169
  v_cvt_pk_bf16_f32 v53, v170, v171
  v_mfma_f32_32x32x16_bf16 v[64:79], a[16:19], v[48:51], v[64:79]
  v_cvt_pk_bf16_f32 v54, v172, v173
  v_cvt_pk_bf16_f32 v55, v174, v175
  v_mul_f32 v176, s63, v176
  v_mul_f32 v177, s63, v177
  v_mul_f32 v178, s63, v178
  v_mul_f32 v179, s63, v179
  v_mul_f32 v180, s63, v180
  v_mul_f32 v181, s63, v181
  v_mul_f32 v182, s63, v182
  v_mul_f32 v183, s63, v183
  v_cvt_pk_bf16_f32 v56, v176, v177
  v_cvt_pk_bf16_f32 v57, v178, v179
  v_mfma_f32_32x32x16_bf16 v[64:79], a[20:23], v[52:55], v[64:79]
  v_cvt_pk_bf16_f32 v58, v180, v181
  v_cvt_pk_bf16_f32 v59, v182, v183
  v_mul_f32 v184, s63, v184
  v_mul_f32 v185, s63, v185
  v_mul_f32 v186, s63, v186
  v_mul_f32 v187, s63, v187
  v_mul_f32 v188, s63, v188
  v_mul_f32 v189, s63, v189
  v_mul_f32 v190, s63, v190
  v_mul_f32 v191, s63, v191
  v_cvt_pk_bf16_f32 v60, v184, v185
  v_cvt_pk_bf16_f32 v61, v186, v187
  v_mfma_f32_32x32x16_bf16 v[64:79], a[24:27], v[56:59], v[64:79]
  v_cvt_pk_bf16_f32 v62, v188, v189
  v_cvt_pk_bf16_f32 v63, v190, v191
  s_nop 1
  v_mfma_f32_32x32x16_bf16 v[64:79], a[28:31], v[60:63], v[64:79]
  s_waitcnt lgkmcnt(0)
  v_mfma_f32_32x32x16_bf16 v[80:95], a[32:35], v[32:35], 0
  ds_read_b128 a[0:3], v16 offset:49152
  ds_read_b128 a[4:7], v17 offset:49152
  ds_read_b128 a[8:11], v18 offset:49152
  ds_read_b128 a[12:15], v19 offset:49152
  buffer_load_dwordx4 v8, s[16:19], s59 offen offset:2048 nt lds
  v_mfma_f32_32x32x16_bf16 v[80:95], a[36:39], v[36:39], v[80:95]
  ds_read_b128 a[16:19], v20 offset:49152
  ds_read_b128 a[20:23], v21 offset:49152
  ds_read_b128 a[24:27], v22 offset:49152
  ds_read_b128 a[28:31], v23 offset:49152
  buffer_load_dwordx4 v9, s[16:19], s59 offen offset:3072 nt lds
  s_nop 1
  v_mfma_f32_32x32x16_bf16 v[80:95], a[40:43], v[40:43], v[80:95]
  v_max3_f32 v24, v64, v65, v66
  v_max3_f32 v24, v24, v67, v68
  v_max3_f32 v24, v24, v69, v70
  v_max3_f32 v24, v24, v71, v72
  v_max3_f32 v24, v24, v73, v74
  v_max3_f32 v24, v24, v75, v76
  v_max3_f32 v24, v24, v77, v78
  v_max_f32 v24, v24, v79
  v_mov_b32 v25, v24
  s_nop 1
  v_permlane32_swap_b32 v24, v25
  s_nop 1
  v_max_f32 v24, v24, v25
  v_sub_f32 v96, 0xc1a00000, v24
  v_mov_b32 v97, v96
  v_mfma_f32_32x32x16_bf16 v[80:95], a[44:47], v[44:47], v[80:95]
  v_mov_b32 v98, v96
  v_mov_b32 v99, v96
  v_mov_b32 v100, v96
  v_mov_b32 v101, v96
  v_mov_b32 v102, v96
  v_mov_b32 v103, v96
  v_mov_b32 v104, v96
  v_mov_b32 v105, v96
  v_mov_b32 v106, v96
  v_mov_b32 v107, v96
  v_mov_b32 v108, v96
  v_mov_b32 v109, v96
  v_mov_b32 v110, v96
  v_mov_b32 v111, v96
  v_add_f32 v64, v64, v96
  v_mfma_f32_32x32x16_bf16 v[80:95], a[48:51], v[48:51], v[80:95]
  v_add_f32 v65, v65, v96
  v_add_f32 v66, v66, v96
  v_add_f32 v67, v67, v96
  v_add_f32 v68, v68, v96
  v_add_f32 v69, v69, v96
  v_add_f32 v70, v70, v96
  v_add_f32 v71, v71, v96
  v_add_f32 v72, v72, v96
  v_add_f32 v73, v73, v96
  v_add_f32 v74, v74, v96
  v_add_f32 v75, v75, v96
  v_add_f32 v76, v76, v96
  v_add_f32 v77, v77, v96
  v_add_f32 v78, v78, v96
  v_mfma_f32_32x32x16_bf16 v[80:95], a[52:55], v[52:55], v[80:95]
  v_add_f32 v79, v79, v96
  v_exp_f32 v24, v64
  v_exp_f32 v25, v65
  v_exp_f32 v26, v66
  v_cvt_pk_bf16_f32 v128, v24, v25
  v_exp_f32 v27, v67
  v_exp_f32 v24, v68
  v_cvt_pk_bf16_f32 v129, v26, v27
  v_exp_f32 v25, v69
  v_mfma_f32_32x32x16_bf16 v[80:95], a[56:59], v[56:59], v[80:95]
  v_exp_f32 v26, v70
  v_cvt_pk_bf16_f32 v130, v24, v25
  v_exp_f32 v27, v71
  v_exp_f32 v24, v72
  v_cvt_pk_bf16_f32 v131, v26, v27
  v_exp_f32 v25, v73
  v_exp_f32 v26, v74
  v_cvt_pk_bf16_f32 v132, v24, v25
  v_exp_f32 v27, v75
  v_mfma_f32_32x32x16_bf16 v[80:95], a[60:63], v[60:63], v[80:95]
  v_exp_f32 v24, v76
  v_cvt_pk_bf16_f32 v133, v26, v27
  v_exp_f32 v25, v77
  v_exp_f32 v26, v78
  v_cvt_pk_bf16_f32 v134, v24, v25
  v_exp_f32 v27, v79
  v_or3_b32 v15, v128, v129, v130
  v_cvt_pk_bf16_f32 v135, v26, v27
  s_waitcnt lgkmcnt(0)
  v_mfma_f32_32x32x16_bf16 v[112:127], a[0:3], v[32:35], v[96:111]
  ds_read_b128 a[32:35], v16 offset:57344
  v_mfma_f32_32x32x16_bf16 v[112:127], a[4:7], v[36:39], v[112:127]
  ds_read_b128 a[36:39], v17 offset:57344
  s_add_u32 m0, s38, 114688
  s_add_u32 s59, s97, 32768
  s_and_b32 s59, s59, 0x1ffff
  s_lshl1_add_u32 s59, s38, s59
  buffer_load_dwordx4 v6, s[16:19], s59 offen offset:0 nt lds
  s_nop 4
  v_mfma_f32_32x32x16_bf16 v[112:127], a[8:11], v[40:43], v[112:127]
  ds_read_b128 a[40:43], v18 offset:57344
  v_add_f32 v80, v80, v96
  v_add_f32 v81, v81, v96
  v_add_f32 v82, v82, v96
  v_add_f32 v83, v83, v96
  v_add_f32 v84, v84, v96
  v_add_f32 v85, v85, v96
  v_add_f32 v86, v86, v96
  v_add_f32 v87, v87, v96
  v_mfma_f32_32x32x16_bf16 v[112:127], a[12:15], v[44:47], v[112:127]
  ds_read_b128 a[44:47], v19 offset:57344
  buffer_load_dwordx4 v7, s[16:19], s59 offen offset:1024 nt lds
  v_add_f32 v88, v88, v96
  v_add_f32 v89, v89, v96
  v_add_f32 v90, v90, v96
  v_add_f32 v91, v91, v96
  v_add_f32 v92, v92, v96
  v_add_f32 v93, v93, v96
  v_add_f32 v94, v94, v96
  v_add_f32 v95, v95, v96
  v_mfma_f32_32x32x16_bf16 v[112:127], a[16:19], v[48:51], v[112:127]
  ds_read_b128 a[48:51], v20 offset:57344
  v_exp_f32 v24, v80
  v_exp_f32 v25, v81
  v_exp_f32 v26, v82
  v_cvt_pk_bf16_f32 v136, v24, v25
  v_exp_f32 v27, v83
  v_mfma_f32_32x32x16_bf16 v[112:127], a[20:23], v[52:55], v[112:127]
  ds_read_b128 a[52:55], v21 offset:57344
  v_exp_f32 v24, v84
  v_cvt_pk_bf16_f32 v137, v26, v27
  v_exp_f32 v25, v85
  v_exp_f32 v26, v86
  v_cvt_pk_bf16_f32 v138, v24, v25
  v_mfma_f32_32x32x16_bf16 v[112:127], a[24:27], v[56:59], v[112:127]
  ds_read_b128 a[56:59], v22 offset:57344
  v_exp_f32 v27, v87
  v_exp_f32 v24, v88
  v_cvt_pk_bf16_f32 v139, v26, v27
  v_exp_f32 v25, v89
  v_mfma_f32_32x32x16_bf16 v[112:127], a[28:31], v[60:63], v[112:127]
  ds_read_b128 a[60:63], v23 offset:57344
  v_exp_f32 v26, v90
  v_cvt_pk_bf16_f32 v140, v24, v25
  v_exp_f32 v27, v91
  v_exp_f32 v24, v92
  s_waitcnt lgkmcnt(4)
  v_mfma_f32_32x32x16_bf16 v[64:79], a[32:35], v[32:35], v[96:111]
  ds_read_b128 a[0:3], v16 offset:0
  v_cvt_pk_bf16_f32 v141, v26, v27
  v_exp_f32 v25, v93
  v_exp_f32 v26, v94
  v_cvt_pk_bf16_f32 v142, v24, v25
  v_exp_f32 v27, v95
  v_mfma_f32_32x32x16_bf16 v[64:79], a[36:39], v[36:39], v[64:79]
  ds_read_b128 a[4:7], v17 offset:0
  buffer_load_dwordx4 v8, s[16:19], s59 offen offset:2048 nt lds
  v_or3_b32 v15, v136, v137, v138
  v_cvt_pk_bf16_f32 v143, v26, v27
  v_or3_b32 v15, v15, v139, v140
  v_or3_b32 v15, v15, v141, v142
  v_bitop3_b32 v15, v15, v143, s67 bitop3:0xa8
  v_cmp_ne_u32 vcc, 0, v15
  v_mfma_f32_32x32x16_bf16 v[64:79], a[40:43], v[40:43], v[64:79]
  s_cbranch_vccnz L_rarev0_1
L_backv0_1:
  ds_read_b128 a[8:11], v18 offset:0
  v_exp_f32 v24, v112
  v_exp_f32 v25, v113
  v_exp_f32 v26, v114
  v_mfma_f32_32x32x16_bf16 v[64:79], a[44:47], v[44:47], v[64:79]
  ds_read_b128 a[12:15], v19 offset:0
  buffer_load_dwordx4 v9, s[16:19], s59 offen offset:3072 nt lds
  v_cvt_pk_bf16_f32 v144, v24, v25
  v_exp_f32 v27, v115
  v_exp_f32 v24, v116
  v_cvt_pk_bf16_f32 v145, v26, v27
  s_waitcnt lgkmcnt(4)
  v_mfma_f32_32x32x16_bf16 v[64:79], a[48:51], v[48:51], v[64:79]
  ds_read_b128 a[16:19], v20 offset:0
  v_exp_f32 v25, v117
  v_exp_f32 v26, v118
  v_cvt_pk_bf16_f32 v146, v24, v25
  v_exp_f32 v27, v119
  v_mfma_f32_32x32x16_bf16 v[64:79], a[52:55], v[52:55], v[64:79]
  ds_read_b128 a[20:23], v21 offset:0
  v_exp_f32 v24, v120
  v_cvt_pk_bf16_f32 v147, v26, v27
  v_exp_f32 v25, v121
  v_exp_f32 v26, v122
  v_mfma_f32_32x32x16_bf16 v[64:79], a[56:59], v[56:59], v[64:79]
  ds_read_b128 a[24:27], v22 offset:0
  v_cvt_pk_bf16_f32 v148, v24, v25
  v_exp_f32 v27, v123
  v_exp_f32 v24, v124
  v_mfma_f32_32x32x16_bf16 v[64:79], a[60:63], v[60:63], v[64:79]
  ds_read_b128 a[28:31], v23 offset:0
  v_cvt_pk_bf16_f32 v149, v26, v27
  v_exp_f32 v25, v125
  v_exp_f32 v26, v126
  s_waitcnt lgkmcnt(4)
  v_mfma_f32_32x32x16_bf16 v[80:95], a[0:3], v[32:35], v[96:111]
  ds_read_b128 a[32:35], v16 offset:8192
  v_cvt_pk_bf16_f32 v150, v24, v25
  v_exp_f32 v27, v127
  v_or3_b32 v15, v144, v145, v146
  v_cvt_pk_bf16_f32 v151, v26, v27
  v_mfma_f32_32x32x16_bf16 v[80:95], a[4:7], v[36:39], v[80:95]
  ds_read_b128 a[36:39], v17 offset:8192
  v_or3_b32 v15, v15, v147, v148
  v_or3_b32 v15, v15, v149, v150
  v_bitop3_b32 v15, v15, v151, s67 bitop3:0xa8
  v_cmp_ne_u32 vcc, 0, v15
  v_mfma_f32_32x32x16_bf16 v[80:95], a[8:11], v[40:43], v[80:95]
  s_cbranch_vccnz L_rarev0_2
L_backv0_2:
  ds_read_b128 a[40:43], v18 offset:8192
  v_exp_f32 v24, v64
  v_exp_f32 v25, v65
  v_exp_f32 v26, v66
  v_mfma_f32_32x32x16_bf16 v[80:95], a[12:15], v[44:47], v[80:95]
  ds_read_b128 a[44:47], v19 offset:8192
  v_cvt_pk_bf16_f32 v152, v24, v25
  v_exp_f32 v27, v67
  v_exp_f32 v24, v68
  v_cvt_pk_bf16_f32 v153, v26, v27
  s_waitcnt lgkmcnt(4)
  v_mfma_f32_32x32x16_bf16 v[80:95], a[16:19], v[48:51], v[80:95]
  ds_read_b128 a[48:51], v20 offset:8192
  v_exp_f32 v25, v69
  v_exp_f32 v26, v70
  v_cvt_pk_bf16_f32 v154, v24, v25
  v_exp_f32 v27, v71
  v_mfma_f32_32x32x16_bf16 v[80:95], a[20:23], v[52:55], v[80:95]
  ds_read_b128 a[52:55], v21 offset:8192
  v_exp_f32 v24, v72
  v_cvt_pk_bf16_f32 v155, v26, v27
  v_exp_f32 v25, v73
  v_exp_f32 v26, v74
  v_mfma_f32_32x32x16_bf16 v[80:95], a[24:27], v[56:59], v[80:95]
  ds_read_b128 a[56:59], v22 offset:8192
  v_cvt_pk_bf16_f32 v156, v24, v25
  v_exp_f32 v27, v75
  v_exp_f32 v24, v76
  v_mfma_f32_32x32x16_bf16 v[80:95], a[28:31], v[60:63], v[80:95]
  ds_read_b128 a[60:63], v23 offset:8192
  v_cvt_pk_bf16_f32 v157, v26, v27
  v_exp_f32 v25, v77
  v_exp_f32 v26, v78
  s_barrier
  s_waitcnt lgkmcnt(4)
  v_mfma_f32_32x32x16_bf16 v[112:127], a[32:35], v[32:35], v[96:111]
  ds_read_b128 a[0:3], v16 offset:16384
  v_cvt_pk_bf16_f32 v158, v24, v25
  v_exp_f32 v27, v79
  v_or3_b32 v15, v152, v153, v154
  v_cvt_pk_bf16_f32 v159, v26, v27
  v_mfma_f32_32x32x16_bf16 v[112:127], a[36:39], v[36:39], v[112:127]
  ds_read_b128 a[4:7], v17 offset:16384
  s_add_u32 m0, s38, 65536
  s_add_u32 s59, s97, 65536
  s_and_b32 s59, s59, 0x1ffff
  s_lshl1_add_u32 s59, s38, s59
  buffer_load_dwordx4 v6, s[16:19], s59 offen offset:0 nt lds
  v_or3_b32 v15, v15, v155, v156
  v_or3_b32 v15, v15, v157, v158
  v_bitop3_b32 v15, v15, v159, s67 bitop3:0xa8
  v_cmp_ne_u32 vcc, 0, v15
  v_mfma_f32_32x32x16_bf16 v[112:127], a[40:43], v[40:43], v[112:127]
  s_cbranch_vccnz L_rarev0_3
L_backv0_3:
  ds_read_b128 a[8:11], v18 offset:16384
  v_exp_f32 v24, v80
  v_exp_f32 v25, v81
  v_exp_f32 v26, v82
  v_mfma_f32_32x32x16_bf16 v[112:127], a[44:47], v[44:47], v[112:127]
  ds_read_b128 a[12:15], v19 offset:16384
  buffer_load_dwordx4 v7, s[16:19], s59 offen offset:1024 nt lds
  v_cvt_pk_bf16_f32 v160, v24, v25
  v_exp_f32 v27, v83
  v_exp_f32 v24, v84
  v_cvt_pk_bf16_f32 v161, v26, v27
  s_waitcnt lgkmcnt(4)
  v_mfma_f32_32x32x16_bf16 v[112:127], a[48:51], v[48:51], v[112:127]
  ds_read_b128 a[16:19], v20 offset:16384
  v_exp_f32 v25, v85
  v_exp_f32 v26, v86
  v_cvt_pk_bf16_f32 v162, v24, v25
  v_exp_f32 v27, v87
  v_mfma_f32_32x32x16_bf16 v[112:127], a[52:55], v[52:55], v[112:127]
  ds_read_b128 a[20:23], v21 offset:16384
  v_exp_f32 v24, v88
  v_cvt_pk_bf16_f32 v163, v26, v27
  v_exp_f32 v25, v89
  v_exp_f32 v26, v90
  v_mfma_f32_32x32x16_bf16 v[112:127], a[56:59], v[56:59], v[112:127]
  ds_read_b128 a[24:27], v22 offset:16384
  v_cvt_pk_bf16_f32 v164, v24, v25
  v_exp_f32 v27, v91
  v_exp_f32 v24, v92
  v_mfma_f32_32x32x16_bf16 v[112:127], a[60:63], v[60:63], v[112:127]
  ds_read_b128 a[28:31], v23 offset:16384
  v_cvt_pk_bf16_f32 v165, v26, v27
  v_exp_f32 v25, v93
  v_exp_f32 v26, v94
  s_waitcnt lgkmcnt(4)
  v_mfma_f32_32x32x16_bf16 v[64:79], a[0:3], v[32:35], v[96:111]
  ds_read_b128 a[32:35], v16 offset:24576
  v_cvt_pk_bf16_f32 v166, v24, v25
  v_exp_f32 v27, v95
  v_or3_b32 v15, v160, v161, v162
  v_cvt_pk_bf16_f32 v167, v26, v27
  v_mfma_f32_32x32x16_bf16 v[64:79], a[4:7], v[36:39], v[64:79]
  ds_read_b128 a[36:39], v17 offset:24576
  buffer_load_dwordx4 v8, s[16:19], s59 offen offset:2048 nt lds
  v_or3_b32 v15, v15, v163, v164
  v_or3_b32 v15, v15, v165, v166
  v_bitop3_b32 v15, v15, v167, s67 bitop3:0xa8
  v_cmp_ne_u32 vcc, 0, v15
  v_mfma_f32_32x32x16_bf16 v[64:79], a[8:11], v[40:43], v[64:79]
  s_cbranch_vccnz L_rarev0_4
L_backv0_4:
  ds_read_b128 a[40:43], v18 offset:24576
  v_exp_f32 v24, v112
  v_exp_f32 v25, v113
  v_exp_f32 v26, v114
  v_mfma_f32_32x32x16_bf16 v[64:79], a[12:15], v[44:47], v[64:79]
  ds_read_b128 a[44:47], v19 offset:24576
  buffer_load_dwordx4 v9, s[16:19], s59 offen offset:3072 nt lds
  v_cvt_pk_bf16_f32 v168, v24, v25
  v_exp_f32 v27, v115
  v_exp_f32 v24, v116
  v_cvt_pk_bf16_f32 v169, v26, v27
  s_waitcnt lgkmcnt(4)
  v_mfma_f32_32x32x16_bf16 v[64:79], a[16:19], v[48:51], v[64:79]
  ds_read_b128 a[48:51], v20 offset:24576
  v_exp_f32 v25, v117
  v_exp_f32 v26, v118
  v_cvt_pk_bf16_f32 v170, v24, v25
  v_exp_f32 v27, v119
  v_mfma_f32_32x32x16_bf16 v[64:79], a[20:23], v[52:55], v[64:79]
  ds_read_b128 a[52:55], v21 offset:24576
  v_exp_f32 v24, v120
  v_cvt_pk_bf16_f32 v171, v26, v27
  v_exp_f32 v25, v121
  v_exp_f32 v26, v122
  v_mfma_f32_32x32x16_bf16 v[64:79], a[24:27], v[56:59], v[64:79]
  ds_read_b128 a[56:59], v22 offset:24576
  v_cvt_pk_bf16_f32 v172, v24, v25
  v_exp_f32 v27, v123
  v_exp_f32 v24, v124
  v_mfma_f32_32x32x16_bf16 v[64:79], a[28:31], v[60:63], v[64:79]
  ds_read_b128 a[60:63], v23 offset:24576
  v_cvt_pk_bf16_f32 v173, v26, v27
  v_exp_f32 v25, v125
  v_exp_f32 v26, v126
  s_waitcnt lgkmcnt(4)
  v_mfma_f32_32x32x16_bf16 v[80:95], a[32:35], v[32:35], v[96:111]
  v_add_u32 v16, 4294934528, v16
  v_add_u32 v17, 4294934528, v17
  v_cvt_pk_bf16_f32 v174, v24, v25
  v_exp_f32 v27, v127
  v_or3_b32 v15, v168, v169, v170
  v_cvt_pk_bf16_f32 v175, v26, v27
  v_mfma_f32_32x32x16_bf16 v[80:95], a[36:39], v[36:39], v[80:95]
  v_add_u32 v18, 4294934528, v18
  v_add_u32 v19, 4294934528, v19
  s_add_u32 m0, s38, 81920
  s_add_u32 s59, s97, 98304
  s_and_b32 s59, s59, 0x1ffff
  s_lshl1_add_u32 s59, s38, s59
  buffer_load_dwordx4 v6, s[16:19], s59 offen offset:0 nt lds
  v_or3_b32 v15, v15, v171, v172
  v_or3_b32 v15, v15, v173, v174
  v_bitop3_b32 v15, v15, v175, s67 bitop3:0xa8
  v_cmp_ne_u32 vcc, 0, v15
  v_mfma_f32_32x32x16_bf16 v[80:95], a[40:43], v[40:43], v[80:95]
  s_cbranch_vccnz L_rarev0_5
L_backv0_5:
  v_add_u32 v20, 4294934528, v20
  v_add_u32 v21, 4294934528, v21
  v_exp_f32 v24, v64
  v_exp_f32 v25, v65
  v_exp_f32 v26, v66
  v_mfma_f32_32x32x16_bf16 v[80:95], a[44:47], v[44:47], v[80:95]
  v_add_u32 v22, 4294934528, v22
  v_add_u32 v23, 4294934528, v23
  buffer_load_dwordx4 v7, s[16:19], s59 offen offset:1024 nt lds
  v_cvt_pk_bf16_f32 v176, v24, v25
  v_exp_f32 v27, v67
  v_exp_f32 v24, v68
  v_cvt_pk_bf16_f32 v177, v26, v27
  s_waitcnt lgkmcnt(0)
  v_mfma_f32_32x32x16_bf16 v[80:95], a[48:51], v[48:51], v[80:95]
  ds_read_b128 a[0:3], v16 offset:0
  ds_read_b128 a[4:7], v17 offset:0
  v_exp_f32 v25, v69
  v_exp_f32 v26, v70
  v_cvt_pk_bf16_f32 v178, v24, v25
  v_exp_f32 v27, v71
  v_mfma_f32_32x32x16_bf16 v[80:95], a[52:55], v[52:55], v[80:95]
  ds_read_b128 a[8:11], v18 offset:0
  ds_read_b128 a[12:15], v19 offset:0
  v_exp_f32 v24, v72
  v_cvt_pk_bf16_f32 v179, v26, v27
  v_exp_f32 v25, v73
  v_exp_f32 v26, v74
  v_mfma_f32_32x32x16_bf16 v[80:95], a[56:59], v[56:59], v[80:95]
  ds_read_b128 a[16:19], v20 offset:0
  ds_read_b128 a[20:23], v21 offset:0
  v_cvt_pk_bf16_f32 v180, v24, v25
  v_exp_f32 v27, v75
  v_exp_f32 v24, v76
  v_mfma_f32_32x32x16_bf16 v[80:95], a[60:63], v[60:63], v[80:95]
  ds_read_b128 a[24:27], v22 offset:0
  ds_read_b128 a[28:31], v23 offset:0
  v_cvt_pk_bf16_f32 v181, v26, v27
  v_exp_f32 v25, v77
  v_exp_f32 v26, v78
  s_waitcnt lgkmcnt(4)
  v_mfma_f32_32x32x16_bf16 v[112:127], a[0:3], v[32:35], v[96:111]
  ds_read_b128 a[32:35], v16 offset:8192
  v_cvt_pk_bf16_f32 v182, v24, v25
  v_exp_f32 v27, v79
  v_or3_b32 v15, v176, v177, v178
  v_cvt_pk_bf16_f32 v183, v26, v27
  v_mfma_f32_32x32x16_bf16 v[112:127], a[4:7], v[36:39], v[112:127]
  ds_read_b128 a[36:39], v17 offset:8192
  buffer_load_dwordx4 v8, s[16:19], s59 offen offset:2048 nt lds
  v_or3_b32 v15, v15, v179, v180
  v_or3_b32 v15, v15, v181, v182
  v_bitop3_b32 v15, v15, v183, s67 bitop3:0xa8
  v_cmp_ne_u32 vcc, 0, v15
  v_mfma_f32_32x32x16_bf16 v[112:127], a[8:11], v[40:43], v[112:127]
  s_cbranch_vccnz L_rarev0_6
L_backv0_6:
  ds_read_b128 a[40:43], v18 offset:8192
  v_exp_f32 v24, v80
  v_exp_f32 v25, v81
  v_exp_f32 v26, v82
  v_mfma_f32_32x32x16_bf16 v[112:127], a[12:15], v[44:47], v[112:127]
  ds_read_b128 a[44:47], v19 offset:8192
  buffer_load_dwordx4 v9, s[16:19], s59 offen offset:3072 nt lds
  v_cvt_pk_bf16_f32 v184, v24, v25
  v_exp_f32 v27, v83
  v_exp_f32 v24, v84
  v_cvt_pk_bf16_f32 v185, v26, v27
  s_waitcnt lgkmcnt(4)
  v_mfma_f32_32x32x16_bf16 v[112:127], a[16:19], v[48:51], v[112:127]
  ds_read_b128 a[48:51], v20 offset:8192
  v_exp_f32 v25, v85
  v_exp_f32 v26, v86
  v_cvt_pk_bf16_f32 v186, v24, v25
  v_exp_f32 v27, v87
  v_mfma_f32_32x32x16_bf16 v[112:127], a[20:23], v[52:55], v[112:127]
  ds_read_b128 a[52:55], v21 offset:8192
  v_exp_f32 v24, v88
  v_cvt_pk_bf16_f32 v187, v26, v27
  v_exp_f32 v25, v89
  v_exp_f32 v26, v90
  v_mfma_f32_32x32x16_bf16 v[112:127], a[24:27], v[56:59], v[112:127]
  ds_read_b128 a[56:59], v22 offset:8192
  v_cvt_pk_bf16_f32 v188, v24, v25
  v_exp_f32 v27, v91
  v_exp_f32 v24, v92
  v_mfma_f32_32x32x16_bf16 v[112:127], a[28:31], v[60:63], v[112:127]
  ds_read_b128 a[60:63], v23 offset:8192
  v_cvt_pk_bf16_f32 v189, v26, v27
  v_exp_f32 v25, v93
  v_exp_f32 v26, v94
  s_barrier
  s_waitcnt lgkmcnt(4)
  v_mfma_f32_32x32x16_bf16 v[64:79], a[32:35], v[32:35], v[96:111]
  ds_read_b128 a[0:3], v16 offset:16384
  v_cvt_pk_bf16_f32 v190, v24, v25
  v_exp_f32 v27, v95
  v_or3_b32 v15, v184, v185, v186
  v_cvt_pk_bf16_f32 v191, v26, v27
  v_mfma_f32_32x32x16_bf16 v[64:79], a[36:39], v[36:39], v[64:79]
  ds_read_b128 a[4:7], v17 offset:16384
  s_add_u32 m0, s38, 32768
  s_add_u32 s59, s97, 128
  s_and_b32 s59, s59, 0x1ffff
  s_lshl1_add_u32 s59, s38, s59
  buffer_load_dwordx4 v6, s[16:19], s59 offen offset:0 nt lds
  v_or3_b32 v15, v15, v187, v188
  v_or3_b32 v15, v15, v189, v190
  v_bitop3_b32 v15, v15, v191, s67 bitop3:0xa8
  v_cmp_ne_u32 vcc, 0, v15
  v_mfma_f32_32x32x16_bf16 v[64:79], a[40:43], v[40:43], v[64:79]
  s_cbranch_vccnz L_rarev0_7
L_backv0_7:
  ds_read_b128 a[8:11], v18 offset:16384
  v_exp_f32 v24, v112
  v_exp_f32 v25, v113
  v_exp_f32 v26, v114
  v_mfma_f32_32x32x16_bf16 v[64:79], a[44:47], v[44:47], v[64:79]
  ds_read_b128 a[12:15], v19 offset:16384
  buffer_load_dwordx4 v7, s[16:19], s59 offen offset:1024 nt lds
  v_cvt_pk_bf16_f32 v192, v24, v25
  v_exp_f32 v27, v115
  v_exp_f32 v24, v116
  v_cvt_pk_bf16_f32 v193, v26, v27
  s_waitcnt lgkmcnt(4)
  v_mfma_f32_32x32x16_bf16 v[64:79], a[48:51], v[48:51], v[64:79]
  ds_read_b128 a[16:19], v20 offset:16384
  v_exp_f32 v25, v117
  v_exp_f32 v26, v118
  v_cvt_pk_bf16_f32 v194, v24, v25
  v_exp_f32 v27, v119
  v_mfma_f32_32x32x16_bf16 v[64:79], a[52:55], v[52:55], v[64:79]
  ds_read_b128 a[20:23], v21 offset:16384
  v_exp_f32 v24, v120
  v_cvt_pk_bf16_f32 v195, v26, v27
  v_exp_f32 v25, v121
  v_exp_f32 v26, v122
  v_mfma_f32_32x32x16_bf16 v[64:79], a[56:59], v[56:59], v[64:79]
  ds_read_b128 a[24:27], v22 offset:16384
  v_cvt_pk_bf16_f32 v196, v24, v25
  v_exp_f32 v27, v123
  v_exp_f32 v24, v124
  v_mfma_f32_32x32x16_bf16 v[64:79], a[60:63], v[60:63], v[64:79]
  ds_read_b128 a[28:31], v23 offset:16384
  v_cvt_pk_bf16_f32 v197, v26, v27
  v_exp_f32 v25, v125
  v_exp_f32 v26, v126
  s_waitcnt lgkmcnt(4)
  v_mfma_f32_32x32x16_bf16 v[80:95], a[0:3], v[32:35], v[96:111]
  ds_read_b128 a[32:35], v16 offset:24576
  v_cvt_pk_bf16_f32 v198, v24, v25
  v_exp_f32 v27, v127
  v_or3_b32 v15, v192, v193, v194
  v_cvt_pk_bf16_f32 v199, v26, v27
  v_mfma_f32_32x32x16_bf16 v[80:95], a[4:7], v[36:39], v[80:95]
  ds_read_b128 a[36:39], v17 offset:24576
  buffer_load_dwordx4 v8, s[16:19], s59 offen offset:2048 nt lds
  v_or3_b32 v15, v15, v195, v196
  v_or3_b32 v15, v15, v197, v198
  v_bitop3_b32 v15, v15, v199, s67 bitop3:0xa8
  v_cmp_ne_u32 vcc, 0, v15
  v_mfma_f32_32x32x16_bf16 v[80:95], a[8:11], v[40:43], v[80:95]
  s_cbranch_vccnz L_rarev0_8
L_backv0_8:
  ds_read_b128 a[40:43], v18 offset:24576
  v_exp_f32 v24, v64
  v_exp_f32 v25, v65
  v_exp_f32 v26, v66
  v_mfma_f32_32x32x16_bf16 v[80:95], a[12:15], v[44:47], v[80:95]
  ds_read_b128 a[44:47], v19 offset:24576
  buffer_load_dwordx4 v9, s[16:19], s59 offen offset:3072 nt lds
  v_cvt_pk_bf16_f32 v200, v24, v25
  v_exp_f32 v27, v67
  v_exp_f32 v24, v68
  v_cvt_pk_bf16_f32 v201, v26, v27
  s_waitcnt lgkmcnt(4)
  v_mfma_f32_32x32x16_bf16 v[80:95], a[16:19], v[48:51], v[80:95]
  ds_read_b128 a[48:51], v20 offset:24576
  v_exp_f32 v25, v69
  v_exp_f32 v26, v70
  v_cvt_pk_bf16_f32 v202, v24, v25
  v_exp_f32 v27, v71
  v_mfma_f32_32x32x16_bf16 v[80:95], a[20:23], v[52:55], v[80:95]
  ds_read_b128 a[52:55], v21 offset:24576
  v_exp_f32 v24, v72
  v_cvt_pk_bf16_f32 v203, v26, v27
  v_exp_f32 v25, v73
  v_exp_f32 v26, v74
  v_mfma_f32_32x32x16_bf16 v[80:95], a[24:27], v[56:59], v[80:95]
  ds_read_b128 a[56:59], v22 offset:24576
  v_cvt_pk_bf16_f32 v204, v24, v25
  v_exp_f32 v27, v75
  v_exp_f32 v24, v76
  v_mfma_f32_32x32x16_bf16 v[80:95], a[28:31], v[60:63], v[80:95]
  ds_read_b128 a[60:63], v23 offset:24576
  v_cvt_pk_bf16_f32 v205, v26, v27
  v_exp_f32 v25, v77
  v_exp_f32 v26, v78
  s_waitcnt lgkmcnt(4)
  v_mfma_f32_32x32x16_bf16 v[112:127], a[32:35], v[32:35], v[96:111]
  v_add_u32 v16, 131072, v16
  v_add_u32 v17, 131072, v17
  v_cvt_pk_bf16_f32 v206, v24, v25
  v_exp_f32 v27, v79
  v_or3_b32 v15, v200, v201, v202
  v_cvt_pk_bf16_f32 v207, v26, v27
  v_mfma_f32_32x32x16_bf16 v[112:127], a[36:39], v[36:39], v[112:127]
  v_add_u32 v18, 131072, v18
  v_add_u32 v19, 131072, v19
  s_add_u32 m0, s38, 49152
  s_add_u32 s59, s97, 32896
  s_and_b32 s59, s59, 0x1ffff
  s_lshl1_add_u32 s59, s38, s59
  buffer_load_dwordx4 v6, s[16:19], s59 offen offset:0 nt lds
  v_or3_b32 v15, v15, v203, v204
  v_or3_b32 v15, v15, v205, v206
  v_bitop3_b32 v15, v15, v207, s67 bitop3:0xa8
  v_cmp_ne_u32 vcc, 0, v15
  v_mfma_f32_32x32x16_bf16 v[112:127], a[40:43], v[40:43], v[112:127]
  s_cbranch_vccnz L_rarev0_9
L_backv0_9:
  v_add_u32 v20, 131072, v20
  v_add_u32 v21, 131072, v21
  v_exp_f32 v24, v80
  v_exp_f32 v25, v81
  v_exp_f32 v26, v82
  v_mfma_f32_32x32x16_bf16 v[112:127], a[44:47], v[44:47], v[112:127]
  v_add_u32 v22, 131072, v22
  v_add_u32 v23, 131072, v23
  buffer_load_dwordx4 v7, s[16:19], s59 offen offset:1024 nt lds
  v_cvt_pk_bf16_f32 v208, v24, v25
  v_exp_f32 v27, v83
  v_exp_f32 v24, v84
  v_cvt_pk_bf16_f32 v209, v26, v27
  s_waitcnt lgkmcnt(0)
  v_mfma_f32_32x32x16_bf16 v[112:127], a[48:51], v[48:51], v[112:127]
  ds_read_b128 a[0:3], v16 offset:0
  ds_read_b128 a[4:7], v17 offset:0
  v_exp_f32 v25, v85
  v_exp_f32 v26, v86
  v_cvt_pk_bf16_f32 v210, v24, v25
  v_exp_f32 v27, v87
  v_mfma_f32_32x32x16_bf16 v[112:127], a[52:55], v[52:55], v[112:127]
  ds_read_b128 a[8:11], v18 offset:0
  ds_read_b128 a[12:15], v19 offset:0
  v_exp_f32 v24, v88
  v_cvt_pk_bf16_f32 v211, v26, v27
  v_exp_f32 v25, v89
  v_exp_f32 v26, v90
  v_mfma_f32_32x32x16_bf16 v[112:127], a[56:59], v[56:59], v[112:127]
  ds_read_b128 a[16:19], v20 offset:0
  ds_read_b128 a[20:23], v21 offset:0
  v_cvt_pk_bf16_f32 v212, v24, v25
  v_exp_f32 v27, v91
  v_exp_f32 v24, v92
  v_mfma_f32_32x32x16_bf16 v[112:127], a[60:63], v[60:63], v[112:127]
  ds_read_b128 a[24:27], v22 offset:0
  ds_read_b128 a[28:31], v23 offset:0
  v_cvt_pk_bf16_f32 v213, v26, v27
  v_exp_f32 v25, v93
  v_exp_f32 v26, v94
  s_waitcnt lgkmcnt(4)
  v_mfma_f32_32x32x16_bf16 v[64:79], a[0:3], v[32:35], v[96:111]
  ds_read_b128 a[32:35], v16 offset:8192
  v_cvt_pk_bf16_f32 v214, v24, v25
  v_exp_f32 v27, v95
  v_or3_b32 v15, v208, v209, v210
  v_cvt_pk_bf16_f32 v215, v26, v27
  v_mfma_f32_32x32x16_bf16 v[64:79], a[4:7], v[36:39], v[64:79]
  ds_read_b128 a[36:39], v17 offset:8192
  buffer_load_dwordx4 v8, s[16:19], s59 offen offset:2048 nt lds
  v_or3_b32 v15, v15, v211, v212
  v_or3_b32 v15, v15, v213, v214
  v_bitop3_b32 v15, v15, v215, s67 bitop3:0xa8
  v_cmp_ne_u32 vcc, 0, v15
  v_mfma_f32_32x32x16_bf16 v[64:79], a[8:11], v[40:43], v[64:79]
  s_cbranch_vccnz L_rarev0_10
L_backv0_10:
  ds_read_b128 a[40:43], v18 offset:8192
  v_exp_f32 v24, v112
  v_exp_f32 v25, v113
  v_exp_f32 v26, v114
  v_mfma_f32_32x32x16_bf16 v[64:79], a[12:15], v[44:47], v[64:79]
  ds_read_b128 a[44:47], v19 offset:8192
  buffer_load_dwordx4 v9, s[16:19], s59 offen offset:3072 nt lds
  v_cvt_pk_bf16_f32 v216, v24, v25
  v_exp_f32 v27, v115
  v_exp_f32 v24, v116
  v_cvt_pk_bf16_f32 v217, v26, v27
  s_waitcnt lgkmcnt(4)
  v_mfma_f32_32x32x16_bf16 v[64:79], a[16:19], v[48:51], v[64:79]
  ds_read_b128 a[48:51], v20 offset:8192
  v_exp_f32 v25, v117
  v_exp_f32 v26, v118
  v_cvt_pk_bf16_f32 v218, v24, v25
  v_exp_f32 v27, v119
  v_mfma_f32_32x32x16_bf16 v[64:79], a[20:23], v[52:55], v[64:79]
  ds_read_b128 a[52:55], v21 offset:8192
  v_exp_f32 v24, v120
  v_cvt_pk_bf16_f32 v219, v26, v27
  v_exp_f32 v25, v121
  v_exp_f32 v26, v122
  v_mfma_f32_32x32x16_bf16 v[64:79], a[24:27], v[56:59], v[64:79]
  ds_read_b128 a[56:59], v22 offset:8192
  v_cvt_pk_bf16_f32 v220, v24, v25
  v_exp_f32 v27, v123
  v_exp_f32 v24, v124
  v_mfma_f32_32x32x16_bf16 v[64:79], a[28:31], v[60:63], v[64:79]
  ds_read_b128 a[60:63], v23 offset:8192
  v_cvt_pk_bf16_f32 v221, v26, v27
  v_exp_f32 v25, v125
  v_exp_f32 v26, v126
  s_waitcnt vmcnt(24)
  s_barrier
  s_waitcnt lgkmcnt(4)
  v_mfma_f32_32x32x16_bf16 v[80:95], a[32:35], v[32:35], v[96:111]
  ds_read_b128 a[0:3], v16 offset:16384
  v_cvt_pk_bf16_f32 v222, v24, v25
  v_exp_f32 v27, v127
  v_or3_b32 v15, v216, v217, v218
  v_cvt_pk_bf16_f32 v223, v26, v27
  v_mfma_f32_32x32x16_bf16 v[80:95], a[36:39], v[36:39], v[80:95]
  ds_read_b128 a[4:7], v17 offset:16384
  s_mul_i32 s59, s6, 81920
  s_lshl_b32 s60, s39, 2
  s_add_u32 s59, s59, s60
  buffer_load_dwordx4 a[208:211], v10, s[24:27], s59 offen offset:0
  v_or3_b32 v15, v15, v219, v220
  v_or3_b32 v15, v15, v221, v222
  v_bitop3_b32 v15, v15, v223, s67 bitop3:0xa8
  v_cmp_ne_u32 vcc, 0, v15
  v_mfma_f32_32x32x16_bf16 v[80:95], a[40:43], v[40:43], v[80:95]
  s_cbranch_vccnz L_rarev0_11
L_backv0_11:
  ds_read_b128 a[8:11], v18 offset:16384
  v_exp_f32 v24, v64
  v_exp_f32 v25, v65
  v_exp_f32 v26, v66
  v_mfma_f32_32x32x16_bf16 v[80:95], a[44:47], v[44:47], v[80:95]
  ds_read_b128 a[12:15], v19 offset:16384
  buffer_load_dwordx4 a[212:215], v11, s[24:27], s59 offen offset:1024
  v_cvt_pk_bf16_f32 v224, v24, v25
  v_exp_f32 v27, v67
  v_exp_f32 v24, v68
  v_cvt_pk_bf16_f32 v225, v26, v27
  s_waitcnt lgkmcnt(4)
  v_mfma_f32_32x32x16_bf16 v[80:95], a[48:51], v[48:51], v[80:95]
  ds_read_b128 a[16:19], v20 offset:16384
  v_exp_f32 v25, v69
  v_exp_f32 v26, v70
  v_cvt_pk_bf16_f32 v226, v24, v25
  v_exp_f32 v27, v71
  v_mfma_f32_32x32x16_bf16 v[80:95], a[52:55], v[52:55], v[80:95]
  ds_read_b128 a[20:23], v21 offset:16384
  v_exp_f32 v24, v72
  v_cvt_pk_bf16_f32 v227, v26, v27
  v_exp_f32 v25, v73
  v_exp_f32 v26, v74
  v_mfma_f32_32x32x16_bf16 v[80:95], a[56:59], v[56:59], v[80:95]
  ds_read_b128 a[24:27], v22 offset:16384
  v_cvt_pk_bf16_f32 v228, v24, v25
  v_exp_f32 v27, v75
  v_exp_f32 v24, v76
  v_mfma_f32_32x32x16_bf16 v[80:95], a[60:63], v[60:63], v[80:95]
  ds_read_b128 a[28:31], v23 offset:16384
  v_cvt_pk_bf16_f32 v229, v26, v27
  v_exp_f32 v25, v77
  v_exp_f32 v26, v78
  s_waitcnt lgkmcnt(4)
  v_mfma_f32_32x32x16_bf16 v[112:127], a[0:3], v[32:35], v[96:111]
  ds_read_b128 a[32:35], v16 offset:24576
  v_cvt_pk_bf16_f32 v230, v24, v25
  v_exp_f32 v27, v79
  v_or3_b32 v15, v224, v225, v226
  v_cvt_pk_bf16_f32 v231, v26, v27
  v_mfma_f32_32x32x16_bf16 v[112:127], a[4:7], v[36:39], v[112:127]
  ds_read_b128 a[36:39], v17 offset:24576
  buffer_load_dwordx4 a[216:219], v12, s[24:27], s59 offen offset:2048
  v_or3_b32 v15, v15, v227, v228
  v_or3_b32 v15, v15, v229, v230
  v_bitop3_b32 v15, v15, v231, s67 bitop3:0xa8
  v_cmp_ne_u32 vcc, 0, v15
  v_mfma_f32_32x32x16_bf16 v[112:127], a[8:11], v[40:43], v[112:127]
  s_cbranch_vccnz L_rarev0_12
L_backv0_12:
  ds_read_b128 a[40:43], v18 offset:24576
  v_exp_f32 v24, v80
  v_exp_f32 v25, v81
  v_exp_f32 v26, v82
  v_mfma_f32_32x32x16_bf16 v[112:127], a[12:15], v[44:47], v[112:127]
  ds_read_b128 a[44:47], v19 offset:24576
  buffer_load_dwordx4 a[220:223], v13, s[24:27], s59 offen offset:3072
  v_cvt_pk_bf16_f32 v232, v24, v25
  v_exp_f32 v27, v83
  v_exp_f32 v24, v84
  v_cvt_pk_bf16_f32 v233, v26, v27
  s_waitcnt lgkmcnt(4)
  v_mfma_f32_32x32x16_bf16 v[112:127], a[16:19], v[48:51], v[112:127]
  ds_read_b128 a[48:51], v20 offset:24576
  v_exp_f32 v25, v85
  v_exp_f32 v26, v86
  v_cvt_pk_bf16_f32 v234, v24, v25
  v_exp_f32 v27, v87
  v_mfma_f32_32x32x16_bf16 v[112:127], a[20:23], v[52:55], v[112:127]
  ds_read_b128 a[52:55], v21 offset:24576
  v_exp_f32 v24, v88
  v_cvt_pk_bf16_f32 v235, v26, v27
  v_exp_f32 v25, v89
  v_exp_f32 v26, v90
  v_mfma_f32_32x32x16_bf16 v[112:127], a[24:27], v[56:59], v[112:127]
  ds_read_b128 a[56:59], v22 offset:24576
  v_cvt_pk_bf16_f32 v236, v24, v25
  v_exp_f32 v27, v91
  v_exp_f32 v24, v92
  v_mfma_f32_32x32x16_bf16 v[112:127], a[28:31], v[60:63], v[112:127]
  ds_read_b128 a[60:63], v23 offset:24576
  v_cvt_pk_bf16_f32 v237, v26, v27
  v_exp_f32 v25, v93
  v_exp_f32 v26, v94
  s_waitcnt lgkmcnt(4)
  v_mfma_f32_32x32x16_bf16 v[64:79], a[32:35], v[32:35], v[96:111]
  v_cvt_pk_bf16_f32 v238, v24, v25
  v_exp_f32 v27, v95
  v_or3_b32 v15, v232, v233, v234
  v_cvt_pk_bf16_f32 v239, v26, v27
  v_mfma_f32_32x32x16_bf16 v[64:79], a[36:39], v[36:39], v[64:79]
  buffer_load_dwordx4 a[224:227], v14, s[24:27], s59 offen offset:0
  v_or3_b32 v15, v15, v235, v236
  v_or3_b32 v15, v15, v237, v238
  v_bitop3_b32 v15, v15, v239, s67 bitop3:0xa8
  v_cmp_ne_u32 vcc, 0, v15
  s_nop 7
  v_mfma_f32_32x32x16_bf16 v[64:79], a[40:43], v[40:43], v[64:79]
  s_cbranch_vccnz L_rarev0_13
L_backv0_13:
  v_exp_f32 v24, v112
  v_exp_f32 v25, v113
  v_exp_f32 v26, v114
  v_cvt_pk_bf16_f32 v240, v24, v25
  v_exp_f32 v27, v115
  v_mfma_f32_32x32x16_bf16 v[64:79], a[44:47], v[44:47], v[64:79]
  v_exp_f32 v24, v116
  v_cvt_pk_bf16_f32 v241, v26, v27
  v_exp_f32 v25, v117
  v_exp_f32 v26, v118
  v_cvt_pk_bf16_f32 v242, v24, v25
  s_waitcnt lgkmcnt(0)
  v_mfma_f32_32x32x16_bf16 v[64:79], a[48:51], v[48:51], v[64:79]
  v_exp_f32 v27, v119
  v_exp_f32 v24, v120
  v_cvt_pk_bf16_f32 v243, v26, v27
  v_exp_f32 v25, v121
  v_exp_f32 v26, v122
  v_mfma_f32_32x32x16_bf16 v[64:79], a[52:55], v[52:55], v[64:79]
  v_cvt_pk_bf16_f32 v244, v24, v25
  v_exp_f32 v27, v123
  v_exp_f32 v24, v124
  v_cvt_pk_bf16_f32 v245, v26, v27
  v_exp_f32 v25, v125
  v_mfma_f32_32x32x16_bf16 v[64:79], a[56:59], v[56:59], v[64:79]
  v_exp_f32 v26, v126
  v_cvt_pk_bf16_f32 v246, v24, v25
  v_exp_f32 v27, v127
  v_or3_b32 v15, v240, v241, v242
  v_mfma_f32_32x32x16_bf16 v[64:79], a[60:63], v[60:63], v[64:79]
  v_cvt_pk_bf16_f32 v247, v26, v27
  v_or3_b32 v15, v15, v243, v244
  v_or3_b32 v15, v15, v245, v246
  v_bitop3_b32 v15, v15, v247, s67 bitop3:0xa8
  v_cmp_ne_u32 vcc, 0, v15
  s_cbranch_vccnz L_rarev0_14
L_backv0_14:
  v_accvgpr_read_b32 v16, a240
  v_accvgpr_read_b32 v17, a241
  v_accvgpr_read_b32 v22, a242
  v_accvgpr_read_b32 v23, a243
  v_accvgpr_read_b32 v18, a244
  v_accvgpr_read_b32 v19, a245
  v_accvgpr_read_b32 v20, a246
  v_accvgpr_read_b32 v125, a247
  v_accvgpr_read_b32 v116, a248
  v_accvgpr_read_b32 v117, a249
  v_accvgpr_read_b32 v118, a250
  v_accvgpr_read_b32 v119, a251
  v_accvgpr_read_b32 v120, a252
  v_accvgpr_read_b32 v121, a253
  v_accvgpr_read_b32 v122, a254
  v_accvgpr_read_b32 v123, a255
  s_branch L_conv
L_var1:
  s_add_u32 m0, s38, 98304
  s_nop 0
  buffer_load_dwordx4 v192, s[8:11], s57 offen offset:0 lds
  buffer_load_dwordx4 v193, s[8:11], s57 offen offset:1024 lds
  buffer_load_dwordx4 v194, s[8:11], s57 offen offset:2048 lds
  buffer_load_dwordx4 v195, s[8:11], s57 offen offset:3072 lds
  s_add_u32 m0, s38, 114688
  s_nop 0
  buffer_load_dwordx4 v196, s[20:23], s58 offen offset:0 lds
  buffer_load_dwordx4 v197, s[20:23], s58 offen offset:1024 lds
  buffer_load_dwordx4 v198, s[20:23], s58 offen offset:2048 lds
  buffer_load_dwordx4 v199, s[20:23], s58 offen offset:3072 lds
  s_add_u32 s56, s56, 1
  s_cmp_eq_u32 s56, 10
  s_cselect_b32 s56, 0, s56
  s_lshl_b32 s57, s56, 7
  s_add_u32 s57, s57, s61
  s_lshl_b32 s58, s56, 19
  s_add_u32 s58, s58, s62
  s_lshl_b32 s59, s36, 17
  s_add_u32 s12, s42, s59
  s_addc_u32 s13, s43, 0
  s_mov_b32 s14, 131072
  s_mov_b32 s15, 0x20000
  s_add_u32 s16, s44, s59
  s_addc_u32 s17, s45, 0
  s_mov_b32 s18, 131072
  s_mov_b32 s19, 0x20000
  s_mul_i32 s59, s4, 655360
  s_mul_i32 s60, s5, 320
  s_add_u32 s59, s59, s60
  s_add_u32 s24, s48, s59
  s_addc_u32 s25, s49, 0
  s_sub_u32 s26, 5242880, s59
  s_mov_b32 s27, 0x20000
  s_mov_b32 s28, s50
  s_mov_b32 s29, s51
  s_mov_b32 s30, 1310720
  s_mov_b32 s31, 0x20000
  s_mov_b32 s32, s54
  s_mov_b32 s33, s55
  s_mov_b32 s34, 0x10000000
  s_mov_b32 s35, 0x20000
  s_lshl_b32 s59, s6, 7
  s_load_dword s37, s[54:55], s59
  s_mov_b64 exec, 0xffff
  s_mov_b32 s59, 40960
  v_mul_u32_u24 v30, s59, v0
  buffer_load_dword v217, v30, s[24:27], 0 offen
  v_lshlrev_b32 v30, 13, v0
  s_mov_b64 exec, 0xffffffff
  s_mul_i32 s59, s5, 5
  s_lshr_b32 s59, s59, 1
  s_lshr_b32 s60, s6, 2
  s_mul_i32 s60, s60, 5
  s_add_u32 s59, s59, s60
  s_add_u32 s59, s59, 4
  s_cmp_ge_u32 s59, 10
  s_cselect_b32 s60, 10, 0
  s_sub_u32 s59, s59, s60
  s_lshl_b32 s59, s59, 6
  s_and_b32 s60, s6, 3
  s_lshl_b32 s60, s60, 4
  s_add_u32 s59, s59, s60
  s_lshl_b32 s59, s59, 13
  s_cmp_eq_u32 s3, 1
  s_cselect_b32 s59, s59, s22
  v_lshrrev_b32 v30, 1, v0
  v_lshlrev_b32 v30, 13, v30
  v_and_b32 v31, 1, v0
  v_lshl_add_u32 v30, v31, 7, v30
  buffer_load_dword v217, v30, s[20:23], s59 offen
  s_mov_b64 exec, -1
  v_add_u32 v30, 0, v25
  v_xor_b32 v30, v27, v30
  v_lshlrev_b32 v30, 4, v30
  v_lshl_add_u32 v2, v25, 8, v30
  v_add_u32 v30, 4, v25
  v_xor_b32 v30, v27, v30
  v_lshlrev_b32 v30, 4, v30
  v_lshl_add_u32 v3, v25, 8, v30
  v_add_u32 v30, 8, v25
  v_xor_b32 v30, v27, v30
  v_lshlrev_b32 v30, 4, v30
  v_lshl_add_u32 v4, v25, 8, v30
  v_add_u32 v30, 12, v25
  v_xor_b32 v30, v27, v30
  v_lshlrev_b32 v30, 4, v30
  v_lshl_add_u32 v5, v25, 8, v30
  v_and_b32 v30, 1, v25
  v_lshlrev_b32 v30, 2, v30
  v_xor_b32 v30, v26, v30
  v_lshlrev_b32 v30, 4, v30
  v_lshl_add_u32 v30, v24, 8, v30
  v_add_u32 v6, 0, v30
  v_add_u32 v7, 1024, v30
  v_add_u32 v8, 2048, v30
  v_add_u32 v9, 3072, v30
  s_movk_i32 s59, 3277
  s_movk_i32 s60, 1280
  v_add_u32 v30, 0, v0
  v_mul_u32_u24 v31, s59, v30
  v_lshrrev_b32 v31, 16, v31
  v_mul_u32_u24 v23, 20, v31
  v_sub_u32 v30, v30, v23
  v_lshlrev_b32 v30, 4, v30
  v_mad_u32_u24 v30, v31, s60, v30
  v_subrev_u32 v10, 0, v30
  v_add_u32 v30, 64, v0
  v_mul_u32_u24 v31, s59, v30
  v_lshrrev_b32 v31, 16, v31
  v_mul_u32_u24 v23, 20, v31
  v_sub_u32 v30, v30, v23
  v_lshlrev_b32 v30, 4, v30
  v_mad_u32_u24 v30, v31, s60, v30
  v_subrev_u32 v11, 1024, v30
  v_add_u32 v30, 128, v0
  v_mul_u32_u24 v31, s59, v30
  v_lshrrev_b32 v31, 16, v31
  v_mul_u32_u24 v23, 20, v31
  v_sub_u32 v30, v30, v23
  v_lshlrev_b32 v30, 4, v30
  v_mad_u32_u24 v30, v31, s60, v30
  v_subrev_u32 v12, 2048, v30
  v_add_u32 v30, 192, v0
  v_mul_u32_u24 v31, s59, v30
  v_lshrrev_b32 v31, 16, v31
  v_mul_u32_u24 v23, 20, v31
  v_sub_u32 v30, v30, v23
  v_lshlrev_b32 v30, 4, v30
  v_mad_u32_u24 v30, v31, s60, v30
  v_subrev_u32 v13, 3072, v30
  v_add_u32 v30, 256, v0
  v_mul_u32_u24 v31, s59, v30
  v_lshrrev_b32 v31, 16, v31
  v_mul_u32_u24 v23, 20, v31
  v_sub_u32 v30, v30, v23
  v_lshlrev_b32 v30, 4, v30
  v_mad_u32_u24 v30, v31, s60, v30
  v_subrev_u32 v14, 0, v30
  v_lshrrev_b32 v30, 1, v29
  v_and_b32 v30, 7, v30
  v_xor_b32 v30, v28, v30
  v_lshlrev_b32 v30, 4, v30
  v_lshl_add_u32 v30, v29, 7, v30
  v_add_u32 v30, s38, v30
  v_xor_b32 v208, 0, v30
  v_add_u32 v200, 98304, v208
  v_xor_b32 v209, 32, v30
  v_add_u32 v201, 98304, v209
  v_xor_b32 v210, 64, v30
  v_add_u32 v202, 98304, v210
  v_xor_b32 v211, 96, v30
  v_add_u32 v203, 98304, v211
  v_lshrrev_b32 v22, 2, v27
  v_and_b32 v23, 1, v25
  v_lshlrev_b32 v23, 5, v23
  v_and_b32 v30, 1, v27
  v_lshl_add_u32 v23, v30, 4, v23
  v_bfe_u32 v30, v27, 1, 1
  v_lshl_add_u32 v23, v30, 3, v23
  v_lshl_add_u32 v30, v28, 3, v22
  v_lshlrev_b32 v30, 8, v30
  v_add_u32 v30, v30, v23
  v_lshl_add_u32 v30, v22, 6, v30
  v_add_u32 v30, 16384, v30
  v_xor_b32 v212, 0, v30
  v_add_u32 v204, 98304, v212
  v_xor_b32 v213, 64, v30
  v_add_u32 v205, 98304, v213
  v_xor_b32 v214, 128, v30
  v_add_u32 v206, 98304, v214
  v_xor_b32 v215, 192, v30
  v_add_u32 v207, 98304, v215
  v_xor_b32 v30, v28, v27
  v_lshlrev_b32 v30, 4, v30
  v_lshl_add_u32 v30, v29, 8, v30
  v_add_u32 v30, 32768, v30
  v_xor_b32 v16, 0, v30
  v_xor_b32 v17, 32, v30
  v_xor_b32 v18, 64, v30
  v_xor_b32 v19, 96, v30
  v_xor_b32 v20, 128, v30
  v_xor_b32 v21, 160, v30
  v_xor_b32 v22, 192, v30
  v_xor_b32 v23, 224, v30
  v_and_b32 v27, 15, v0
  v_lshrrev_b32 v28, 5, v0
  v_lshrrev_b32 v24, 2, v27
  v_bfe_u32 v25, v0, 4, 1
  v_lshl_add_u32 v30, v28, 2, v24
  v_lshlrev_b32 v31, 5, v25
  v_and_b32 v29, 3, v27
  v_lshl_add_u32 v29, v29, 3, v31
  v_lshl_add_u32 v29, v30, 7, v29
  v_bfe_u32 v26, v27, 3, 1
  v_lshl_add_u32 v29, v26, 6, v29
  v_accvgpr_write_b32 a242, v29
  v_xor_b32 v26, 64, v29
  v_accvgpr_write_b32 a243, v26
  v_add_u32 v29, 65536, v29
  v_accvgpr_write_b32 a240, v29
  v_add_u32 v26, 65536, v26
  v_accvgpr_write_b32 a241, v26
  v_and_b32 v29, 1, v27
  v_lshl_add_u32 v31, v29, 4, v31
  v_bfe_u32 v29, v27, 1, 1
  v_lshl_add_u32 v31, v29, 3, v31
  s_movk_i32 s63, 320
  v_mad_u32_u24 v29, v30, s63, v31
  v_accvgpr_write_b32 a244, v29
  v_add_u32 v29, 65536, v29
  v_accvgpr_write_b32 a245, v29
  v_add_u32 v29, 65536, v29
  v_accvgpr_write_b32 a246, v29
  v_bfe_u32 v29, v0, 2, 1
  v_cmp_eq_u32 vcc, v29, v25
  v_mov_b32 v29, 0x3f803f80
  s_nop 0
  v_cndmask_b32 v29, 0, v29, vcc
  v_accvgpr_write_b32 a248, v29
  v_accvgpr_write_b32 a249, v29
  v_accvgpr_write_b32 a250, v29
  v_accvgpr_write_b32 a251, v29
  s_mov_b32 s50, 0xfffefffe
  s_mov_b32 s51, 0x00010001
  s_add_u32 s44, s5, 1
  s_and_b32 s44, s44, 3
  s_and_b32 s68, s36, 0xfc
  s_add_u32 s44, s44, s68
  s_lshl_b32 s44, s44, 2
  s_add_u32 s44, s44, s3
  s_mul_i32 s44, s44, 8448
  s_add_u32 s44, s44, 1048576
  s_add_u32 s47, s44, 4096
  s_add_u32 s45, s5, 2
  s_and_b32 s45, s45, 3
  s_and_b32 s68, s36, 0xfc
  s_add_u32 s45, s45, s68
  s_lshl_b32 s45, s45, 2
  s_add_u32 s45, s45, s3
  s_mul_i32 s45, s45, 8448
  s_add_u32 s45, s45, 1048576
  s_add_u32 s48, s45, 4096
  s_add_u32 s46, s5, 3
  s_and_b32 s46, s46, 3
  s_and_b32 s68, s36, 0xfc
  s_add_u32 s46, s46, s68
  s_lshl_b32 s46, s46, 2
  s_add_u32 s46, s46, s3
  s_mul_i32 s46, s46, 8448
  s_add_u32 s46, s46, 1048576
  s_add_u32 s49, s46, 4096
  v_and_b32 v29, 3, v0
  v_lshlrev_b32 v29, 4, v29
  v_add_u32 v29, 0, v29
  v_lshrrev_b32 v30, 2, v0
  v_mov_b32 v26, s46
  v_mov_b32 v31, s45
  v_cmp_eq_u32 vcc, 1, v30
  s_nop 1
  v_cndmask_b32 v26, v26, v31, vcc
  v_mov_b32 v31, s44
  v_cmp_eq_u32 vcc, 0, v30
  s_nop 1
  v_cndmask_b32 v26, v26, v31, vcc
  v_add_u32 v26, v26, v29
  v_accvgpr_write_b32 a247, v26
  s_movk_i32 s95, 4096
  s_mov_b32 s96, 0x7fff0000
  s_lshl_b32 s69, s36, 2
  s_add_u32 s69, s69, s3
  s_mul_i32 s69, s69, 8448
  s_add_u32 s69, s69, 1048576
  s_lshl_b32 s63, s6, 2
  s_add_u32 s63, s63, s5
  s_lshl_b32 s63, s63, 3
  s_lshl_b32 s40, s3, 1
  s_add_u32 s40, s40, s63
  s_mul_i32 s40, s40, 41216
  s_mul_i32 s41, s4, 5120
  s_add_u32 s40, s40, s41
  s_add_u32 s40, s40, 16777216
  s_add_u32 s41, s40, 41216
  s_add_u32 s42, s40, 4096
  s_add_u32 s43, s41, 4096
  s_add_u32 s52, s63, s4
  s_mul_i32 s52, s52, 41216
  s_add_u32 s52, s52, 16777216
  s_waitcnt lgkmcnt(0)
  s_add_u32 s37, s37, 1
  v_and_b32 v24, 31, v0
  v_lshrrev_b32 v25, 5, v0
  v_bfe_u32 v26, v0, 2, 1
  v_xor_b32 v26, v26, v25
  v_bfe_u32 v27, v0, 4, 1
  v_or_b32 v26, v26, v27
  v_bfe_u32 v27, v0, 3, 1
  v_bfe_u32 v28, v0, 1, 1
  v_lshl_add_u32 v27, v27, 1, v28
  v_lshl_add_u32 v27, v26, 2, v27
  v_and_b32 v28, 1, v0
  v_lshlrev_b32 v28, 4, v28
  v_mov_b32 v29, 0x3f80
  v_lshlrev_b32 v28, v28, v29
  v_cmp_eq_u32 vcc, 0, v27
  s_nop 1
  v_cndmask_b32 v29, 0, v28, vcc
  v_accvgpr_write_b32 a232, v29
  v_cmp_eq_u32 vcc, 1, v27
  s_nop 1
  v_cndmask_b32 v29, 0, v28, vcc
  v_accvgpr_write_b32 a233, v29
  v_cmp_eq_u32 vcc, 2, v27
  s_nop 1
  v_cndmask_b32 v29, 0, v28, vcc
  v_accvgpr_write_b32 a234, v29
  v_cmp_eq_u32 vcc, 3, v27
  s_nop 1
  v_cndmask_b32 v29, 0, v28, vcc
  v_accvgpr_write_b32 a235, v29
  s_lshr_b32 s63, s4, 1
  s_lshl_b32 s63, s63, 5
  s_lshl_b32 s68, s6, 7
  s_add_u32 s63, s63, s68
  v_add_u32 v24, s63, v24
  s_movk_i32 s68, 1280
  v_mul_lo_u32 v24, v24, s68
  v_lshl_add_u32 v24, v25, 4, v24
  s_mul_i32 s63, s5, 320
  s_and_b32 s68, s4, 1
  s_lshl_b32 s68, s68, 5
  s_add_u32 s63, s63, s68
  v_add_u32 v24, s63, v24
  v_accvgpr_write_b32 a236, v24
  v_lshrrev_b32 v26, 2, v0
  s_movk_i32 s68, 5120
  v_mul_u32_u24 v26, s68, v26
  v_and_b32 v27, 3, v0
  v_lshl_add_u32 v26, v27, 4, v26
  v_accvgpr_write_b32 a237, v26
  s_lshl_b32 s54, s3, 10
  s_add_u32 s54, s54, s52
  s_add_u32 s52, s52, 4096
  s_lshl_b32 s55, s3, 6
  s_and_b32 s63, s37, 63
  s_lshl_b32 s63, s63, 2
  s_or_b32 s63, s63, 1
  s_mul_i32 s63, s63, 0x101
  s_bfe_u32 s68, s37, 0x60006
  s_lshl_b32 s68, s68, 2
  s_or_b32 s68, s68, 2
  s_mul_i32 s68, s68, 0x1010000
  s_or_b32 s63, s63, s68
  v_and_b32 v29, 3, v0
  v_lshlrev_b32 v29, 2, v29
  v_lshrrev_b32 v29, v29, s63
  v_lshrrev_b32 v30, 0, v29
  v_and_b32 v30, s51, v30
  v_accvgpr_write_b32 a252, v30
  v_lshrrev_b32 v30, 1, v29
  v_and_b32 v30, s51, v30
  v_accvgpr_write_b32 a253, v30
  v_lshrrev_b32 v30, 2, v29
  v_and_b32 v30, s51, v30
  v_accvgpr_write_b32 a254, v30
  v_lshrrev_b32 v30, 3, v29
  v_and_b32 v30, s51, v30
  v_accvgpr_write_b32 a255, v30
  s_add_u32 m0, s38, 0
  s_nop 0
  buffer_load_dwordx4 v192, s[8:11], s57 offen offset:0 lds
  buffer_load_dwordx4 v193, s[8:11], s57 offen offset:1024 lds
  buffer_load_dwordx4 v194, s[8:11], s57 offen offset:2048 lds
  buffer_load_dwordx4 v195, s[8:11], s57 offen offset:3072 lds
  s_add_u32 m0, s38, 16384
  s_nop 0
  buffer_load_dwordx4 v196, s[20:23], s58 offen offset:0 lds
  buffer_load_dwordx4 v197, s[20:23], s58 offen offset:1024 lds
  buffer_load_dwordx4 v198, s[20:23], s58 offen offset:2048 lds
  buffer_load_dwordx4 v199, s[20:23], s58 offen offset:3072 lds
  s_add_u32 s56, s56, 1
  s_cmp_eq_u32 s56, 10
  s_cselect_b32 s56, 0, s56
  s_lshl_b32 s57, s56, 7
  s_add_u32 s57, s57, s61
  s_lshl_b32 s58, s56, 19
  s_add_u32 s58, s58, s62
  s_cmp_eq_u32 s3, 0
  s_cbranch_scc0 L_noorphv1_
  s_mul_i32 s59, s6, 5
  s_lshr_b32 s59, s59, 2
  s_lshr_b32 s60, s5, 1
  s_mul_i32 s60, s60, 5
  s_add_u32 s59, s59, s60
  s_add_u32 s59, s59, 4
  s_cmp_ge_u32 s59, 10
  s_cselect_b32 s60, 10, 0
  s_sub_u32 s59, s59, s60
  s_lshl_b32 s59, s59, 7
  s_and_b32 s60, s5, 1
  s_mul_i32 s60, s60, 81920
  s_add_u32 s59, s59, s60
  s_movk_i32 s60, 1280
  v_mul_u32_u24 v30, s60, v0
  buffer_load_dword v217, v30, s[8:11], s59 offen
  s_branch L_orphdv1_
L_noorphv1_:
  v_mov_b32 v30, 0
  buffer_load_dword v217, v30, s[8:11], s10 offen
L_orphdv1_:
  s_waitcnt vmcnt(11) lgkmcnt(0)
  s_barrier
  ds_read_b128 a[128:131], v200 offset:0
  ds_read_b64_tr_b16 a[0:1], v204 offset:0
  ds_read_b64_tr_b16 a[2:3], v204 offset:1024
  ds_read_b64_tr_b16 a[4:5], v205 offset:0
  ds_read_b64_tr_b16 a[6:7], v205 offset:1024
  ds_read_b64_tr_b16 a[8:9], v206 offset:0
  ds_read_b64_tr_b16 a[10:11], v206 offset:1024
  ds_read_b64_tr_b16 a[12:13], v207 offset:0
  ds_read_b64_tr_b16 a[14:15], v207 offset:1024
  ds_read_b128 a[132:135], v201 offset:0
  ds_read_b64_tr_b16 a[16:17], v204 offset:4096
  ds_read_b64_tr_b16 a[18:19], v204 offset:5120
  s_waitcnt lgkmcnt(7)
  v_mfma_f32_32x32x16_bf16 v[128:143], a[0:3], a[128:131], 0
  ds_read_b64_tr_b16 a[20:21], v205 offset:4096
  ds_read_b64_tr_b16 a[22:23], v205 offset:5120
  ds_read_b64_tr_b16 a[24:25], v206 offset:4096
  v_mfma_f32_32x32x16_bf16 v[144:159], a[4:7], a[128:131], 0
  ds_read_b64_tr_b16 a[26:27], v206 offset:5120
  ds_read_b64_tr_b16 a[28:29], v207 offset:4096
  ds_read_b64_tr_b16 a[30:31], v207 offset:5120
  s_add_u32 m0, s38, 131072
  s_nop 0
  buffer_load_dwordx4 v192, s[8:11], s57 offen offset:0 lds
  s_waitcnt lgkmcnt(9)
  v_mfma_f32_32x32x16_bf16 v[160:175], a[8:11], a[128:131], 0
  ds_read_b128 a[136:139], v202 offset:0
  ds_read_b64_tr_b16 a[32:33], v204 offset:8192
  ds_read_b64_tr_b16 a[34:35], v204 offset:9216
  buffer_load_dwordx4 v193, s[8:11], s57 offen offset:1024 lds
  v_mfma_f32_32x32x16_bf16 v[176:191], a[12:15], a[128:131], 0
  ds_read_b64_tr_b16 a[36:37], v205 offset:8192
  ds_read_b64_tr_b16 a[38:39], v205 offset:9216
  ds_read_b64_tr_b16 a[40:41], v206 offset:8192
  buffer_load_dwordx4 v194, s[8:11], s57 offen offset:2048 lds
  s_waitcnt lgkmcnt(10)
  v_mfma_f32_32x32x16_bf16 v[128:143], a[16:19], a[132:135], v[128:143]
  ds_read_b64_tr_b16 a[42:43], v206 offset:9216
  ds_read_b64_tr_b16 a[44:45], v207 offset:8192
  ds_read_b64_tr_b16 a[46:47], v207 offset:9216
  buffer_load_dwordx4 v195, s[8:11], s57 offen offset:3072 lds
  v_mfma_f32_32x32x16_bf16 v[144:159], a[20:23], a[132:135], v[144:159]
  ds_read_b128 a[140:143], v203 offset:0
  ds_read_b64_tr_b16 a[48:49], v204 offset:12288
  ds_read_b64_tr_b16 a[50:51], v204 offset:13312
  s_waitcnt lgkmcnt(12)
  v_mfma_f32_32x32x16_bf16 v[160:175], a[24:27], a[132:135], v[160:175]
  ds_read_b64_tr_b16 a[52:53], v205 offset:12288
  ds_read_b64_tr_b16 a[54:55], v205 offset:13312
  ds_read_b64_tr_b16 a[56:57], v206 offset:12288
  s_add_u32 m0, s38, 147456
  s_nop 0
  buffer_load_dwordx4 v196, s[20:23], s58 offen offset:0 lds
  v_mfma_f32_32x32x16_bf16 v[176:191], a[28:31], a[132:135], v[176:191]
  ds_read_b64_tr_b16 a[58:59], v206 offset:13312
  ds_read_b64_tr_b16 a[60:61], v207 offset:12288
  ds_read_b64_tr_b16 a[62:63], v207 offset:13312
  s_waitcnt lgkmcnt(13)
  v_mfma_f32_32x32x16_bf16 v[128:143], a[32:35], a[136:139], v[128:143]
  buffer_load_dwordx4 v197, s[20:23], s58 offen offset:1024 lds
  v_mfma_f32_32x32x16_bf16 v[144:159], a[36:39], a[136:139], v[144:159]
  buffer_load_dwordx4 v198, s[20:23], s58 offen offset:2048 lds
  s_waitcnt lgkmcnt(9)
  v_mfma_f32_32x32x16_bf16 v[160:175], a[40:43], a[136:139], v[160:175]
  buffer_load_dwordx4 v199, s[20:23], s58 offen offset:3072 lds
  v_mfma_f32_32x32x16_bf16 v[176:191], a[44:47], a[136:139], v[176:191]
  s_add_u32 s56, s56, 1
  s_cmp_eq_u32 s56, 10
  s_cselect_b32 s56, 0, s56
  s_lshl_b32 s57, s56, 7
  s_add_u32 s57, s57, s61
  s_lshl_b32 s58, s56, 19
  s_add_u32 s58, s58, s62
  s_waitcnt vmcnt(9) lgkmcnt(0)
  s_barrier
  v_mfma_f32_32x32x16_bf16 v[128:143], a[48:51], a[140:143], v[128:143]
  ds_read_b128 a[144:147], v208 offset:0
  ds_read_b64_tr_b16 a[64:65], v212 offset:0
  ds_read_b64_tr_b16 a[66:67], v212 offset:1024
  v_mfma_f32_32x32x16_bf16 v[144:159], a[52:55], a[140:143], v[144:159]
  ds_read_b64_tr_b16 a[68:69], v213 offset:0
  ds_read_b64_tr_b16 a[70:71], v213 offset:1024
  ds_read_b64_tr_b16 a[72:73], v214 offset:0
  s_add_u32 m0, s38, 98304
  s_nop 0
  buffer_load_dwordx4 v192, s[8:11], s57 offen offset:0 lds
  v_mfma_f32_32x32x16_bf16 v[160:175], a[56:59], a[140:143], v[160:175]
  ds_read_b64_tr_b16 a[74:75], v214 offset:1024
  ds_read_b64_tr_b16 a[76:77], v215 offset:0
  ds_read_b64_tr_b16 a[78:79], v215 offset:1024
  v_mfma_f32_32x32x16_bf16 v[176:191], a[60:63], a[140:143], v[176:191]
  ds_read_b128 a[148:151], v209 offset:0
  ds_read_b64_tr_b16 a[80:81], v212 offset:4096
  ds_read_b64_tr_b16 a[82:83], v212 offset:5120
  buffer_load_dwordx4 v193, s[8:11], s57 offen offset:1024 lds
  s_waitcnt lgkmcnt(7)
  v_mfma_f32_32x32x16_bf16 v[128:143], a[64:67], a[144:147], v[128:143]
  ds_read_b64_tr_b16 a[84:85], v213 offset:4096
  ds_read_b64_tr_b16 a[86:87], v213 offset:5120
  ds_read_b64_tr_b16 a[88:89], v214 offset:4096
  v_mfma_f32_32x32x16_bf16 v[144:159], a[68:71], a[144:147], v[144:159]
  ds_read_b64_tr_b16 a[90:91], v214 offset:5120
  ds_read_b64_tr_b16 a[92:93], v215 offset:4096
  ds_read_b64_tr_b16 a[94:95], v215 offset:5120
  buffer_load_dwordx4 v194, s[8:11], s57 offen offset:2048 lds
  s_waitcnt lgkmcnt(9)
  v_mfma_f32_32x32x16_bf16 v[160:175], a[72:75], a[144:147], v[160:175]
  ds_read_b128 a[152:155], v210 offset:0
  ds_read_b64_tr_b16 a[96:97], v212 offset:8192
  ds_read_b64_tr_b16 a[98:99], v212 offset:9216
  v_mfma_f32_32x32x16_bf16 v[176:191], a[76:79], a[144:147], v[176:191]
  ds_read_b64_tr_b16 a[100:101], v213 offset:8192
  ds_read_b64_tr_b16 a[102:103], v213 offset:9216
  ds_read_b64_tr_b16 a[104:105], v214 offset:8192
  buffer_load_dwordx4 v195, s[8:11], s57 offen offset:3072 lds
  s_waitcnt lgkmcnt(10)
  v_mfma_f32_32x32x16_bf16 v[128:143], a[80:83], a[148:151], v[128:143]
  ds_read_b64_tr_b16 a[106:107], v214 offset:9216
  ds_read_b64_tr_b16 a[108:109], v215 offset:8192
  ds_read_b64_tr_b16 a[110:111], v215 offset:9216
  v_mfma_f32_32x32x16_bf16 v[144:159], a[84:87], a[148:151], v[144:159]
  ds_read_b128 a[156:159], v211 offset:0
  ds_read_b64_tr_b16 a[112:113], v212 offset:12288
  ds_read_b64_tr_b16 a[114:115], v212 offset:13312
  s_add_u32 m0, s38, 114688
  s_nop 0
  buffer_load_dwordx4 v196, s[20:23], s58 offen offset:0 lds
  s_waitcnt lgkmcnt(12)
  v_mfma_f32_32x32x16_bf16 v[160:175], a[88:91], a[148:151], v[160:175]
  ds_read_b64_tr_b16 a[116:117], v213 offset:12288
  ds_read_b64_tr_b16 a[118:119], v213 offset:13312
  ds_read_b64_tr_b16 a[120:121], v214 offset:12288
  v_mfma_f32_32x32x16_bf16 v[176:191], a[92:95], a[148:151], v[176:191]
  ds_read_b64_tr_b16 a[122:123], v214 offset:13312
  ds_read_b64_tr_b16 a[124:125], v215 offset:12288
  ds_read_b64_tr_b16 a[126:127], v215 offset:13312
  buffer_load_dwordx4 v197, s[20:23], s58 offen offset:1024 lds
  s_waitcnt lgkmcnt(13)
  v_mfma_f32_32x32x16_bf16 v[128:143], a[96:99], a[152:155], v[128:143]
  v_mfma_f32_32x32x16_bf16 v[144:159], a[100:103], a[152:155], v[144:159]
  buffer_load_dwordx4 v198, s[20:23], s58 offen offset:2048 lds
  s_waitcnt lgkmcnt(9)
  v_mfma_f32_32x32x16_bf16 v[160:175], a[104:107], a[152:155], v[160:175]
  buffer_load_dwordx4 v199, s[20:23], s58 offen offset:3072 lds
  v_mfma_f32_32x32x16_bf16 v[176:191], a[108:111], a[152:155], v[176:191]
  s_add_u32 s56, s56, 1
  s_cmp_eq_u32 s56, 10
  s_cselect_b32 s56, 0, s56
  s_lshl_b32 s57, s56, 7
  s_add_u32 s57, s57, s61
  s_lshl_b32 s58, s56, 19
  s_add_u32 s58, s58, s62
  s_waitcnt vmcnt(8) lgkmcnt(0)
  s_barrier
  v_mfma_f32_32x32x16_bf16 v[128:143], a[112:115], a[156:159], v[128:143]
  ds_read_b128 a[128:131], v200 offset:32768
  ds_read_b64_tr_b16 a[0:1], v204 offset:32768
  ds_read_b64_tr_b16 a[2:3], v204 offset:33792
  v_mfma_f32_32x32x16_bf16 v[144:159], a[116:119], a[156:159], v[144:159]
  ds_read_b64_tr_b16 a[4:5], v205 offset:32768
  ds_read_b64_tr_b16 a[6:7], v205 offset:33792
  ds_read_b64_tr_b16 a[8:9], v206 offset:32768
  s_add_u32 m0, s38, 0
  s_nop 0
  buffer_load_dwordx4 v192, s[8:11], s57 offen offset:0 lds
  v_mfma_f32_32x32x16_bf16 v[160:175], a[120:123], a[156:159], v[160:175]
  ds_read_b64_tr_b16 a[10:11], v206 offset:33792
  ds_read_b64_tr_b16 a[12:13], v207 offset:32768
  ds_read_b64_tr_b16 a[14:15], v207 offset:33792
  v_mfma_f32_32x32x16_bf16 v[176:191], a[124:127], a[156:159], v[176:191]
  ds_read_b128 a[132:135], v201 offset:32768
  ds_read_b64_tr_b16 a[16:17], v204 offset:36864
  ds_read_b64_tr_b16 a[18:19], v204 offset:37888
  buffer_load_dwordx4 v193, s[8:11], s57 offen offset:1024 lds
  s_waitcnt lgkmcnt(7)
  v_mfma_f32_32x32x16_bf16 v[128:143], a[0:3], a[128:131], v[128:143]
  ds_read_b64_tr_b16 a[20:21], v205 offset:36864
  ds_read_b64_tr_b16 a[22:23], v205 offset:37888
  ds_read_b64_tr_b16 a[24:25], v206 offset:36864
  v_mfma_f32_32x32x16_bf16 v[144:159], a[4:7], a[128:131], v[144:159]
  ds_read_b64_tr_b16 a[26:27], v206 offset:37888
  ds_read_b64_tr_b16 a[28:29], v207 offset:36864
  ds_read_b64_tr_b16 a[30:31], v207 offset:37888
  buffer_load_dwordx4 v194, s[8:11], s57 offen offset:2048 lds
  s_waitcnt lgkmcnt(9)
  v_mfma_f32_32x32x16_bf16 v[160:175], a[8:11], a[128:131], v[160:175]
  ds_read_b128 a[136:139], v202 offset:32768
  ds_read_b64_tr_b16 a[32:33], v204 offset:40960
  ds_read_b64_tr_b16 a[34:35], v204 offset:41984
  v_mfma_f32_32x32x16_bf16 v[176:191], a[12:15], a[128:131], v[176:191]
  ds_read_b64_tr_b16 a[36:37], v205 offset:40960
  ds_read_b64_tr_b16 a[38:39], v205 offset:41984
  ds_read_b64_tr_b16 a[40:41], v206 offset:40960
  buffer_load_dwordx4 v195, s[8:11], s57 offen offset:3072 lds
  s_waitcnt lgkmcnt(10)
  v_mfma_f32_32x32x16_bf16 v[128:143], a[16:19], a[132:135], v[128:143]
  ds_read_b64_tr_b16 a[42:43], v206 offset:41984
  ds_read_b64_tr_b16 a[44:45], v207 offset:40960
  ds_read_b64_tr_b16 a[46:47], v207 offset:41984
  v_mfma_f32_32x32x16_bf16 v[144:159], a[20:23], a[132:135], v[144:159]
  ds_read_b128 a[140:143], v203 offset:32768
  ds_read_b64_tr_b16 a[48:49], v204 offset:45056
  ds_read_b64_tr_b16 a[50:51], v204 offset:46080
  s_add_u32 m0, s38, 16384
  s_nop 0
  buffer_load_dwordx4 v196, s[20:23], s58 offen offset:0 lds
  s_waitcnt lgkmcnt(12)
  v_mfma_f32_32x32x16_bf16 v[160:175], a[24:27], a[132:135], v[160:175]
  ds_read_b64_tr_b16 a[52:53], v205 offset:45056
  ds_read_b64_tr_b16 a[54:55], v205 offset:46080
  ds_read_b64_tr_b16 a[56:57], v206 offset:45056
  v_mfma_f32_32x32x16_bf16 v[176:191], a[28:31], a[132:135], v[176:191]
  ds_read_b64_tr_b16 a[58:59], v206 offset:46080
  ds_read_b64_tr_b16 a[60:61], v207 offset:45056
  ds_read_b64_tr_b16 a[62:63], v207 offset:46080
  buffer_load_dwordx4 v197, s[20:23], s58 offen offset:1024 lds
  s_waitcnt lgkmcnt(13)
  v_mfma_f32_32x32x16_bf16 v[128:143], a[32:35], a[136:139], v[128:143]
  v_mfma_f32_32x32x16_bf16 v[144:159], a[36:39], a[136:139], v[144:159]
  buffer_load_dwordx4 v198, s[20:23], s58 offen offset:2048 lds
  s_waitcnt lgkmcnt(9)
  v_mfma_f32_32x32x16_bf16 v[160:175], a[40:43], a[136:139], v[160:175]
  buffer_load_dwordx4 v199, s[20:23], s58 offen offset:3072 lds
  v_mfma_f32_32x32x16_bf16 v[176:191], a[44:47], a[136:139], v[176:191]
  s_add_u32 s56, s56, 1
  s_cmp_eq_u32 s56, 10
  s_cselect_b32 s56, 0, s56
  s_lshl_b32 s57, s56, 7
  s_add_u32 s57, s57, s61
  s_lshl_b32 s58, s56, 19
  s_add_u32 s58, s58, s62
  s_waitcnt vmcnt(8) lgkmcnt(0)
  s_barrier
  v_mfma_f32_32x32x16_bf16 v[128:143], a[48:51], a[140:143], v[128:143]
  ds_read_b128 a[144:147], v200 offset:0
  ds_read_b64_tr_b16 a[64:65], v204 offset:0
  ds_read_b64_tr_b16 a[66:67], v204 offset:1024
  v_mfma_f32_32x32x16_bf16 v[144:159], a[52:55], a[140:143], v[144:159]
  ds_read_b64_tr_b16 a[68:69], v205 offset:0
  ds_read_b64_tr_b16 a[70:71], v205 offset:1024
  ds_read_b64_tr_b16 a[72:73], v206 offset:0
  s_add_u32 m0, s38, 131072
  s_nop 0
  buffer_load_dwordx4 v192, s[8:11], s57 offen offset:0 lds
  v_mfma_f32_32x32x16_bf16 v[160:175], a[56:59], a[140:143], v[160:175]
  ds_read_b64_tr_b16 a[74:75], v206 offset:1024
  ds_read_b64_tr_b16 a[76:77], v207 offset:0
  ds_read_b64_tr_b16 a[78:79], v207 offset:1024
  v_mfma_f32_32x32x16_bf16 v[176:191], a[60:63], a[140:143], v[176:191]
  ds_read_b128 a[148:151], v201 offset:0
  ds_read_b64_tr_b16 a[80:81], v204 offset:4096
  ds_read_b64_tr_b16 a[82:83], v204 offset:5120
  buffer_load_dwordx4 v193, s[8:11], s57 offen offset:1024 lds
  s_waitcnt lgkmcnt(7)
  v_mfma_f32_32x32x16_bf16 v[128:143], a[64:67], a[144:147], v[128:143]
  ds_read_b64_tr_b16 a[84:85], v205 offset:4096
  ds_read_b64_tr_b16 a[86:87], v205 offset:5120
  ds_read_b64_tr_b16 a[88:89], v206 offset:4096
  v_mfma_f32_32x32x16_bf16 v[144:159], a[68:71], a[144:147], v[144:159]
  ds_read_b64_tr_b16 a[90:91], v206 offset:5120
  ds_read_b64_tr_b16 a[92:93], v207 offset:4096
  ds_read_b64_tr_b16 a[94:95], v207 offset:5120
  buffer_load_dwordx4 v194, s[8:11], s57 offen offset:2048 lds
  s_waitcnt lgkmcnt(9)
  v_mfma_f32_32x32x16_bf16 v[160:175], a[72:75], a[144:147], v[160:175]
  ds_read_b128 a[152:155], v202 offset:0
  ds_read_b64_tr_b16 a[96:97], v204 offset:8192
  ds_read_b64_tr_b16 a[98:99], v204 offset:9216
  v_mfma_f32_32x32x16_bf16 v[176:191], a[76:79], a[144:147], v[176:191]
  ds_read_b64_tr_b16 a[100:101], v205 offset:8192
  ds_read_b64_tr_b16 a[102:103], v205 offset:9216
  ds_read_b64_tr_b16 a[104:105], v206 offset:8192
  buffer_load_dwordx4 v195, s[8:11], s57 offen offset:3072 lds
  s_waitcnt lgkmcnt(10)
  v_mfma_f32_32x32x16_bf16 v[128:143], a[80:83], a[148:151], v[128:143]
  ds_read_b64_tr_b16 a[106:107], v206 offset:9216
  ds_read_b64_tr_b16 a[108:109], v207 offset:8192
  ds_read_b64_tr_b16 a[110:111], v207 offset:9216
  v_mfma_f32_32x32x16_bf16 v[144:159], a[84:87], a[148:151], v[144:159]
  ds_read_b128 a[156:159], v203 offset:0
  ds_read_b64_tr_b16 a[112:113], v204 offset:12288
  ds_read_b64_tr_b16 a[114:115], v204 offset:13312
  s_add_u32 m0, s38, 147456
  s_nop 0
  buffer_load_dwordx4 v196, s[20:23], s58 offen offset:0 lds
  s_waitcnt lgkmcnt(12)
  v_mfma_f32_32x32x16_bf16 v[160:175], a[88:91], a[148:151], v[160:175]
  ds_read_b64_tr_b16 a[116:117], v205 offset:12288
  ds_read_b64_tr_b16 a[118:119], v205 offset:13312
  ds_read_b64_tr_b16 a[120:121], v206 offset:12288
  v_mfma_f32_32x32x16_bf16 v[176:191], a[92:95], a[148:151], v[176:191]
  ds_read_b64_tr_b16 a[122:123], v206 offset:13312
  ds_read_b64_tr_b16 a[124:125], v207 offset:12288
  ds_read_b64_tr_b16 a[126:127], v207 offset:13312
  buffer_load_dwordx4 v197, s[20:23], s58 offen offset:1024 lds
  s_waitcnt lgkmcnt(13)
  v_mfma_f32_32x32x16_bf16 v[128:143], a[96:99], a[152:155], v[128:143]
  v_mfma_f32_32x32x16_bf16 v[144:159], a[100:103], a[152:155], v[144:159]
  buffer_load_dwordx4 v198, s[20:23], s58 offen offset:2048 lds
  s_waitcnt lgkmcnt(9)
  v_mfma_f32_32x32x16_bf16 v[160:175], a[104:107], a[152:155], v[160:175]
  buffer_load_dwordx4 v199, s[20:23], s58 offen offset:3072 lds
  v_mfma_f32_32x32x16_bf16 v[176:191], a[108:111], a[152:155], v[176:191]
  s_add_u32 s56, s56, 1
  s_cmp_eq_u32 s56, 10
  s_cselect_b32 s56, 0, s56
  s_lshl_b32 s57, s56, 7
  s_add_u32 s57, s57, s61
  s_lshl_b32 s58, s56, 19
  s_add_u32 s58, s58, s62
  s_waitcnt vmcnt(8) lgkmcnt(0)
  s_barrier
  v_mfma_f32_32x32x16_bf16 v[128:143], a[112:115], a[156:159], v[128:143]
  ds_read_b128 a[128:131], v208 offset:0
  ds_read_b64_tr_b16 a[0:1], v212 offset:0
  ds_read_b64_tr_b16 a[2:3], v212 offset:1024
  v_mfma_f32_32x32x16_bf16 v[144:159], a[116:119], a[156:159], v[144:159]
  ds_read_b64_tr_b16 a[4:5], v213 offset:0
  ds_read_b64_tr_b16 a[6:7], v213 offset:1024
  ds_read_b64_tr_b16 a[8:9], v214 offset:0
  s_add_u32 m0, s38, 98304
  s_nop 0
  buffer_load_dwordx4 v192, s[8:11], s57 offen offset:0 lds
  v_mfma_f32_32x32x16_bf16 v[160:175], a[120:123], a[156:159], v[160:175]
  ds_read_b64_tr_b16 a[10:11], v214 offset:1024
  ds_read_b64_tr_b16 a[12:13], v215 offset:0
  ds_read_b64_tr_b16 a[14:15], v215 offset:1024
  v_mfma_f32_32x32x16_bf16 v[176:191], a[124:127], a[156:159], v[176:191]
  ds_read_b128 a[132:135], v209 offset:0
  ds_read_b64_tr_b16 a[16:17], v212 offset:4096
  ds_read_b64_tr_b16 a[18:19], v212 offset:5120
  buffer_load_dwordx4 v193, s[8:11], s57 offen offset:1024 lds
  s_waitcnt lgkmcnt(7)
  v_mfma_f32_32x32x16_bf16 v[128:143], a[0:3], a[128:131], v[128:143]
  ds_read_b64_tr_b16 a[20:21], v213 offset:4096
  ds_read_b64_tr_b16 a[22:23], v213 offset:5120
  ds_read_b64_tr_b16 a[24:25], v214 offset:4096
  v_mfma_f32_32x32x16_bf16 v[144:159], a[4:7], a[128:131], v[144:159]
  ds_read_b64_tr_b16 a[26:27], v214 offset:5120
  ds_read_b64_tr_b16 a[28:29], v215 offset:4096
  ds_read_b64_tr_b16 a[30:31], v215 offset:5120
  buffer_load_dwordx4 v194, s[8:11], s57 offen offset:2048 lds
  s_waitcnt lgkmcnt(9)
  v_mfma_f32_32x32x16_bf16 v[160:175], a[8:11], a[128:131], v[160:175]
  ds_read_b128 a[136:139], v210 offset:0
  ds_read_b64_tr_b16 a[32:33], v212 offset:8192
  ds_read_b64_tr_b16 a[34:35], v212 offset:9216
  v_mfma_f32_32x32x16_bf16 v[176:191], a[12:15], a[128:131], v[176:191]
  ds_read_b64_tr_b16 a[36:37], v213 offset:8192
  ds_read_b64_tr_b16 a[38:39], v213 offset:9216
  ds_read_b64_tr_b16 a[40:41], v214 offset:8192
  buffer_load_dwordx4 v195, s[8:11], s57 offen offset:3072 lds
  s_waitcnt lgkmcnt(10)
  v_mfma_f32_32x32x16_bf16 v[128:143], a[16:19], a[132:135], v[128:143]
  ds_read_b64_tr_b16 a[42:43], v214 offset:9216
  ds_read_b64_tr_b16 a[44:45], v215 offset:8192
  ds_read_b64_tr_b16 a[46:47], v215 offset:9216
  v_mfma_f32_32x32x16_bf16 v[144:159], a[20:23], a[132:135], v[144:159]
  ds_read_b128 a[140:143], v211 offset:0
  ds_read_b64_tr_b16 a[48:49], v212 offset:12288
  ds_read_b64_tr_b16 a[50:51], v212 offset:13312
  s_add_u32 m0, s38, 114688
  s_nop 0
  buffer_load_dwordx4 v196, s[20:23], s58 offen offset:0 lds
  s_waitcnt lgkmcnt(12)
  v_mfma_f32_32x32x16_bf16 v[160:175], a[24:27], a[132:135], v[160:175]
  ds_read_b64_tr_b16 a[52:53], v213 offset:12288
  ds_read_b64_tr_b16 a[54:55], v213 offset:13312
  ds_read_b64_tr_b16 a[56:57], v214 offset:12288
  v_mfma_f32_32x32x16_bf16 v[176:191], a[28:31], a[132:135], v[176:191]
  ds_read_b64_tr_b16 a[58:59], v214 offset:13312
  ds_read_b64_tr_b16 a[60:61], v215 offset:12288
  ds_read_b64_tr_b16 a[62:63], v215 offset:13312
  buffer_load_dwordx4 v197, s[20:23], s58 offen offset:1024 lds
  s_waitcnt lgkmcnt(13)
  v_mfma_f32_32x32x16_bf16 v[128:143], a[32:35], a[136:139], v[128:143]
  v_mfma_f32_32x32x16_bf16 v[144:159], a[36:39], a[136:139], v[144:159]
  buffer_load_dwordx4 v198, s[20:23], s58 offen offset:2048 lds
  s_waitcnt lgkmcnt(9)
  v_mfma_f32_32x32x16_bf16 v[160:175], a[40:43], a[136:139], v[160:175]
  buffer_load_dwordx4 v199, s[20:23], s58 offen offset:3072 lds
  v_mfma_f32_32x32x16_bf16 v[176:191], a[44:47], a[136:139], v[176:191]
  s_add_u32 s56, s56, 1
  s_cmp_eq_u32 s56, 10
  s_cselect_b32 s56, 0, s56
  s_lshl_b32 s57, s56, 7
  s_add_u32 s57, s57, s61
  s_lshl_b32 s58, s56, 19
  s_add_u32 s58, s58, s62
  s_waitcnt vmcnt(8) lgkmcnt(0)
  s_barrier
  v_mfma_f32_32x32x16_bf16 v[128:143], a[48:51], a[140:143], v[128:143]
  ds_read_b128 a[144:147], v200 offset:32768
  ds_read_b64_tr_b16 a[64:65], v204 offset:32768
  ds_read_b64_tr_b16 a[66:67], v204 offset:33792
  v_mfma_f32_32x32x16_bf16 v[144:159], a[52:55], a[140:143], v[144:159]
  ds_read_b64_tr_b16 a[68:69], v205 offset:32768
  ds_read_b64_tr_b16 a[70:71], v205 offset:33792
  ds_read_b64_tr_b16 a[72:73], v206 offset:32768
  s_add_u32 m0, s38, 0
  s_nop 0
  buffer_load_dwordx4 v192, s[8:11], s57 offen offset:0 lds
  v_mfma_f32_32x32x16_bf16 v[160:175], a[56:59], a[140:143], v[160:175]
  ds_read_b64_tr_b16 a[74:75], v206 offset:33792
  ds_read_b64_tr_b16 a[76:77], v207 offset:32768
  ds_read_b64_tr_b16 a[78:79], v207 offset:33792
  v_mfma_f32_32x32x16_bf16 v[176:191], a[60:63], a[140:143], v[176:191]
  ds_read_b128 a[148:151], v201 offset:32768
  ds_read_b64_tr_b16 a[80:81], v204 offset:36864
  ds_read_b64_tr_b16 a[82:83], v204 offset:37888
  buffer_load_dwordx4 v193, s[8:11], s57 offen offset:1024 lds
  s_waitcnt lgkmcnt(7)
  v_mfma_f32_32x32x16_bf16 v[128:143], a[64:67], a[144:147], v[128:143]
  ds_read_b64_tr_b16 a[84:85], v205 offset:36864
  ds_read_b64_tr_b16 a[86:87], v205 offset:37888
  ds_read_b64_tr_b16 a[88:89], v206 offset:36864
  v_mfma_f32_32x32x16_bf16 v[144:159], a[68:71], a[144:147], v[144:159]
  ds_read_b64_tr_b16 a[90:91], v206 offset:37888
  ds_read_b64_tr_b16 a[92:93], v207 offset:36864
  ds_read_b64_tr_b16 a[94:95], v207 offset:37888
  buffer_load_dwordx4 v194, s[8:11], s57 offen offset:2048 lds
  s_waitcnt lgkmcnt(9)
  v_mfma_f32_32x32x16_bf16 v[160:175], a[72:75], a[144:147], v[160:175]
  ds_read_b128 a[152:155], v202 offset:32768
  ds_read_b64_tr_b16 a[96:97], v204 offset:40960
  ds_read_b64_tr_b16 a[98:99], v204 offset:41984
  v_mfma_f32_32x32x16_bf16 v[176:191], a[76:79], a[144:147], v[176:191]
  ds_read_b64_tr_b16 a[100:101], v205 offset:40960
  ds_read_b64_tr_b16 a[102:103], v205 offset:41984
  ds_read_b64_tr_b16 a[104:105], v206 offset:40960
  buffer_load_dwordx4 v195, s[8:11], s57 offen offset:3072 lds
  s_waitcnt lgkmcnt(10)
  v_mfma_f32_32x32x16_bf16 v[128:143], a[80:83], a[148:151], v[128:143]
  ds_read_b64_tr_b16 a[106:107], v206 offset:41984
  ds_read_b64_tr_b16 a[108:109], v207 offset:40960
  ds_read_b64_tr_b16 a[110:111], v207 offset:41984
  v_mfma_f32_32x32x16_bf16 v[144:159], a[84:87], a[148:151], v[144:159]
  ds_read_b128 a[156:159], v203 offset:32768
  ds_read_b64_tr_b16 a[112:113], v204 offset:45056
  ds_read_b64_tr_b16 a[114:115], v204 offset:46080
  s_add_u32 m0, s38, 16384
  s_nop 0
  buffer_load_dwordx4 v196, s[20:23], s58 offen offset:0 lds
  s_waitcnt lgkmcnt(12)
  v_mfma_f32_32x32x16_bf16 v[160:175], a[88:91], a[148:151], v[160:175]
  ds_read_b64_tr_b16 a[116:117], v205 offset:45056
  ds_read_b64_tr_b16 a[118:119], v205 offset:46080
  ds_read_b64_tr_b16 a[120:121], v206 offset:45056
  v_mfma_f32_32x32x16_bf16 v[176:191], a[92:95], a[148:151], v[176:191]
  ds_read_b64_tr_b16 a[122:123], v206 offset:46080
  ds_read_b64_tr_b16 a[124:125], v207 offset:45056
  ds_read_b64_tr_b16 a[126:127], v207 offset:46080
  buffer_load_dwordx4 v197, s[20:23], s58 offen offset:1024 lds
  s_waitcnt lgkmcnt(13)
  v_mfma_f32_32x32x16_bf16 v[128:143], a[96:99], a[152:155], v[128:143]
  v_mfma_f32_32x32x16_bf16 v[144:159], a[100:103], a[152:155], v[144:159]
  buffer_load_dwordx4 v198, s[20:23], s58 offen offset:2048 lds
  s_waitcnt lgkmcnt(9)
  v_mfma_f32_32x32x16_bf16 v[160:175], a[104:107], a[152:155], v[160:175]
  buffer_load_dwordx4 v199, s[20:23], s58 offen offset:3072 lds
  v_mfma_f32_32x32x16_bf16 v[176:191], a[108:111], a[152:155], v[176:191]
  s_add_u32 s56, s56, 1
  s_cmp_eq_u32 s56, 10
  s_cselect_b32 s56, 0, s56
  s_lshl_b32 s57, s56, 7
  s_add_u32 s57, s57, s61
  s_lshl_b32 s58, s56, 19
  s_add_u32 s58, s58, s62
  s_waitcnt vmcnt(8) lgkmcnt(0)
  s_barrier
  v_mfma_f32_32x32x16_bf16 v[128:143], a[112:115], a[156:159], v[128:143]
  ds_read_b128 a[128:131], v200 offset:0
  ds_read_b64_tr_b16 a[0:1], v204 offset:0
  ds_read_b64_tr_b16 a[2:3], v204 offset:1024
  v_mfma_f32_32x32x16_bf16 v[144:159], a[116:119], a[156:159], v[144:159]
  ds_read_b64_tr_b16 a[4:5], v205 offset:0
  ds_read_b64_tr_b16 a[6:7], v205 offset:1024
  ds_read_b64_tr_b16 a[8:9], v206 offset:0
  s_add_u32 m0, s38, 131072
  s_nop 0
  buffer_load_dwordx4 v192, s[8:11], s57 offen offset:0 lds
  v_mfma_f32_32x32x16_bf16 v[160:175], a[120:123], a[156:159], v[160:175]
  ds_read_b64_tr_b16 a[10:11], v206 offset:1024
  ds_read_b64_tr_b16 a[12:13], v207 offset:0
  ds_read_b64_tr_b16 a[14:15], v207 offset:1024
  v_mfma_f32_32x32x16_bf16 v[176:191], a[124:127], a[156:159], v[176:191]
  ds_read_b128 a[132:135], v201 offset:0
  ds_read_b64_tr_b16 a[16:17], v204 offset:4096
  ds_read_b64_tr_b16 a[18:19], v204 offset:5120
  buffer_load_dwordx4 v193, s[8:11], s57 offen offset:1024 lds
  s_waitcnt lgkmcnt(7)
  v_mfma_f32_32x32x16_bf16 v[128:143], a[0:3], a[128:131], v[128:143]
  ds_read_b64_tr_b16 a[20:21], v205 offset:4096
  ds_read_b64_tr_b16 a[22:23], v205 offset:5120
  ds_read_b64_tr_b16 a[24:25], v206 offset:4096
  v_mfma_f32_32x32x16_bf16 v[144:159], a[4:7], a[128:131], v[144:159]
  ds_read_b64_tr_b16 a[26:27], v206 offset:5120
  ds_read_b64_tr_b16 a[28:29], v207 offset:4096
  ds_read_b64_tr_b16 a[30:31], v207 offset:5120
  buffer_load_dwordx4 v194, s[8:11], s57 offen offset:2048 lds
  s_waitcnt lgkmcnt(9)
  v_mfma_f32_32x32x16_bf16 v[160:175], a[8:11], a[128:131], v[160:175]
  ds_read_b128 a[136:139], v202 offset:0
  ds_read_b64_tr_b16 a[32:33], v204 offset:8192
  ds_read_b64_tr_b16 a[34:35], v204 offset:9216
  v_mfma_f32_32x32x16_bf16 v[176:191], a[12:15], a[128:131], v[176:191]
  ds_read_b64_tr_b16 a[36:37], v205 offset:8192
  ds_read_b64_tr_b16 a[38:39], v205 offset:9216
  ds_read_b64_tr_b16 a[40:41], v206 offset:8192
  buffer_load_dwordx4 v195, s[8:11], s57 offen offset:3072 lds
  s_waitcnt lgkmcnt(10)
  v_mfma_f32_32x32x16_bf16 v[128:143], a[16:19], a[132:135], v[128:143]
  ds_read_b64_tr_b16 a[42:43], v206 offset:9216
  ds_read_b64_tr_b16 a[44:45], v207 offset:8192
  ds_read_b64_tr_b16 a[46:47], v207 offset:9216
  v_mfma_f32_32x32x16_bf16 v[144:159], a[20:23], a[132:135], v[144:159]
  ds_read_b128 a[140:143], v203 offset:0
  ds_read_b64_tr_b16 a[48:49], v204 offset:12288
  ds_read_b64_tr_b16 a[50:51], v204 offset:13312
  s_add_u32 m0, s38, 147456
  s_nop 0
  buffer_load_dwordx4 v196, s[20:23], s58 offen offset:0 lds
  s_waitcnt lgkmcnt(12)
  v_mfma_f32_32x32x16_bf16 v[160:175], a[24:27], a[132:135], v[160:175]
  ds_read_b64_tr_b16 a[52:53], v205 offset:12288
  ds_read_b64_tr_b16 a[54:55], v205 offset:13312
  ds_read_b64_tr_b16 a[56:57], v206 offset:12288
  v_mfma_f32_32x32x16_bf16 v[176:191], a[28:31], a[132:135], v[176:191]
  ds_read_b64_tr_b16 a[58:59], v206 offset:13312
  ds_read_b64_tr_b16 a[60:61], v207 offset:12288
  ds_read_b64_tr_b16 a[62:63], v207 offset:13312
  buffer_load_dwordx4 v197, s[20:23], s58 offen offset:1024 lds
  s_waitcnt lgkmcnt(13)
  v_mfma_f32_32x32x16_bf16 v[128:143], a[32:35], a[136:139], v[128:143]
  v_mfma_f32_32x32x16_bf16 v[144:159], a[36:39], a[136:139], v[144:159]
  buffer_load_dwordx4 v198, s[20:23], s58 offen offset:2048 lds
  s_waitcnt lgkmcnt(9)
  v_mfma_f32_32x32x16_bf16 v[160:175], a[40:43], a[136:139], v[160:175]
  buffer_load_dwordx4 v199, s[20:23], s58 offen offset:3072 lds
  v_mfma_f32_32x32x16_bf16 v[176:191], a[44:47], a[136:139], v[176:191]
  s_add_u32 s56, s56, 1
  s_cmp_eq_u32 s56, 10
  s_cselect_b32 s56, 0, s56
  s_lshl_b32 s57, s56, 7
  s_add_u32 s57, s57, s61
  s_lshl_b32 s58, s56, 19
  s_add_u32 s58, s58, s62
  s_waitcnt vmcnt(8) lgkmcnt(0)
  s_barrier
  v_mfma_f32_32x32x16_bf16 v[128:143], a[48:51], a[140:143], v[128:143]
  ds_read_b128 a[144:147], v208 offset:0
  ds_read_b64_tr_b16 a[64:65], v212 offset:0
  ds_read_b64_tr_b16 a[66:67], v212 offset:1024
  s_add_u32 m0, s38, 98304
  s_nop 0
  buffer_load_dwordx4 v192, s[8:11], s57 offen offset:0 lds
  v_mfma_f32_32x32x16_bf16 v[144:159], a[52:55], a[140:143], v[144:159]
  ds_read_b64_tr_b16 a[68:69], v213 offset:0
  ds_read_b64_tr_b16 a[70:71], v213 offset:1024
  ds_read_b64_tr_b16 a[72:73], v214 offset:0
  buffer_load_dwordx4 v193, s[8:11], s57 offen offset:1024 lds
  v_mfma_f32_32x32x16_bf16 v[160:175], a[56:59], a[140:143], v[160:175]
  ds_read_b64_tr_b16 a[74:75], v214 offset:1024
  ds_read_b64_tr_b16 a[76:77], v215 offset:0
  ds_read_b64_tr_b16 a[78:79], v215 offset:1024
  buffer_load_dwordx4 v194, s[8:11], s57 offen offset:2048 lds
  v_mfma_f32_32x32x16_bf16 v[176:191], a[60:63], a[140:143], v[176:191]
  ds_read_b128 a[148:151], v209 offset:0
  ds_read_b64_tr_b16 a[80:81], v212 offset:4096
  ds_read_b64_tr_b16 a[82:83], v212 offset:5120
  buffer_load_dwordx4 v195, s[8:11], s57 offen offset:3072 lds
  s_waitcnt lgkmcnt(7)
  v_mfma_f32_32x32x16_bf16 v[128:143], a[64:67], a[144:147], v[128:143]
  ds_read_b64_tr_b16 a[84:85], v213 offset:4096
  ds_read_b64_tr_b16 a[86:87], v213 offset:5120
  ds_read_b64_tr_b16 a[88:89], v214 offset:4096
  s_add_u32 m0, s38, 114688
  s_nop 0
  buffer_load_dwordx4 v196, s[20:23], s58 offen offset:0 lds
  v_mfma_f32_32x32x16_bf16 v[144:159], a[68:71], a[144:147], v[144:159]
  ds_read_b64_tr_b16 a[90:91], v214 offset:5120
  ds_read_b64_tr_b16 a[92:93], v215 offset:4096
  ds_read_b64_tr_b16 a[94:95], v215 offset:5120
  buffer_load_dwordx4 v197, s[20:23], s58 offen offset:1024 lds
  s_waitcnt lgkmcnt(9)
  v_mfma_f32_32x32x16_bf16 v[160:175], a[72:75], a[144:147], v[160:175]
  ds_read_b128 a[152:155], v210 offset:0
  ds_read_b64_tr_b16 a[96:97], v212 offset:8192
  ds_read_b64_tr_b16 a[98:99], v212 offset:9216
  buffer_load_dwordx4 v198, s[20:23], s58 offen offset:2048 lds
  v_mfma_f32_32x32x16_bf16 v[176:191], a[76:79], a[144:147], v[176:191]
  ds_read_b64_tr_b16 a[100:101], v213 offset:8192
  ds_read_b64_tr_b16 a[102:103], v213 offset:9216
  ds_read_b64_tr_b16 a[104:105], v214 offset:8192
  buffer_load_dwordx4 v199, s[20:23], s58 offen offset:3072 lds
  s_waitcnt lgkmcnt(10)
  v_mfma_f32_32x32x16_bf16 v[128:143], a[80:83], a[148:151], v[128:143]
  ds_read_b64_tr_b16 a[106:107], v214 offset:9216
  ds_read_b64_tr_b16 a[108:109], v215 offset:8192
  ds_read_b64_tr_b16 a[110:111], v215 offset:9216
  s_add_u32 m0, s38, 65536
  s_add_u32 s59, s97, 0
  s_and_b32 s59, s59, 0x1ffff
  s_add_u32 s59, s59, s38
  buffer_load_dwordx4 v2, s[12:15], s59 offen offset:0 nt lds
  v_mfma_f32_32x32x16_bf16 v[144:159], a[84:87], a[148:151], v[144:159]
  ds_read_b128 a[156:159], v211 offset:0
  ds_read_b64_tr_b16 a[112:113], v212 offset:12288
  ds_read_b64_tr_b16 a[114:115], v212 offset:13312
  buffer_load_dwordx4 v3, s[12:15], s59 offen offset:1024 nt lds
  s_waitcnt lgkmcnt(12)
  v_mfma_f32_32x32x16_bf16 v[160:175], a[88:91], a[148:151], v[160:175]
  ds_read_b64_tr_b16 a[116:117], v213 offset:12288
  ds_read_b64_tr_b16 a[118:119], v213 offset:13312
  ds_read_b64_tr_b16 a[120:121], v214 offset:12288
  buffer_load_dwordx4 v4, s[12:15], s59 offen offset:2048 nt lds
  v_mfma_f32_32x32x16_bf16 v[176:191], a[92:95], a[148:151], v[176:191]
  ds_read_b64_tr_b16 a[122:123], v214 offset:13312
  ds_read_b64_tr_b16 a[124:125], v215 offset:12288
  ds_read_b64_tr_b16 a[126:127], v215 offset:13312
  buffer_load_dwordx4 v5, s[12:15], s59 offen offset:3072 nt lds
  s_waitcnt lgkmcnt(13)
  v_mfma_f32_32x32x16_bf16 v[128:143], a[96:99], a[152:155], v[128:143]
  s_add_u32 m0, s38, 81920
  s_add_u32 s59, s97, 16384
  s_and_b32 s59, s59, 0x1ffff
  s_add_u32 s59, s59, s38
  buffer_load_dwordx4 v2, s[12:15], s59 offen offset:0 nt lds
  v_mfma_f32_32x32x16_bf16 v[144:159], a[100:103], a[152:155], v[144:159]
  buffer_load_dwordx4 v3, s[12:15], s59 offen offset:1024 nt lds
  s_waitcnt lgkmcnt(9)
  v_mfma_f32_32x32x16_bf16 v[160:175], a[104:107], a[152:155], v[160:175]
  buffer_load_dwordx4 v4, s[12:15], s59 offen offset:2048 nt lds
  v_mfma_f32_32x32x16_bf16 v[176:191], a[108:111], a[152:155], v[176:191]
  buffer_load_dwordx4 v5, s[12:15], s59 offen offset:3072 nt lds
  s_waitcnt vmcnt(16) lgkmcnt(0)
  s_barrier
  v_mfma_f32_32x32x16_bf16 v[128:143], a[112:115], a[156:159], v[128:143]
  ds_read_b128 a[128:131], v200 offset:32768
  ds_read_b64_tr_b16 a[0:1], v204 offset:32768
  ds_read_b64_tr_b16 a[2:3], v204 offset:33792
  s_add_u32 m0, s38, 32768
  s_add_u32 s59, s97, 32768
  s_and_b32 s59, s59, 0x1ffff
  s_add_u32 s59, s59, s38
  buffer_load_dwordx4 v2, s[12:15], s59 offen offset:0 nt lds
  v_mfma_f32_32x32x16_bf16 v[144:159], a[116:119], a[156:159], v[144:159]
  ds_read_b64_tr_b16 a[4:5], v205 offset:32768
  ds_read_b64_tr_b16 a[6:7], v205 offset:33792
  ds_read_b64_tr_b16 a[8:9], v206 offset:32768
  buffer_load_dwordx4 v3, s[12:15], s59 offen offset:1024 nt lds
  v_mfma_f32_32x32x16_bf16 v[160:175], a[120:123], a[156:159], v[160:175]
  ds_read_b64_tr_b16 a[10:11], v206 offset:33792
  ds_read_b64_tr_b16 a[12:13], v207 offset:32768
  ds_read_b64_tr_b16 a[14:15], v207 offset:33792
  buffer_load_dwordx4 v4, s[12:15], s59 offen offset:2048 nt lds
  v_mfma_f32_32x32x16_bf16 v[176:191], a[124:127], a[156:159], v[176:191]
  ds_read_b128 a[132:135], v201 offset:32768
  ds_read_b64_tr_b16 a[16:17], v204 offset:36864
  ds_read_b64_tr_b16 a[18:19], v204 offset:37888
  buffer_load_dwordx4 v5, s[12:15], s59 offen offset:3072 nt lds
  s_waitcnt lgkmcnt(7)
  v_mfma_f32_32x32x16_bf16 v[128:143], a[0:3], a[128:131], v[128:143]
  ds_read_b64_tr_b16 a[20:21], v205 offset:36864
  ds_read_b64_tr_b16 a[22:23], v205 offset:37888
  ds_read_b64_tr_b16 a[24:25], v206 offset:36864
  s_add_u32 m0, s38, 49152
  s_add_u32 s59, s97, 49152
  s_and_b32 s59, s59, 0x1ffff
  s_add_u32 s59, s59, s38
  buffer_load_dwordx4 v2, s[12:15], s59 offen offset:0 nt lds
  v_mfma_f32_32x32x16_bf16 v[144:159], a[4:7], a[128:131], v[144:159]
  ds_read_b64_tr_b16 a[26:27], v206 offset:37888
  ds_read_b64_tr_b16 a[28:29], v207 offset:36864
  ds_read_b64_tr_b16 a[30:31], v207 offset:37888
  buffer_load_dwordx4 v3, s[12:15], s59 offen offset:1024 nt lds
  s_waitcnt lgkmcnt(9)
  v_mfma_f32_32x32x16_bf16 v[160:175], a[8:11], a[128:131], v[160:175]
  ds_read_b128 a[136:139], v202 offset:32768
  ds_read_b64_tr_b16 a[32:33], v204 offset:40960
  ds_read_b64_tr_b16 a[34:35], v204 offset:41984
  buffer_load_dwordx4 v4, s[12:15], s59 offen offset:2048 nt lds
  v_mfma_f32_32x32x16_bf16 v[176:191], a[12:15], a[128:131], v[176:191]
  ds_read_b64_tr_b16 a[36:37], v205 offset:40960
  ds_read_b64_tr_b16 a[38:39], v205 offset:41984
  ds_read_b64_tr_b16 a[40:41], v206 offset:40960
  buffer_load_dwordx4 v5, s[12:15], s59 offen offset:3072 nt lds
  s_waitcnt lgkmcnt(10)
  v_mfma_f32_32x32x16_bf16 v[128:143], a[16:19], a[132:135], v[128:143]
  ds_read_b64_tr_b16 a[42:43], v206 offset:41984
  ds_read_b64_tr_b16 a[44:45], v207 offset:40960
  ds_read_b64_tr_b16 a[46:47], v207 offset:41984
  s_add_u32 m0, s38, 0
  s_add_u32 s59, s97, 65536
  s_and_b32 s59, s59, 0x1ffff
  s_add_u32 s59, s59, s38
  buffer_load_dwordx4 v2, s[12:15], s59 offen offset:0 nt lds
  v_mfma_f32_32x32x16_bf16 v[144:159], a[20:23], a[132:135], v[144:159]
  ds_read_b128 a[140:143], v203 offset:32768
  ds_read_b64_tr_b16 a[48:49], v204 offset:45056
  ds_read_b64_tr_b16 a[50:51], v204 offset:46080
  buffer_load_dwordx4 v3, s[12:15], s59 offen offset:1024 nt lds
  s_waitcnt lgkmcnt(12)
  v_mfma_f32_32x32x16_bf16 v[160:175], a[24:27], a[132:135], v[160:175]
  ds_read_b64_tr_b16 a[52:53], v205 offset:45056
  ds_read_b64_tr_b16 a[54:55], v205 offset:46080
  ds_read_b64_tr_b16 a[56:57], v206 offset:45056
  buffer_load_dwordx4 v4, s[12:15], s59 offen offset:2048 nt lds
  v_mfma_f32_32x32x16_bf16 v[176:191], a[28:31], a[132:135], v[176:191]
  ds_read_b64_tr_b16 a[58:59], v206 offset:46080
  ds_read_b64_tr_b16 a[60:61], v207 offset:45056
  ds_read_b64_tr_b16 a[62:63], v207 offset:46080
  buffer_load_dwordx4 v5, s[12:15], s59 offen offset:3072 nt lds
  s_waitcnt lgkmcnt(13)
  v_mfma_f32_32x32x16_bf16 v[128:143], a[32:35], a[136:139], v[128:143]
  s_add_u32 m0, s38, 16384
  s_add_u32 s59, s97, 81920
  s_and_b32 s59, s59, 0x1ffff
  s_add_u32 s59, s59, s38
  buffer_load_dwordx4 v2, s[12:15], s59 offen offset:0 nt lds
  v_mfma_f32_32x32x16_bf16 v[144:159], a[36:39], a[136:139], v[144:159]
  buffer_load_dwordx4 v3, s[12:15], s59 offen offset:1024 nt lds
  s_waitcnt lgkmcnt(9)
  v_mfma_f32_32x32x16_bf16 v[160:175], a[40:43], a[136:139], v[160:175]
  buffer_load_dwordx4 v4, s[12:15], s59 offen offset:2048 nt lds
  v_mfma_f32_32x32x16_bf16 v[176:191], a[44:47], a[136:139], v[176:191]
  buffer_load_dwordx4 v5, s[12:15], s59 offen offset:3072 nt lds
  s_waitcnt vmcnt(24) lgkmcnt(0)
  s_barrier
  v_mfma_f32_32x32x16_bf16 v[128:143], a[48:51], a[140:143], v[128:143]
  ds_read_b128 a[144:147], v200 offset:0
  ds_read_b64_tr_b16 a[64:65], v204 offset:0
  ds_read_b64_tr_b16 a[66:67], v204 offset:1024
  v_mfma_f32_32x32x16_bf16 v[144:159], a[52:55], a[140:143], v[144:159]
  ds_read_b64_tr_b16 a[68:69], v205 offset:0
  ds_read_b64_tr_b16 a[70:71], v205 offset:1024
  ds_read_b64_tr_b16 a[72:73], v206 offset:0
  s_add_u32 m0, s38, 131072
  s_add_u32 s59, s97, 98304
  s_and_b32 s59, s59, 0x1ffff
  s_add_u32 s59, s59, s38
  buffer_load_dwordx4 v2, s[12:15], s59 offen offset:0 nt lds
  v_mfma_f32_32x32x16_bf16 v[160:175], a[56:59], a[140:143], v[160:175]
  ds_read_b64_tr_b16 a[74:75], v206 offset:1024
  ds_read_b64_tr_b16 a[76:77], v207 offset:0
  ds_read_b64_tr_b16 a[78:79], v207 offset:1024
  v_mfma_f32_32x32x16_bf16 v[176:191], a[60:63], a[140:143], v[176:191]
  ds_read_b128 a[148:151], v201 offset:0
  ds_read_b64_tr_b16 a[80:81], v204 offset:4096
  ds_read_b64_tr_b16 a[82:83], v204 offset:5120
  buffer_load_dwordx4 v3, s[12:15], s59 offen offset:1024 nt lds
  s_waitcnt lgkmcnt(7)
  v_mfma_f32_32x32x16_bf16 v[128:143], a[64:67], a[144:147], v[128:143]
  ds_read_b64_tr_b16 a[84:85], v205 offset:4096
  ds_read_b64_tr_b16 a[86:87], v205 offset:5120
  ds_read_b64_tr_b16 a[88:89], v206 offset:4096
  v_mfma_f32_32x32x16_bf16 v[144:159], a[68:71], a[144:147], v[144:159]
  ds_read_b64_tr_b16 a[90:91], v206 offset:5120
  ds_read_b64_tr_b16 a[92:93], v207 offset:4096
  ds_read_b64_tr_b16 a[94:95], v207 offset:5120
  buffer_load_dwordx4 v4, s[12:15], s59 offen offset:2048 nt lds
  s_waitcnt lgkmcnt(9)
  v_mfma_f32_32x32x16_bf16 v[160:175], a[72:75], a[144:147], v[160:175]
  ds_read_b128 a[152:155], v202 offset:0
  ds_read_b64_tr_b16 a[96:97], v204 offset:8192
  ds_read_b64_tr_b16 a[98:99], v204 offset:9216
  v_mfma_f32_32x32x16_bf16 v[176:191], a[76:79], a[144:147], v[176:191]
  ds_read_b64_tr_b16 a[100:101], v205 offset:8192
  ds_read_b64_tr_b16 a[102:103], v205 offset:9216
  ds_read_b64_tr_b16 a[104:105], v206 offset:8192
  buffer_load_dwordx4 v5, s[12:15], s59 offen offset:3072 nt lds
  s_waitcnt lgkmcnt(10)
  v_mfma_f32_32x32x16_bf16 v[128:143], a[80:83], a[148:151], v[128:143]
  ds_read_b64_tr_b16 a[106:107], v206 offset:9216
  ds_read_b64_tr_b16 a[108:109], v207 offset:8192
  ds_read_b64_tr_b16 a[110:111], v207 offset:9216
  v_mfma_f32_32x32x16_bf16 v[144:159], a[84:87], a[148:151], v[144:159]
  ds_read_b128 a[156:159], v203 offset:0
  ds_read_b64_tr_b16 a[112:113], v204 offset:12288
  ds_read_b64_tr_b16 a[114:115], v204 offset:13312
  s_add_u32 m0, s38, 147456
  s_add_u32 s59, s97, 114688
  s_and_b32 s59, s59, 0x1ffff
  s_add_u32 s59, s59, s38
  buffer_load_dwordx4 v2, s[12:15], s59 offen offset:0 nt lds
  s_waitcnt lgkmcnt(12)
  v_mfma_f32_32x32x16_bf16 v[160:175], a[88:91], a[148:151], v[160:175]
  ds_read_b64_tr_b16 a[116:117], v205 offset:12288
  ds_read_b64_tr_b16 a[118:119], v205 offset:13312
  ds_read_b64_tr_b16 a[120:121], v206 offset:12288
  v_mfma_f32_32x32x16_bf16 v[176:191], a[92:95], a[148:151], v[176:191]
  ds_read_b64_tr_b16 a[122:123], v206 offset:13312
  ds_read_b64_tr_b16 a[124:125], v207 offset:12288
  ds_read_b64_tr_b16 a[126:127], v207 offset:13312
  buffer_load_dwordx4 v3, s[12:15], s59 offen offset:1024 nt lds
  s_waitcnt lgkmcnt(13)
  v_mfma_f32_32x32x16_bf16 v[128:143], a[96:99], a[152:155], v[128:143]
  v_mfma_f32_32x32x16_bf16 v[144:159], a[100:103], a[152:155], v[144:159]
  buffer_load_dwordx4 v4, s[12:15], s59 offen offset:2048 nt lds
  s_waitcnt lgkmcnt(9)
  v_mfma_f32_32x32x16_bf16 v[160:175], a[104:107], a[152:155], v[160:175]
  buffer_load_dwordx4 v5, s[12:15], s59 offen offset:3072 nt lds
  v_mfma_f32_32x32x16_bf16 v[176:191], a[108:111], a[152:155], v[176:191]
  s_waitcnt vmcnt(28) lgkmcnt(0)
  s_barrier
  v_mfma_f32_32x32x16_bf16 v[128:143], a[112:115], a[156:159], v[128:143]
  ds_read_b128 a[0:3], v16 offset:32768
  ds_read_b128 a[4:7], v17 offset:32768
  ds_read_b128 a[8:11], v18 offset:32768
  v_mfma_f32_32x32x16_bf16 v[144:159], a[116:119], a[156:159], v[144:159]
  ds_read_b128 a[12:15], v19 offset:32768
  ds_read_b128 a[16:19], v20 offset:32768
  ds_read_b128 a[20:23], v21 offset:32768
  v_mfma_f32_32x32x16_bf16 v[160:175], a[120:123], a[156:159], v[160:175]
  ds_read_b128 a[24:27], v22 offset:32768
  ds_read_b128 a[28:31], v23 offset:32768
  v_mfma_f32_32x32x16_bf16 v[176:191], a[124:127], a[156:159], v[176:191]
  s_mov_b32 s63, 0x3e0293ee
  s_nop 9
  v_mul_f32 v128, s63, v128
  v_mul_f32 v129, s63, v129
  v_mul_f32 v130, s63, v130
  v_mul_f32 v131, s63, v131
  v_mul_f32 v132, s63, v132
  v_mul_f32 v133, s63, v133
  v_mul_f32 v134, s63, v134
  v_mul_f32 v135, s63, v135
  v_cvt_pk_bf16_f32 v32, v128, v129
  v_cvt_pk_bf16_f32 v33, v130, v131
  v_cvt_pk_bf16_f32 v34, v132, v133
  v_cvt_pk_bf16_f32 v35, v134, v135
  v_mul_f32 v136, s63, v136
  v_mul_f32 v137, s63, v137
  v_mul_f32 v138, s63, v138
  v_mul_f32 v139, s63, v139
  v_mul_f32 v140, s63, v140
  v_mul_f32 v141, s63, v141
  v_mul_f32 v142, s63, v142
  v_mul_f32 v143, s63, v143
  v_cvt_pk_bf16_f32 v36, v136, v137
  v_cvt_pk_bf16_f32 v37, v138, v139
  s_mov_b32 s67, 0x40004000
  s_waitcnt lgkmcnt(0)
  v_mfma_f32_32x32x16_bf16 v[64:79], a[0:3], v[32:35], 0
  v_cvt_pk_bf16_f32 v38, v140, v141
  v_cvt_pk_bf16_f32 v39, v142, v143
  v_mul_f32 v144, s63, v144
  v_mul_f32 v145, s63, v145
  v_mul_f32 v146, s63, v146
  v_mul_f32 v147, s63, v147
  v_mul_f32 v148, s63, v148
  v_mul_f32 v149, s63, v149
  v_mul_f32 v150, s63, v150
  v_mul_f32 v151, s63, v151
  v_cvt_pk_bf16_f32 v40, v144, v145
  v_cvt_pk_bf16_f32 v41, v146, v147
  ds_read_b128 a[32:35], v16 offset:40960
  ds_read_b128 a[36:39], v17 offset:40960
  ds_read_b128 a[40:43], v18 offset:40960
  ds_read_b128 a[44:47], v19 offset:40960
  s_add_u32 m0, s38, 98304
  s_add_u32 s59, s97, 0
  s_and_b32 s59, s59, 0x1ffff
  s_lshl1_add_u32 s59, s38, s59
  buffer_load_dwordx4 v6, s[16:19], s59 offen offset:0 nt lds
  v_mfma_f32_32x32x16_bf16 v[64:79], a[4:7], v[36:39], v[64:79]
  v_cvt_pk_bf16_f32 v42, v148, v149
  v_cvt_pk_bf16_f32 v43, v150, v151
  v_mul_f32 v152, s63, v152
  v_mul_f32 v153, s63, v153
  v_mul_f32 v154, s63, v154
  v_mul_f32 v155, s63, v155
  v_mul_f32 v156, s63, v156
  v_mul_f32 v157, s63, v157
  v_mul_f32 v158, s63, v158
  v_mul_f32 v159, s63, v159
  v_cvt_pk_bf16_f32 v44, v152, v153
  v_cvt_pk_bf16_f32 v45, v154, v155
  ds_read_b128 a[48:51], v20 offset:40960
  ds_read_b128 a[52:55], v21 offset:40960
  ds_read_b128 a[56:59], v22 offset:40960
  ds_read_b128 a[60:63], v23 offset:40960
  buffer_load_dwordx4 v7, s[16:19], s59 offen offset:1024 nt lds
  v_mfma_f32_32x32x16_bf16 v[64:79], a[8:11], v[40:43], v[64:79]
  v_cvt_pk_bf16_f32 v46, v156, v157
  v_cvt_pk_bf16_f32 v47, v158, v159
  v_mul_f32 v160, s63, v160
  v_mul_f32 v161, s63, v161
  v_mul_f32 v162, s63, v162
  v_mul_f32 v163, s63, v163
  v_mul_f32 v164, s63, v164
  v_mul_f32 v165, s63, v165
  v_mul_f32 v166, s63, v166
  v_mul_f32 v167, s63, v167
  v_cvt_pk_bf16_f32 v48, v160, v161
  v_cvt_pk_bf16_f32 v49, v162, v163
  v_mfma_f32_32x32x16_bf16 v[64:79], a[12:15], v[44:47], v[64:79]
  v_cvt_pk_bf16_f32 v50, v164, v165
  v_cvt_pk_bf16_f32 v51, v166, v167
  v_mul_f32 v168, s63, v168
  v_mul_f32 v169, s63, v169
  v_mul_f32 v170, s63, v170
  v_mul_f32 v171, s63, v171
  v_mul_f32 v172, s63, v172
  v_mul_f32 v173, s63, v173
  v_mul_f32 v174, s63, v174
  v_mul_f32 v175, s63, v175
  v_cvt_pk_bf16_f32 v52, v168, v169
  v_cvt_pk_bf16_f32 v53, v170, v171
  v_mfma_f32_32x32x16_bf16 v[64:79], a[16:19], v[48:51], v[64:79]
  v_cvt_pk_bf16_f32 v54, v172, v173
  v_cvt_pk_bf16_f32 v55, v174, v175
  v_mul_f32 v176, s63, v176
  v_mul_f32 v177, s63, v177
  v_mul_f32 v178, s63, v178
  v_mul_f32 v179, s63, v179
  v_mul_f32 v180, s63, v180
  v_mul_f32 v181, s63, v181
  v_mul_f32 v182, s63, v182
  v_mul_f32 v183, s63, v183
  v_cvt_pk_bf16_f32 v56, v176, v177
  v_cvt_pk_bf16_f32 v57, v178, v179
  v_mfma_f32_32x32x16_bf16 v[64:79], a[20:23], v[52:55], v[64:79]
  v_cvt_pk_bf16_f32 v58, v180, v181
  v_cvt_pk_bf16_f32 v59, v182, v183
  v_mul_f32 v184, s63, v184
  v_mul_f32 v185, s63, v185
  v_mul_f32 v186, s63, v186
  v_mul_f32 v187, s63, v187
  v_mul_f32 v188, s63, v188
  v_mul_f32 v189, s63, v189
  v_mul_f32 v190, s63, v190
  v_mul_f32 v191, s63, v191
  v_cvt_pk_bf16_f32 v60, v184, v185
  v_cvt_pk_bf16_f32 v61, v186, v187
  v_mfma_f32_32x32x16_bf16 v[64:79], a[24:27], v[56:59], v[64:79]
  v_cvt_pk_bf16_f32 v62, v188, v189
  v_cvt_pk_bf16_f32 v63, v190, v191
  s_nop 1
  v_mfma_f32_32x32x16_bf16 v[64:79], a[28:31], v[60:63], v[64:79]
  s_waitcnt vmcnt(26)
  s_barrier
  s_waitcnt lgkmcnt(0)
  v_mfma_f32_32x32x16_bf16 v[80:95], a[32:35], v[32:35], 0
  ds_read_b128 a[0:3], v16 offset:49152
  ds_read_b128 a[4:7], v17 offset:49152
  ds_read_b128 a[8:11], v18 offset:49152
  ds_read_b128 a[12:15], v19 offset:49152
  buffer_load_dwordx4 v8, s[16:19], s59 offen offset:2048 nt lds
  v_mfma_f32_32x32x16_bf16 v[80:95], a[36:39], v[36:39], v[80:95]
  ds_read_b128 a[16:19], v20 offset:49152
  ds_read_b128 a[20:23], v21 offset:49152
  ds_read_b128 a[24:27], v22 offset:49152
  ds_read_b128 a[28:31], v23 offset:49152
  buffer_load_dwordx4 v9, s[16:19], s59 offen offset:3072 nt lds
  s_nop 1
  v_mfma_f32_32x32x16_bf16 v[80:95], a[40:43], v[40:43], v[80:95]
  v_max3_f32 v24, v64, v65, v66
  v_max3_f32 v24, v24, v67, v68
  v_max3_f32 v24, v24, v69, v70
  v_max3_f32 v24, v24, v71, v72
  v_max3_f32 v24, v24, v73, v74
  v_max3_f32 v24, v24, v75, v76
  v_max3_f32 v24, v24, v77, v78
  v_max_f32 v24, v24, v79
  v_mov_b32 v25, v24
  s_nop 1
  v_permlane32_swap_b32 v24, v25
  s_nop 1
  v_max_f32 v24, v24, v25
  v_sub_f32 v96, 0xc1a00000, v24
  v_mov_b32 v97, v96
  v_mfma_f32_32x32x16_bf16 v[80:95], a[44:47], v[44:47], v[80:95]
  v_mov_b32 v98, v96
  v_mov_b32 v99, v96
  v_mov_b32 v100, v96
  v_mov_b32 v101, v96
  v_mov_b32 v102, v96
  v_mov_b32 v103, v96
  v_mov_b32 v104, v96
  v_mov_b32 v105, v96
  v_mov_b32 v106, v96
  v_mov_b32 v107, v96
  v_mov_b32 v108, v96
  v_mov_b32 v109, v96
  v_mov_b32 v110, v96
  v_mov_b32 v111, v96
  v_add_f32 v64, v64, v96
  v_mfma_f32_32x32x16_bf16 v[80:95], a[48:51], v[48:51], v[80:95]
  v_add_f32 v65, v65, v96
  v_add_f32 v66, v66, v96
  v_add_f32 v67, v67, v96
  v_add_f32 v68, v68, v96
  v_add_f32 v69, v69, v96
  v_add_f32 v70, v70, v96
  v_add_f32 v71, v71, v96
  v_add_f32 v72, v72, v96
  v_add_f32 v73, v73, v96
  v_add_f32 v74, v74, v96
  v_add_f32 v75, v75, v96
  v_add_f32 v76, v76, v96
  v_add_f32 v77, v77, v96
  v_add_f32 v78, v78, v96
  v_mfma_f32_32x32x16_bf16 v[80:95], a[52:55], v[52:55], v[80:95]
  v_add_f32 v79, v79, v96
  v_exp_f32 v24, v64
  v_exp_f32 v25, v65
  v_exp_f32 v26, v66
  v_cvt_pk_bf16_f32 v128, v24, v25
  v_exp_f32 v27, v67
  v_exp_f32 v24, v68
  v_cvt_pk_bf16_f32 v129, v26, v27
  v_exp_f32 v25, v69
  v_mfma_f32_32x32x16_bf16 v[80:95], a[56:59], v[56:59], v[80:95]
  v_exp_f32 v26, v70
  v_cvt_pk_bf16_f32 v130, v24, v25
  v_exp_f32 v27, v71
  v_exp_f32 v24, v72
  v_cvt_pk_bf16_f32 v131, v26, v27
  v_exp_f32 v25, v73
  v_exp_f32 v26, v74
  v_cvt_pk_bf16_f32 v132, v24, v25
  v_exp_f32 v27, v75
  v_mfma_f32_32x32x16_bf16 v[80:95], a[60:63], v[60:63], v[80:95]
  v_exp_f32 v24, v76
  v_cvt_pk_bf16_f32 v133, v26, v27
  v_exp_f32 v25, v77
  v_exp_f32 v26, v78
  v_cvt_pk_bf16_f32 v134, v24, v25
  v_exp_f32 v27, v79
  v_or3_b32 v15, v128, v129, v130
  v_cvt_pk_bf16_f32 v135, v26, v27
  s_waitcnt lgkmcnt(0)
  v_mfma_f32_32x32x16_bf16 v[112:127], a[0:3], v[32:35], v[96:111]
  ds_read_b128 a[32:35], v16 offset:57344
  v_mfma_f32_32x32x16_bf16 v[112:127], a[4:7], v[36:39], v[112:127]
  ds_read_b128 a[36:39], v17 offset:57344
  s_add_u32 m0, s38, 114688
  s_add_u32 s59, s97, 32768
  s_and_b32 s59, s59, 0x1ffff
  s_lshl1_add_u32 s59, s38, s59
  buffer_load_dwordx4 v6, s[16:19], s59 offen offset:0 nt lds
  s_nop 4
  v_mfma_f32_32x32x16_bf16 v[112:127], a[8:11], v[40:43], v[112:127]
  ds_read_b128 a[40:43], v18 offset:57344
  v_add_f32 v80, v80, v96
  v_add_f32 v81, v81, v96
  v_add_f32 v82, v82, v96
  v_add_f32 v83, v83, v96
  v_add_f32 v84, v84, v96
  v_add_f32 v85, v85, v96
  v_add_f32 v86, v86, v96
  v_add_f32 v87, v87, v96
  v_mfma_f32_32x32x16_bf16 v[112:127], a[12:15], v[44:47], v[112:127]
  ds_read_b128 a[44:47], v19 offset:57344
  buffer_load_dwordx4 v7, s[16:19], s59 offen offset:1024 nt lds
  v_add_f32 v88, v88, v96
  v_add_f32 v89, v89, v96
  v_add_f32 v90, v90, v96
  v_add_f32 v91, v91, v96
  v_add_f32 v92, v92, v96
  v_add_f32 v93, v93, v96
  v_add_f32 v94, v94, v96
  v_add_f32 v95, v95, v96
  v_mfma_f32_32x32x16_bf16 v[112:127], a[16:19], v[48:51], v[112:127]
  ds_read_b128 a[48:51], v20 offset:57344
  v_exp_f32 v24, v80
  v_exp_f32 v25, v81
  v_exp_f32 v26, v82
  v_cvt_pk_bf16_f32 v136, v24, v25
  v_exp_f32 v27, v83
  v_mfma_f32_32x32x16_bf16 v[112:127], a[20:23], v[52:55], v[112:127]
  ds_read_b128 a[52:55], v21 offset:57344
  v_exp_f32 v24, v84
  v_cvt_pk_bf16_f32 v137, v26, v27
  v_exp_f32 v25, v85
  v_exp_f32 v26, v86
  v_cvt_pk_bf16_f32 v138, v24, v25
  v_mfma_f32_32x32x16_bf16 v[112:127], a[24:27], v[56:59], v[112:127]
  ds_read_b128 a[56:59], v22 offset:57344
  v_exp_f32 v27, v87
  v_exp_f32 v24, v88
  v_cvt_pk_bf16_f32 v139, v26, v27
  v_exp_f32 v25, v89
  v_mfma_f32_32x32x16_bf16 v[112:127], a[28:31], v[60:63], v[112:127]
  ds_read_b128 a[60:63], v23 offset:57344
  v_exp_f32 v26, v90
  v_cvt_pk_bf16_f32 v140, v24, v25
  v_exp_f32 v27, v91
  v_exp_f32 v24, v92
  s_waitcnt vmcnt(26)
  s_barrier
  s_waitcnt lgkmcnt(4)
  v_mfma_f32_32x32x16_bf16 v[64:79], a[32:35], v[32:35], v[96:111]
  ds_read_b128 a[0:3], v16 offset:0
  v_cvt_pk_bf16_f32 v141, v26, v27
  v_exp_f32 v25, v93
  v_exp_f32 v26, v94
  v_cvt_pk_bf16_f32 v142, v24, v25
  v_exp_f32 v27, v95
  v_mfma_f32_32x32x16_bf16 v[64:79], a[36:39], v[36:39], v[64:79]
  ds_read_b128 a[4:7], v17 offset:0
  buffer_load_dwordx4 v8, s[16:19], s59 offen offset:2048 nt lds
  v_or3_b32 v15, v136, v137, v138
  v_cvt_pk_bf16_f32 v143, v26, v27
  v_or3_b32 v15, v15, v139, v140
  v_or3_b32 v15, v15, v141, v142
  v_bitop3_b32 v15, v15, v143, s67 bitop3:0xa8
  v_cmp_ne_u32 vcc, 0, v15
  v_mfma_f32_32x32x16_bf16 v[64:79], a[40:43], v[40:43], v[64:79]
  s_cbranch_vccnz L_rarev1_1
L_backv1_1:
  ds_read_b128 a[8:11], v18 offset:0
  v_exp_f32 v24, v112
  v_exp_f32 v25, v113
  v_exp_f32 v26, v114
  v_mfma_f32_32x32x16_bf16 v[64:79], a[44:47], v[44:47], v[64:79]
  ds_read_b128 a[12:15], v19 offset:0
  buffer_load_dwordx4 v9, s[16:19], s59 offen offset:3072 nt lds
  v_cvt_pk_bf16_f32 v144, v24, v25
  v_exp_f32 v27, v115
  v_exp_f32 v24, v116
  v_cvt_pk_bf16_f32 v145, v26, v27
  s_waitcnt lgkmcnt(4)
  v_mfma_f32_32x32x16_bf16 v[64:79], a[48:51], v[48:51], v[64:79]
  ds_read_b128 a[16:19], v20 offset:0
  v_exp_f32 v25, v117
  v_exp_f32 v26, v118
  v_cvt_pk_bf16_f32 v146, v24, v25
  v_exp_f32 v27, v119
  v_mfma_f32_32x32x16_bf16 v[64:79], a[52:55], v[52:55], v[64:79]
  ds_read_b128 a[20:23], v21 offset:0
  v_exp_f32 v24, v120
  v_cvt_pk_bf16_f32 v147, v26, v27
  v_exp_f32 v25, v121
  v_exp_f32 v26, v122
  v_mfma_f32_32x32x16_bf16 v[64:79], a[56:59], v[56:59], v[64:79]
  ds_read_b128 a[24:27], v22 offset:0
  v_cvt_pk_bf16_f32 v148, v24, v25
  v_exp_f32 v27, v123
  v_exp_f32 v24, v124
  v_mfma_f32_32x32x16_bf16 v[64:79], a[60:63], v[60:63], v[64:79]
  ds_read_b128 a[28:31], v23 offset:0
  v_cvt_pk_bf16_f32 v149, v26, v27
  v_exp_f32 v25, v125
  v_exp_f32 v26, v126
  s_waitcnt lgkmcnt(4)
  v_mfma_f32_32x32x16_bf16 v[80:95], a[0:3], v[32:35], v[96:111]
  ds_read_b128 a[32:35], v16 offset:8192
  v_cvt_pk_bf16_f32 v150, v24, v25
  v_exp_f32 v27, v127
  v_or3_b32 v15, v144, v145, v146
  v_cvt_pk_bf16_f32 v151, v26, v27
  v_mfma_f32_32x32x16_bf16 v[80:95], a[4:7], v[36:39], v[80:95]
  ds_read_b128 a[36:39], v17 offset:8192
  v_or3_b32 v15, v15, v147, v148
  v_or3_b32 v15, v15, v149, v150
  v_bitop3_b32 v15, v15, v151, s67 bitop3:0xa8
  v_cmp_ne_u32 vcc, 0, v15
  v_mfma_f32_32x32x16_bf16 v[80:95], a[8:11], v[40:43], v[80:95]
  s_cbranch_vccnz L_rarev1_2
L_backv1_2:
  ds_read_b128 a[40:43], v18 offset:8192
  v_exp_f32 v24, v64
  v_exp_f32 v25, v65
  v_exp_f32 v26, v66
  v_mfma_f32_32x32x16_bf16 v[80:95], a[12:15], v[44:47], v[80:95]
  ds_read_b128 a[44:47], v19 offset:8192
  v_cvt_pk_bf16_f32 v152, v24, v25
  v_exp_f32 v27, v67
  v_exp_f32 v24, v68
  v_cvt_pk_bf16_f32 v153, v26, v27
  s_waitcnt lgkmcnt(4)
  v_mfma_f32_32x32x16_bf16 v[80:95], a[16:19], v[48:51], v[80:95]
  ds_read_b128 a[48:51], v20 offset:8192
  v_exp_f32 v25, v69
  v_exp_f32 v26, v70
  v_cvt_pk_bf16_f32 v154, v24, v25
  v_exp_f32 v27, v71
  v_mfma_f32_32x32x16_bf16 v[80:95], a[20:23], v[52:55], v[80:95]
  ds_read_b128 a[52:55], v21 offset:8192
  v_exp_f32 v24, v72
  v_cvt_pk_bf16_f32 v155, v26, v27
  v_exp_f32 v25, v73
  v_exp_f32 v26, v74
  v_mfma_f32_32x32x16_bf16 v[80:95], a[24:27], v[56:59], v[80:95]
  ds_read_b128 a[56:59], v22 offset:8192
  v_cvt_pk_bf16_f32 v156, v24, v25
  v_exp_f32 v27, v75
  v_exp_f32 v24, v76
  v_mfma_f32_32x32x16_bf16 v[80:95], a[28:31], v[60:63], v[80:95]
  ds_read_b128 a[60:63], v23 offset:8192
  v_cvt_pk_bf16_f32 v157, v26, v27
  v_exp_f32 v25, v77
  v_exp_f32 v26, v78
  s_waitcnt vmcnt(24)
  s_barrier
  s_waitcnt lgkmcnt(4)
  v_mfma_f32_32x32x16_bf16 v[112:127], a[32:35], v[32:35], v[96:111]
  ds_read_b128 a[0:3], v16 offset:16384
  v_cvt_pk_bf16_f32 v158, v24, v25
  v_exp_f32 v27, v79
  v_or3_b32 v15, v152, v153, v154
  v_cvt_pk_bf16_f32 v159, v26, v27
  v_mfma_f32_32x32x16_bf16 v[112:127], a[36:39], v[36:39], v[112:127]
  ds_read_b128 a[4:7], v17 offset:16384
  s_add_u32 m0, s38, 65536
  s_add_u32 s59, s97, 65536
  s_and_b32 s59, s59, 0x1ffff
  s_lshl1_add_u32 s59, s38, s59
  buffer_load_dwordx4 v6, s[16:19], s59 offen offset:0 nt lds
  v_or3_b32 v15, v15, v155, v156
  v_or3_b32 v15, v15, v157, v158
  v_bitop3_b32 v15, v15, v159, s67 bitop3:0xa8
  v_cmp_ne_u32 vcc, 0, v15
  v_mfma_f32_32x32x16_bf16 v[112:127], a[40:43], v[40:43], v[112:127]
  s_cbranch_vccnz L_rarev1_3
L_backv1_3:
  ds_read_b128 a[8:11], v18 offset:16384
  v_exp_f32 v24, v80
  v_exp_f32 v25, v81
  v_exp_f32 v26, v82
  v_mfma_f32_32x32x16_bf16 v[112:127], a[44:47], v[44:47], v[112:127]
  ds_read_b128 a[12:15], v19 offset:16384
  buffer_load_dwordx4 v7, s[16:19], s59 offen offset:1024 nt lds
  v_cvt_pk_bf16_f32 v160, v24, v25
  v_exp_f32 v27, v83
  v_exp_f32 v24, v84
  v_cvt_pk_bf16_f32 v161, v26, v27
  s_waitcnt lgkmcnt(4)
  v_mfma_f32_32x32x16_bf16 v[112:127], a[48:51], v[48:51], v[112:127]
  ds_read_b128 a[16:19], v20 offset:16384
  v_exp_f32 v25, v85
  v_exp_f32 v26, v86
  v_cvt_pk_bf16_f32 v162, v24, v25
  v_exp_f32 v27, v87
  v_mfma_f32_32x32x16_bf16 v[112:127], a[52:55], v[52:55], v[112:127]
  ds_read_b128 a[20:23], v21 offset:16384
  v_exp_f32 v24, v88
  v_cvt_pk_bf16_f32 v163, v26, v27
  v_exp_f32 v25, v89
  v_exp_f32 v26, v90
  v_mfma_f32_32x32x16_bf16 v[112:127], a[56:59], v[56:59], v[112:127]
  ds_read_b128 a[24:27], v22 offset:16384
  v_cvt_pk_bf16_f32 v164, v24, v25
  v_exp_f32 v27, v91
  v_exp_f32 v24, v92
  v_mfma_f32_32x32x16_bf16 v[112:127], a[60:63], v[60:63], v[112:127]
  ds_read_b128 a[28:31], v23 offset:16384
  v_cvt_pk_bf16_f32 v165, v26, v27
  v_exp_f32 v25, v93
  v_exp_f32 v26, v94
  s_waitcnt lgkmcnt(4)
  v_mfma_f32_32x32x16_bf16 v[64:79], a[0:3], v[32:35], v[96:111]
  ds_read_b128 a[32:35], v16 offset:24576
  v_cvt_pk_bf16_f32 v166, v24, v25
  v_exp_f32 v27, v95
  v_or3_b32 v15, v160, v161, v162
  v_cvt_pk_bf16_f32 v167, v26, v27
  v_mfma_f32_32x32x16_bf16 v[64:79], a[4:7], v[36:39], v[64:79]
  ds_read_b128 a[36:39], v17 offset:24576
  buffer_load_dwordx4 v8, s[16:19], s59 offen offset:2048 nt lds
  v_or3_b32 v15, v15, v163, v164
  v_or3_b32 v15, v15, v165, v166
  v_bitop3_b32 v15, v15, v167, s67 bitop3:0xa8
  v_cmp_ne_u32 vcc, 0, v15
  v_mfma_f32_32x32x16_bf16 v[64:79], a[8:11], v[40:43], v[64:79]
  s_cbranch_vccnz L_rarev1_4
L_backv1_4:
  ds_read_b128 a[40:43], v18 offset:24576
  v_exp_f32 v24, v112
  v_exp_f32 v25, v113
  v_exp_f32 v26, v114
  v_mfma_f32_32x32x16_bf16 v[64:79], a[12:15], v[44:47], v[64:79]
  ds_read_b128 a[44:47], v19 offset:24576
  buffer_load_dwordx4 v9, s[16:19], s59 offen offset:3072 nt lds
  v_cvt_pk_bf16_f32 v168, v24, v25
  v_exp_f32 v27, v115
  v_exp_f32 v24, v116
  v_cvt_pk_bf16_f32 v169, v26, v27
  s_waitcnt lgkmcnt(4)
  v_mfma_f32_32x32x16_bf16 v[64:79], a[16:19], v[48:51], v[64:79]
  ds_read_b128 a[48:51], v20 offset:24576
  v_exp_f32 v25, v117
  v_exp_f32 v26, v118
  v_cvt_pk_bf16_f32 v170, v24, v25
  v_exp_f32 v27, v119
  v_mfma_f32_32x32x16_bf16 v[64:79], a[20:23], v[52:55], v[64:79]
  ds_read_b128 a[52:55], v21 offset:24576
  v_exp_f32 v24, v120
  v_cvt_pk_bf16_f32 v171, v26, v27
  v_exp_f32 v25, v121
  v_exp_f32 v26, v122
  v_mfma_f32_32x32x16_bf16 v[64:79], a[24:27], v[56:59], v[64:79]
  ds_read_b128 a[56:59], v22 offset:24576
  v_cvt_pk_bf16_f32 v172, v24, v25
  v_exp_f32 v27, v123
  v_exp_f32 v24, v124
  v_mfma_f32_32x32x16_bf16 v[64:79], a[28:31], v[60:63], v[64:79]
  ds_read_b128 a[60:63], v23 offset:24576
  v_cvt_pk_bf16_f32 v173, v26, v27
  v_exp_f32 v25, v125
  v_exp_f32 v26, v126
  s_waitcnt vmcnt(24)
  s_barrier
  s_waitcnt lgkmcnt(4)
  v_mfma_f32_32x32x16_bf16 v[80:95], a[32:35], v[32:35], v[96:111]
  v_add_u32 v16, 4294934528, v16
  v_add_u32 v17, 4294934528, v17
  v_cvt_pk_bf16_f32 v174, v24, v25
  v_exp_f32 v27, v127
  v_or3_b32 v15, v168, v169, v170
  v_cvt_pk_bf16_f32 v175, v26, v27
  v_mfma_f32_32x32x16_bf16 v[80:95], a[36:39], v[36:39], v[80:95]
  v_add_u32 v18, 4294934528, v18
  v_add_u32 v19, 4294934528, v19
  s_add_u32 m0, s38, 81920
  s_add_u32 s59, s97, 98304
  s_and_b32 s59, s59, 0x1ffff
  s_lshl1_add_u32 s59, s38, s59
  buffer_load_dwordx4 v6, s[16:19], s59 offen offset:0 nt lds
  v_or3_b32 v15, v15, v171, v172
  v_or3_b32 v15, v15, v173, v174
  v_bitop3_b32 v15, v15, v175, s67 bitop3:0xa8
  v_cmp_ne_u32 vcc, 0, v15
  v_mfma_f32_32x32x16_bf16 v[80:95], a[40:43], v[40:43], v[80:95]
  s_cbranch_vccnz L_rarev1_5
L_backv1_5:
  v_add_u32 v20, 4294934528, v20
  v_add_u32 v21, 4294934528, v21
  v_exp_f32 v24, v64
  v_exp_f32 v25, v65
  v_exp_f32 v26, v66
  v_mfma_f32_32x32x16_bf16 v[80:95], a[44:47], v[44:47], v[80:95]
  v_add_u32 v22, 4294934528, v22
  v_add_u32 v23, 4294934528, v23
  buffer_load_dwordx4 v7, s[16:19], s59 offen offset:1024 nt lds
  v_cvt_pk_bf16_f32 v176, v24, v25
  v_exp_f32 v27, v67
  v_exp_f32 v24, v68
  v_cvt_pk_bf16_f32 v177, v26, v27
  s_waitcnt lgkmcnt(0)
  v_mfma_f32_32x32x16_bf16 v[80:95], a[48:51], v[48:51], v[80:95]
  ds_read_b128 a[0:3], v16 offset:0
  ds_read_b128 a[4:7], v17 offset:0
  v_exp_f32 v25, v69
  v_exp_f32 v26, v70
  v_cvt_pk_bf16_f32 v178, v24, v25
  v_exp_f32 v27, v71
  v_mfma_f32_32x32x16_bf16 v[80:95], a[52:55], v[52:55], v[80:95]
  ds_read_b128 a[8:11], v18 offset:0
  ds_read_b128 a[12:15], v19 offset:0
  v_exp_f32 v24, v72
  v_cvt_pk_bf16_f32 v179, v26, v27
  v_exp_f32 v25, v73
  v_exp_f32 v26, v74
  v_mfma_f32_32x32x16_bf16 v[80:95], a[56:59], v[56:59], v[80:95]
  ds_read_b128 a[16:19], v20 offset:0
  ds_read_b128 a[20:23], v21 offset:0
  v_cvt_pk_bf16_f32 v180, v24, v25
  v_exp_f32 v27, v75
  v_exp_f32 v24, v76
  v_mfma_f32_32x32x16_bf16 v[80:95], a[60:63], v[60:63], v[80:95]
  ds_read_b128 a[24:27], v22 offset:0
  ds_read_b128 a[28:31], v23 offset:0
  v_cvt_pk_bf16_f32 v181, v26, v27
  v_exp_f32 v25, v77
  v_exp_f32 v26, v78
  s_waitcnt lgkmcnt(4)
  v_mfma_f32_32x32x16_bf16 v[112:127], a[0:3], v[32:35], v[96:111]
  ds_read_b128 a[32:35], v16 offset:8192
  v_cvt_pk_bf16_f32 v182, v24, v25
  v_exp_f32 v27, v79
  v_or3_b32 v15, v176, v177, v178
  v_cvt_pk_bf16_f32 v183, v26, v27
  v_mfma_f32_32x32x16_bf16 v[112:127], a[4:7], v[36:39], v[112:127]
  ds_read_b128 a[36:39], v17 offset:8192
  buffer_load_dwordx4 v8, s[16:19], s59 offen offset:2048 nt lds
  v_or3_b32 v15, v15, v179, v180
  v_or3_b32 v15, v15, v181, v182
  v_bitop3_b32 v15, v15, v183, s67 bitop3:0xa8
  v_cmp_ne_u32 vcc, 0, v15
  v_mfma_f32_32x32x16_bf16 v[112:127], a[8:11], v[40:43], v[112:127]
  s_cbranch_vccnz L_rarev1_6
L_backv1_6:
  ds_read_b128 a[40:43], v18 offset:8192
  v_exp_f32 v24, v80
  v_exp_f32 v25, v81
  v_exp_f32 v26, v82
  v_mfma_f32_32x32x16_bf16 v[112:127], a[12:15], v[44:47], v[112:127]
  ds_read_b128 a[44:47], v19 offset:8192
  buffer_load_dwordx4 v9, s[16:19], s59 offen offset:3072 nt lds
  v_cvt_pk_bf16_f32 v184, v24, v25
  v_exp_f32 v27, v83
  v_exp_f32 v24, v84
  v_cvt_pk_bf16_f32 v185, v26, v27
  s_waitcnt lgkmcnt(4)
  v_mfma_f32_32x32x16_bf16 v[112:127], a[16:19], v[48:51], v[112:127]
  ds_read_b128 a[48:51], v20 offset:8192
  v_exp_f32 v25, v85
  v_exp_f32 v26, v86
  v_cvt_pk_bf16_f32 v186, v24, v25
  v_exp_f32 v27, v87
  v_mfma_f32_32x32x16_bf16 v[112:127], a[20:23], v[52:55], v[112:127]
  ds_read_b128 a[52:55], v21 offset:8192
  v_exp_f32 v24, v88
  v_cvt_pk_bf16_f32 v187, v26, v27
  v_exp_f32 v25, v89
  v_exp_f32 v26, v90
  v_mfma_f32_32x32x16_bf16 v[112:127], a[24:27], v[56:59], v[112:127]
  ds_read_b128 a[56:59], v22 offset:8192
  v_cvt_pk_bf16_f32 v188, v24, v25
  v_exp_f32 v27, v91
  v_exp_f32 v24, v92
  v_mfma_f32_32x32x16_bf16 v[112:127], a[28:31], v[60:63], v[112:127]
  ds_read_b128 a[60:63], v23 offset:8192
  v_cvt_pk_bf16_f32 v189, v26, v27
  v_exp_f32 v25, v93
  v_exp_f32 v26, v94
  s_waitcnt vmcnt(24)
  s_barrier
  s_waitcnt lgkmcnt(4)
  v_mfma_f32_32x32x16_bf16 v[64:79], a[32:35], v[32:35], v[96:111]
  ds_read_b128 a[0:3], v16 offset:16384
  v_cvt_pk_bf16_f32 v190, v24, v25
  v_exp_f32 v27, v95
  v_or3_b32 v15, v184, v185, v186
  v_cvt_pk_bf16_f32 v191, v26, v27
  v_mfma_f32_32x32x16_bf16 v[64:79], a[36:39], v[36:39], v[64:79]
  ds_read_b128 a[4:7], v17 offset:16384
  s_add_u32 m0, s38, 32768
  s_add_u32 s59, s97, 128
  s_and_b32 s59, s59, 0x1ffff
  s_lshl1_add_u32 s59, s38, s59
  buffer_load_dwordx4 v6, s[16:19], s59 offen offset:0 nt lds
  v_or3_b32 v15, v15, v187, v188
  v_or3_b32 v15, v15, v189, v190
  v_bitop3_b32 v15, v15, v191, s67 bitop3:0xa8
  v_cmp_ne_u32 vcc, 0, v15
  v_mfma_f32_32x32x16_bf16 v[64:79], a[40:43], v[40:43], v[64:79]
  s_cbranch_vccnz L_rarev1_7
L_backv1_7:
  ds_read_b128 a[8:11], v18 offset:16384
  v_exp_f32 v24, v112
  v_exp_f32 v25, v113
  v_exp_f32 v26, v114
  v_mfma_f32_32x32x16_bf16 v[64:79], a[44:47], v[44:47], v[64:79]
  ds_read_b128 a[12:15], v19 offset:16384
  buffer_load_dwordx4 v7, s[16:19], s59 offen offset:1024 nt lds
  v_cvt_pk_bf16_f32 v192, v24, v25
  v_exp_f32 v27, v115
  v_exp_f32 v24, v116
  v_cvt_pk_bf16_f32 v193, v26, v27
  s_waitcnt lgkmcnt(4)
  v_mfma_f32_32x32x16_bf16 v[64:79], a[48:51], v[48:51], v[64:79]
  ds_read_b128 a[16:19], v20 offset:16384
  v_exp_f32 v25, v117
  v_exp_f32 v26, v118
  v_cvt_pk_bf16_f32 v194, v24, v25
  v_exp_f32 v27, v119
  v_mfma_f32_32x32x16_bf16 v[64:79], a[52:55], v[52:55], v[64:79]
  ds_read_b128 a[20:23], v21 offset:16384
  v_exp_f32 v24, v120
  v_cvt_pk_bf16_f32 v195, v26, v27
  v_exp_f32 v25, v121
  v_exp_f32 v26, v122
  v_mfma_f32_32x32x16_bf16 v[64:79], a[56:59], v[56:59], v[64:79]
  ds_read_b128 a[24:27], v22 offset:16384
  v_cvt_pk_bf16_f32 v196, v24, v25
  v_exp_f32 v27, v123
  v_exp_f32 v24, v124
  v_mfma_f32_32x32x16_bf16 v[64:79], a[60:63], v[60:63], v[64:79]
  ds_read_b128 a[28:31], v23 offset:16384
  v_cvt_pk_bf16_f32 v197, v26, v27
  v_exp_f32 v25, v125
  v_exp_f32 v26, v126
  s_waitcnt lgkmcnt(4)
  v_mfma_f32_32x32x16_bf16 v[80:95], a[0:3], v[32:35], v[96:111]
  ds_read_b128 a[32:35], v16 offset:24576
  v_cvt_pk_bf16_f32 v198, v24, v25
  v_exp_f32 v27, v127
  v_or3_b32 v15, v192, v193, v194
  v_cvt_pk_bf16_f32 v199, v26, v27
  v_mfma_f32_32x32x16_bf16 v[80:95], a[4:7], v[36:39], v[80:95]
  ds_read_b128 a[36:39], v17 offset:24576
  buffer_load_dwordx4 v8, s[16:19], s59 offen offset:2048 nt lds
  v_or3_b32 v15, v15, v195, v196
  v_or3_b32 v15, v15, v197, v198
  v_bitop3_b32 v15, v15, v199, s67 bitop3:0xa8
  v_cmp_ne_u32 vcc, 0, v15
  v_mfma_f32_32x32x16_bf16 v[80:95], a[8:11], v[40:43], v[80:95]
  s_cbranch_vccnz L_rarev1_8
L_backv1_8:
  ds_read_b128 a[40:43], v18 offset:24576
  v_exp_f32 v24, v64
  v_exp_f32 v25, v65
  v_exp_f32 v26, v66
  v_mfma_f32_32x32x16_bf16 v[80:95], a[12:15], v[44:47], v[80:95]
  ds_read_b128 a[44:47], v19 offset:24576
  buffer_load_dwordx4 v9, s[16:19], s59 offen offset:3072 nt lds
  v_cvt_pk_bf16_f32 v200, v24, v25
  v_exp_f32 v27, v67
  v_exp_f32 v24, v68
  v_cvt_pk_bf16_f32 v201, v26, v27
  s_waitcnt lgkmcnt(4)
  v_mfma_f32_32x32x16_bf16 v[80:95], a[16:19], v[48:51], v[80:95]
  ds_read_b128 a[48:51], v20 offset:24576
  v_exp_f32 v25, v69
  v_exp_f32 v26, v70
  v_cvt_pk_bf16_f32 v202, v24, v25
  v_exp_f32 v27, v71
  v_mfma_f32_32x32x16_bf16 v[80:95], a[20:23], v[52:55], v[80:95]
  ds_read_b128 a[52:55], v21 offset:24576
  v_exp_f32 v24, v72
  v_cvt_pk_bf16_f32 v203, v26, v27
  v_exp_f32 v25, v73
  v_exp_f32 v26, v74
  v_mfma_f32_32x32x16_bf16 v[80:95], a[24:27], v[56:59], v[80:95]
  ds_read_b128 a[56:59], v22 offset:24576
  v_cvt_pk_bf16_f32 v204, v24, v25
  v_exp_f32 v27, v75
  v_exp_f32 v24, v76
  v_mfma_f32_32x32x16_bf16 v[80:95], a[28:31], v[60:63], v[80:95]
  ds_read_b128 a[60:63], v23 offset:24576
  v_cvt_pk_bf16_f32 v205, v26, v27
  v_exp_f32 v25, v77
  v_exp_f32 v26, v78
  s_waitcnt vmcnt(24)
  s_barrier
  s_waitcnt lgkmcnt(4)
  v_mfma_f32_32x32x16_bf16 v[112:127], a[32:35], v[32:35], v[96:111]
  v_add_u32 v16, 131072, v16
  v_add_u32 v17, 131072, v17
  v_cvt_pk_bf16_f32 v206, v24, v25
  v_exp_f32 v27, v79
  v_or3_b32 v15, v200, v201, v202
  v_cvt_pk_bf16_f32 v207, v26, v27
  v_mfma_f32_32x32x16_bf16 v[112:127], a[36:39], v[36:39], v[112:127]
  v_add_u32 v18, 131072, v18
  v_add_u32 v19, 131072, v19
  s_add_u32 m0, s38, 49152
  s_add_u32 s59, s97, 32896
  s_and_b32 s59, s59, 0x1ffff
  s_lshl1_add_u32 s59, s38, s59
  buffer_load_dwordx4 v6, s[16:19], s59 offen offset:0 nt lds
  v_or3_b32 v15, v15, v203, v204
  v_or3_b32 v15, v15, v205, v206
  v_bitop3_b32 v15, v15, v207, s67 bitop3:0xa8
  v_cmp_ne_u32 vcc, 0, v15
  v_mfma_f32_32x32x16_bf16 v[112:127], a[40:43], v[40:43], v[112:127]
  s_cbranch_vccnz L_rarev1_9
L_backv1_9:
  v_add_u32 v20, 131072, v20
  v_add_u32 v21, 131072, v21
  v_exp_f32 v24, v80
  v_exp_f32 v25, v81
  v_exp_f32 v26, v82
  v_mfma_f32_32x32x16_bf16 v[112:127], a[44:47], v[44:47], v[112:127]
  v_add_u32 v22, 131072, v22
  v_add_u32 v23, 131072, v23
  buffer_load_dwordx4 v7, s[16:19], s59 offen offset:1024 nt lds
  v_cvt_pk_bf16_f32 v208, v24, v25
  v_exp_f32 v27, v83
  v_exp_f32 v24, v84
  v_cvt_pk_bf16_f32 v209, v26, v27
  s_waitcnt lgkmcnt(0)
  v_mfma_f32_32x32x16_bf16 v[112:127], a[48:51], v[48:51], v[112:127]
  ds_read_b128 a[0:3], v16 offset:0
  ds_read_b128 a[4:7], v17 offset:0
  v_exp_f32 v25, v85
  v_exp_f32 v26, v86
  v_cvt_pk_bf16_f32 v210, v24, v25
  v_exp_f32 v27, v87
  v_mfma_f32_32x32x16_bf16 v[112:127], a[52:55], v[52:55], v[112:127]
  ds_read_b128 a[8:11], v18 offset:0
  ds_read_b128 a[12:15], v19 offset:0
  v_exp_f32 v24, v88
  v_cvt_pk_bf16_f32 v211, v26, v27
  v_exp_f32 v25, v89
  v_exp_f32 v26, v90
  v_mfma_f32_32x32x16_bf16 v[112:127], a[56:59], v[56:59], v[112:127]
  ds_read_b128 a[16:19], v20 offset:0
  ds_read_b128 a[20:23], v21 offset:0
  v_cvt_pk_bf16_f32 v212, v24, v25
  v_exp_f32 v27, v91
  v_exp_f32 v24, v92
  v_mfma_f32_32x32x16_bf16 v[112:127], a[60:63], v[60:63], v[112:127]
  ds_read_b128 a[24:27], v22 offset:0
  ds_read_b128 a[28:31], v23 offset:0
  v_cvt_pk_bf16_f32 v213, v26, v27
  v_exp_f32 v25, v93
  v_exp_f32 v26, v94
  s_waitcnt lgkmcnt(4)
  v_mfma_f32_32x32x16_bf16 v[64:79], a[0:3], v[32:35], v[96:111]
  ds_read_b128 a[32:35], v16 offset:8192
  v_cvt_pk_bf16_f32 v214, v24, v25
  v_exp_f32 v27, v95
  v_or3_b32 v15, v208, v209, v210
  v_cvt_pk_bf16_f32 v215, v26, v27
  v_mfma_f32_32x32x16_bf16 v[64:79], a[4:7], v[36:39], v[64:79]
  ds_read_b128 a[36:39], v17 offset:8192
  buffer_load_dwordx4 v8, s[16:19], s59 offen offset:2048 nt lds
  v_or3_b32 v15, v15, v211, v212
  v_or3_b32 v15, v15, v213, v214
  v_bitop3_b32 v15, v15, v215, s67 bitop3:0xa8
  v_cmp_ne_u32 vcc, 0, v15
  v_mfma_f32_32x32x16_bf16 v[64:79], a[8:11], v[40:43], v[64:79]
  s_cbranch_vccnz L_rarev1_10
L_backv1_10:
  ds_read_b128 a[40:43], v18 offset:8192
  v_exp_f32 v24, v112
  v_exp_f32 v25, v113
  v_exp_f32 v26, v114
  v_mfma_f32_32x32x16_bf16 v[64:79], a[12:15], v[44:47], v[64:79]
  ds_read_b128 a[44:47], v19 offset:8192
  buffer_load_dwordx4 v9, s[16:19], s59 offen offset:3072 nt lds
  v_cvt_pk_bf16_f32 v216, v24, v25
  v_exp_f32 v27, v115
  v_exp_f32 v24, v116
  v_cvt_pk_bf16_f32 v217, v26, v27
  s_waitcnt lgkmcnt(4)
  v_mfma_f32_32x32x16_bf16 v[64:79], a[16:19], v[48:51], v[64:79]
  ds_read_b128 a[48:51], v20 offset:8192
  v_exp_f32 v25, v117
  v_exp_f32 v26, v118
  v_cvt_pk_bf16_f32 v218, v24, v25
  v_exp_f32 v27, v119
  v_mfma_f32_32x32x16_bf16 v[64:79], a[20:23], v[52:55], v[64:79]
  ds_read_b128 a[52:55], v21 offset:8192
  v_exp_f32 v24, v120
  v_cvt_pk_bf16_f32 v219, v26, v27
  v_exp_f32 v25, v121
  v_exp_f32 v26, v122
  v_mfma_f32_32x32x16_bf16 v[64:79], a[24:27], v[56:59], v[64:79]
  ds_read_b128 a[56:59], v22 offset:8192
  v_cvt_pk_bf16_f32 v220, v24, v25
  v_exp_f32 v27, v123
  v_exp_f32 v24, v124
  v_mfma_f32_32x32x16_bf16 v[64:79], a[28:31], v[60:63], v[64:79]
  ds_read_b128 a[60:63], v23 offset:8192
  v_cvt_pk_bf16_f32 v221, v26, v27
  v_exp_f32 v25, v125
  v_exp_f32 v26, v126
  s_waitcnt vmcnt(24)
  s_barrier
  s_waitcnt lgkmcnt(4)
  v_mfma_f32_32x32x16_bf16 v[80:95], a[32:35], v[32:35], v[96:111]
  ds_read_b128 a[0:3], v16 offset:16384
  v_cvt_pk_bf16_f32 v222, v24, v25
  v_exp_f32 v27, v127
  v_or3_b32 v15, v216, v217, v218
  v_cvt_pk_bf16_f32 v223, v26, v27
  v_mfma_f32_32x32x16_bf16 v[80:95], a[36:39], v[36:39], v[80:95]
  ds_read_b128 a[4:7], v17 offset:16384
  s_mul_i32 s59, s6, 81920
  s_lshl_b32 s60, s39, 2
  s_add_u32 s59, s59, s60
  buffer_load_dwordx4 a[208:211], v10, s[24:27], s59 offen offset:0
  v_or3_b32 v15, v15, v219, v220
  v_or3_b32 v15, v15, v221, v222
  v_bitop3_b32 v15, v15, v223, s67 bitop3:0xa8
  v_cmp_ne_u32 vcc, 0, v15
  v_mfma_f32_32x32x16_bf16 v[80:95], a[40:43], v[40:43], v[80:95]
  s_cbranch_vccnz L_rarev1_11
L_backv1_11:
  ds_read_b128 a[8:11], v18 offset:16384
  v_exp_f32 v24, v64
  v_exp_f32 v25, v65
  v_exp_f32 v26, v66
  v_mfma_f32_32x32x16_bf16 v[80:95], a[44:47], v[44:47], v[80:95]
  ds_read_b128 a[12:15], v19 offset:16384
  buffer_load_dwordx4 a[212:215], v11, s[24:27], s59 offen offset:1024
  v_cvt_pk_bf16_f32 v224, v24, v25
  v_exp_f32 v27, v67
  v_exp_f32 v24, v68
  v_cvt_pk_bf16_f32 v225, v26, v27
  s_waitcnt lgkmcnt(4)
  v_mfma_f32_32x32x16_bf16 v[80:95], a[48:51], v[48:51], v[80:95]
  ds_read_b128 a[16:19], v20 offset:16384
  v_exp_f32 v25, v69
  v_exp_f32 v26, v70
  v_cvt_pk_bf16_f32 v226, v24, v25
  v_exp_f32 v27, v71
  v_mfma_f32_32x32x16_bf16 v[80:95], a[52:55], v[52:55], v[80:95]
  ds_read_b128 a[20:23], v21 offset:16384
  v_exp_f32 v24, v72
  v_cvt_pk_bf16_f32 v227, v26, v27
  v_exp_f32 v25, v73
  v_exp_f32 v26, v74
  v_mfma_f32_32x32x16_bf16 v[80:95], a[56:59], v[56:59], v[80:95]
  ds_read_b128 a[24:27], v22 offset:16384
  v_cvt_pk_bf16_f32 v228, v24, v25
  v_exp_f32 v27, v75
  v_exp_f32 v24, v76
  v_mfma_f32_32x32x16_bf16 v[80:95], a[60:63], v[60:63], v[80:95]
  ds_read_b128 a[28:31], v23 offset:16384
  v_cvt_pk_bf16_f32 v229, v26, v27
  v_exp_f32 v25, v77
  v_exp_f32 v26, v78
  s_waitcnt lgkmcnt(4)
  v_mfma_f32_32x32x16_bf16 v[112:127], a[0:3], v[32:35], v[96:111]
  ds_read_b128 a[32:35], v16 offset:24576
  v_cvt_pk_bf16_f32 v230, v24, v25
  v_exp_f32 v27, v79
  v_or3_b32 v15, v224, v225, v226
  v_cvt_pk_bf16_f32 v231, v26, v27
  v_mfma_f32_32x32x16_bf16 v[112:127], a[4:7], v[36:39], v[112:127]
  ds_read_b128 a[36:39], v17 offset:24576
  buffer_load_dwordx4 a[216:219], v12, s[24:27], s59 offen offset:2048
  v_or3_b32 v15, v15, v227, v228
  v_or3_b32 v15, v15, v229, v230
  v_bitop3_b32 v15, v15, v231, s67 bitop3:0xa8
  v_cmp_ne_u32 vcc, 0, v15
  v_mfma_f32_32x32x16_bf16 v[112:127], a[8:11], v[40:43], v[112:127]
  s_cbranch_vccnz L_rarev1_12
L_backv1_12:
  ds_read_b128 a[40:43], v18 offset:24576
  v_exp_f32 v24, v80
  v_exp_f32 v25, v81
  v_exp_f32 v26, v82
  v_mfma_f32_32x32x16_bf16 v[112:127], a[12:15], v[44:47], v[112:127]
  ds_read_b128 a[44:47], v19 offset:24576
  buffer_load_dwordx4 a[220:223], v13, s[24:27], s59 offen offset:3072
  v_cvt_pk_bf16_f32 v232, v24, v25
  v_exp_f32 v27, v83
  v_exp_f32 v24, v84
  v_cvt_pk_bf16_f32 v233, v26, v27
  s_waitcnt lgkmcnt(4)
  v_mfma_f32_32x32x16_bf16 v[112:127], a[16:19], v[48:51], v[112:127]
  ds_read_b128 a[48:51], v20 offset:24576
  v_exp_f32 v25, v85
  v_exp_f32 v26, v86
  v_cvt_pk_bf16_f32 v234, v24, v25
  v_exp_f32 v27, v87
  v_mfma_f32_32x32x16_bf16 v[112:127], a[20:23], v[52:55], v[112:127]
  ds_read_b128 a[52:55], v21 offset:24576
  v_exp_f32 v24, v88
  v_cvt_pk_bf16_f32 v235, v26, v27
  v_exp_f32 v25, v89
  v_exp_f32 v26, v90
  v_mfma_f32_32x32x16_bf16 v[112:127], a[24:27], v[56:59], v[112:127]
  ds_read_b128 a[56:59], v22 offset:24576
  v_cvt_pk_bf16_f32 v236, v24, v25
  v_exp_f32 v27, v91
  v_exp_f32 v24, v92
  v_mfma_f32_32x32x16_bf16 v[112:127], a[28:31], v[60:63], v[112:127]
  ds_read_b128 a[60:63], v23 offset:24576
  v_cvt_pk_bf16_f32 v237, v26, v27
  v_exp_f32 v25, v93
  v_exp_f32 v26, v94
  s_waitcnt lgkmcnt(4)
  v_mfma_f32_32x32x16_bf16 v[64:79], a[32:35], v[32:35], v[96:111]
  v_cvt_pk_bf16_f32 v238, v24, v25
  v_exp_f32 v27, v95
  v_or3_b32 v15, v232, v233, v234
  v_cvt_pk_bf16_f32 v239, v26, v27
  v_mfma_f32_32x32x16_bf16 v[64:79], a[36:39], v[36:39], v[64:79]
  buffer_load_dwordx4 a[224:227], v14, s[24:27], s59 offen offset:0
  v_or3_b32 v15, v15, v235, v236
  v_or3_b32 v15, v15, v237, v238
  v_bitop3_b32 v15, v15, v239, s67 bitop3:0xa8
  v_cmp_ne_u32 vcc, 0, v15
  s_nop 7
  v_mfma_f32_32x32x16_bf16 v[64:79], a[40:43], v[40:43], v[64:79]
  s_cbranch_vccnz L_rarev1_13
L_backv1_13:
  v_exp_f32 v24, v112
  v_exp_f32 v25, v113
  v_exp_f32 v26, v114
  v_cvt_pk_bf16_f32 v240, v24, v25
  v_exp_f32 v27, v115
  v_mfma_f32_32x32x16_bf16 v[64:79], a[44:47], v[44:47], v[64:79]
  v_exp_f32 v24, v116
  v_cvt_pk_bf16_f32 v241, v26, v27
  v_exp_f32 v25, v117
  v_exp_f32 v26, v118
  v_cvt_pk_bf16_f32 v242, v24, v25
  s_waitcnt lgkmcnt(0)
  v_mfma_f32_32x32x16_bf16 v[64:79], a[48:51], v[48:51], v[64:79]
  v_exp_f32 v27, v119
  v_exp_f32 v24, v120
  v_cvt_pk_bf16_f32 v243, v26, v27
  v_exp_f32 v25, v121
  v_exp_f32 v26, v122
  v_mfma_f32_32x32x16_bf16 v[64:79], a[52:55], v[52:55], v[64:79]
  v_cvt_pk_bf16_f32 v244, v24, v25
  v_exp_f32 v27, v123
  v_exp_f32 v24, v124
  v_cvt_pk_bf16_f32 v245, v26, v27
  v_exp_f32 v25, v125
  v_mfma_f32_32x32x16_bf16 v[64:79], a[56:59], v[56:59], v[64:79]
  v_exp_f32 v26, v126
  v_cvt_pk_bf16_f32 v246, v24, v25
  v_exp_f32 v27, v127
  v_or3_b32 v15, v240, v241, v242
  v_mfma_f32_32x32x16_bf16 v[64:79], a[60:63], v[60:63], v[64:79]
  v_cvt_pk_bf16_f32 v247, v26, v27
  v_or3_b32 v15, v15, v243, v244
  v_or3_b32 v15, v15, v245, v246
  v_bitop3_b32 v15, v15, v247, s67 bitop3:0xa8
  v_cmp_ne_u32 vcc, 0, v15
  s_cbranch_vccnz L_rarev1_14
L_backv1_14:
  v_accvgpr_read_b32 v16, a240
  v_accvgpr_read_b32 v17, a241
  v_accvgpr_read_b32 v22, a242
  v_accvgpr_read_b32 v23, a243
  v_accvgpr_read_b32 v18, a244
  v_accvgpr_read_b32 v19, a245
  v_accvgpr_read_b32 v20, a246
  v_accvgpr_read_b32 v125, a247
  v_accvgpr_read_b32 v116, a248
  v_accvgpr_read_b32 v117, a249
  v_accvgpr_read_b32 v118, a250
  v_accvgpr_read_b32 v119, a251
  v_accvgpr_read_b32 v120, a252
  v_accvgpr_read_b32 v121, a253
  v_accvgpr_read_b32 v122, a254
  v_accvgpr_read_b32 v123, a255
L_conv:
  s_mov_b32 s63, 0x07060302
  s_waitcnt vmcnt(25) lgkmcnt(0)
  s_barrier
  ds_read_b64_tr_b16 a[0:1], v16 offset:32768
  ds_read_b64_tr_b16 a[2:3], v16 offset:33792
  ds_read_b64_tr_b16 a[4:5], v17 offset:32768
  ds_read_b64_tr_b16 a[6:7], v17 offset:33792
  ds_read_b64_tr_b16 a[8:9], v16 offset:34816
  ds_read_b64_tr_b16 a[10:11], v16 offset:35840
  ds_read_b64_tr_b16 a[12:13], v17 offset:34816
  ds_read_b64_tr_b16 a[14:15], v17 offset:35840
  ds_read_b64_tr_b16 a[16:17], v16 offset:36864
  ds_read_b64_tr_b16 a[18:19], v16 offset:37888
  ds_read_b64_tr_b16 a[20:21], v17 offset:36864
  ds_read_b64_tr_b16 a[22:23], v17 offset:37888
  s_waitcnt lgkmcnt(8)
  v_mfma_f32_32x32x16_bf16 v[32:47], a[0:3], v[128:131], 0
  s_add_u32 m0, s38, 0
  s_add_u32 s59, s97, 65664
  s_and_b32 s59, s59, 0x1ffff
  s_lshl1_add_u32 s59, s38, s59
  buffer_load_dwordx4 v6, s[16:19], s59 offen offset:0 nt lds
  v_mfma_f32_32x32x16_bf16 v[48:63], a[4:7], v[128:131], 0
  ds_read_b64_tr_b16 a[24:25], v16 offset:38912
  ds_read_b64_tr_b16 a[26:27], v16 offset:39936
  v_exp_f32 v24, v64
  v_exp_f32 v25, v65
  v_exp_f32 v26, v66
  v_mfma_f32_16x16x32_bf16 v[112:115], v[116:119], v[128:131], 0
  ds_read_b64_tr_b16 a[28:29], v17 offset:38912
  s_waitcnt lgkmcnt(7)
  v_mfma_f32_32x32x16_bf16 v[32:47], a[8:11], v[132:135], v[32:47]
  ds_read_b64_tr_b16 a[30:31], v17 offset:39936
  v_cvt_pk_bf16_f32 v248, v24, v25
  v_exp_f32 v27, v67
  v_exp_f32 v24, v68
  v_cvt_pk_bf16_f32 v249, v26, v27
  v_mfma_f32_32x32x16_bf16 v[48:63], a[12:15], v[132:135], v[48:63]
  ds_read_b64_tr_b16 a[32:33], v16 offset:40960
  ds_read_b64_tr_b16 a[34:35], v16 offset:41984
  v_exp_f32 v25, v69
  v_exp_f32 v26, v70
  v_cvt_pk_bf16_f32 v250, v24, v25
  v_mfma_f32_16x16x32_bf16 v[112:115], v[116:119], v[132:135], v[112:115]
  ds_read_b64_tr_b16 a[36:37], v17 offset:40960
  s_waitcnt lgkmcnt(7)
  v_mfma_f32_32x32x16_bf16 v[32:47], a[16:19], v[136:139], v[32:47]
  buffer_load_dwordx4 v7, s[16:19], s59 offen offset:1024 nt lds
  ds_read_b64_tr_b16 a[38:39], v17 offset:41984
  v_exp_f32 v27, v71
  v_mfma_f32_32x32x16_bf16 v[48:63], a[20:23], v[136:139], v[48:63]
  ds_read_b64_tr_b16 a[40:41], v16 offset:43008
  ds_read_b64_tr_b16 a[42:43], v16 offset:44032
  v_exp_f32 v24, v72
  v_cvt_pk_bf16_f32 v251, v26, v27
  v_exp_f32 v25, v73
  v_mfma_f32_16x16x32_bf16 v[112:115], v[116:119], v[136:139], v[112:115]
  ds_read_b64_tr_b16 a[44:45], v17 offset:43008
  s_waitcnt lgkmcnt(7)
  v_mfma_f32_32x32x16_bf16 v[32:47], a[24:27], v[140:143], v[32:47]
  ds_read_b64_tr_b16 a[46:47], v17 offset:44032
  v_exp_f32 v26, v74
  v_cvt_pk_bf16_f32 v252, v24, v25
  v_exp_f32 v27, v75
  v_exp_f32 v24, v76
  v_mfma_f32_32x32x16_bf16 v[48:63], a[28:31], v[140:143], v[48:63]
  ds_read_b64_tr_b16 a[48:49], v16 offset:45056
  ds_read_b64_tr_b16 a[50:51], v16 offset:46080
  v_cvt_pk_bf16_f32 v253, v26, v27
  v_exp_f32 v25, v77
  v_exp_f32 v26, v78
  v_mfma_f32_16x16x32_bf16 v[112:115], v[116:119], v[140:143], v[112:115]
  ds_read_b64_tr_b16 a[52:53], v17 offset:45056
  s_waitcnt lgkmcnt(7)
  v_mfma_f32_32x32x16_bf16 v[32:47], a[32:35], v[144:147], v[32:47]
  buffer_load_dwordx4 v8, s[16:19], s59 offen offset:2048 nt lds
  ds_read_b64_tr_b16 a[54:55], v17 offset:46080
  v_cvt_pk_bf16_f32 v254, v24, v25
  v_mfma_f32_32x32x16_bf16 v[48:63], a[36:39], v[144:147], v[48:63]
  ds_read_b64_tr_b16 a[56:57], v16 offset:47104
  ds_read_b64_tr_b16 a[58:59], v16 offset:48128
  v_exp_f32 v27, v79
  v_or3_b32 v15, v248, v249, v250
  v_cvt_pk_bf16_f32 v255, v26, v27
  v_mfma_f32_16x16x32_bf16 v[112:115], v[116:119], v[144:147], v[112:115]
  ds_read_b64_tr_b16 a[60:61], v17 offset:47104
  s_waitcnt lgkmcnt(7)
  v_mfma_f32_32x32x16_bf16 v[32:47], a[40:43], v[148:151], v[32:47]
  ds_read_b64_tr_b16 a[62:63], v17 offset:48128
  v_or3_b32 v15, v15, v251, v252
  v_or3_b32 v15, v15, v253, v254
  v_bitop3_b32 v15, v15, v255, s67 bitop3:0xa8
  v_cmp_ne_u32 vcc, 0, v15
  v_mfma_f32_32x32x16_bf16 v[48:63], a[44:47], v[148:151], v[48:63]
  s_waitcnt vmcnt(24)
  s_barrier
  ds_read_b64_tr_b16 a[0:1], v16 offset:49152
  ds_read_b64_tr_b16 a[2:3], v16 offset:50176
  s_cbranch_vccnz L_rarec_15
L_backc_15:
  v_mfma_f32_16x16x32_bf16 v[112:115], v[116:119], v[148:151], v[112:115]
  ds_read_b64_tr_b16 a[4:5], v17 offset:49152
  s_waitcnt lgkmcnt(7)
  v_mfma_f32_32x32x16_bf16 v[32:47], a[48:51], v[152:155], v[32:47]
  buffer_load_dwordx4 v9, s[16:19], s59 offen offset:3072 nt lds
  ds_read_b64_tr_b16 a[6:7], v17 offset:50176
  v_mfma_f32_32x32x16_bf16 v[48:63], a[52:55], v[152:155], v[48:63]
  ds_read_b64_tr_b16 a[8:9], v16 offset:51200
  ds_read_b64_tr_b16 a[10:11], v16 offset:52224
  v_mfma_f32_16x16x32_bf16 v[112:115], v[116:119], v[152:155], v[112:115]
  ds_read_b64_tr_b16 a[12:13], v17 offset:51200
  s_waitcnt lgkmcnt(7)
  v_mfma_f32_32x32x16_bf16 v[32:47], a[56:59], v[156:159], v[32:47]
  ds_read_b64_tr_b16 a[14:15], v17 offset:52224
  v_mfma_f32_32x32x16_bf16 v[48:63], a[60:63], v[156:159], v[48:63]
  ds_read_b64_tr_b16 a[16:17], v16 offset:53248
  ds_read_b64_tr_b16 a[18:19], v16 offset:54272
  v_mfma_f32_16x16x32_bf16 v[112:115], v[116:119], v[156:159], v[112:115]
  ds_read_b64_tr_b16 a[20:21], v17 offset:53248
  s_waitcnt lgkmcnt(7)
  v_mfma_f32_32x32x16_bf16 v[32:47], a[0:3], v[160:163], v[32:47]
  s_add_u32 m0, s38, 16384
  s_add_u32 s59, s97, 98432
  s_and_b32 s59, s59, 0x1ffff
  s_lshl1_add_u32 s59, s38, s59
  buffer_load_dwordx4 v6, s[16:19], s59 offen offset:0 nt lds
  v_mfma_f32_32x32x16_bf16 v[48:63], a[4:7], v[160:163], v[48:63]
  ds_read_b64_tr_b16 a[22:23], v17 offset:54272
  ds_read_b64_tr_b16 a[24:25], v16 offset:55296
  ds_read_b64_tr_b16 a[26:27], v16 offset:56320
  v_mfma_f32_16x16x32_bf16 v[112:115], v[116:119], v[160:163], v[112:115]
  ds_read_b64_tr_b16 a[28:29], v17 offset:55296
  s_waitcnt lgkmcnt(7)
  v_mfma_f32_32x32x16_bf16 v[32:47], a[8:11], v[164:167], v[32:47]
  ds_read_b64_tr_b16 a[30:31], v17 offset:56320
  v_mfma_f32_32x32x16_bf16 v[48:63], a[12:15], v[164:167], v[48:63]
  ds_read_b64_tr_b16 a[32:33], v16 offset:57344
  ds_read_b64_tr_b16 a[34:35], v16 offset:58368
  v_mfma_f32_16x16x32_bf16 v[112:115], v[116:119], v[164:167], v[112:115]
  ds_read_b64_tr_b16 a[36:37], v17 offset:57344
  s_waitcnt lgkmcnt(7)
  v_mfma_f32_32x32x16_bf16 v[32:47], a[16:19], v[168:171], v[32:47]
  buffer_load_dwordx4 v7, s[16:19], s59 offen offset:1024 nt lds
  ds_read_b64_tr_b16 a[38:39], v17 offset:58368
  v_mfma_f32_32x32x16_bf16 v[48:63], a[20:23], v[168:171], v[48:63]
  ds_read_b64_tr_b16 a[40:41], v16 offset:59392
  ds_read_b64_tr_b16 a[42:43], v16 offset:60416
  v_mfma_f32_16x16x32_bf16 v[112:115], v[116:119], v[168:171], v[112:115]
  ds_read_b64_tr_b16 a[44:45], v17 offset:59392
  s_waitcnt lgkmcnt(7)
  v_mfma_f32_32x32x16_bf16 v[32:47], a[24:27], v[172:175], v[32:47]
  ds_read_b64_tr_b16 a[46:47], v17 offset:60416
  v_mfma_f32_32x32x16_bf16 v[48:63], a[28:31], v[172:175], v[48:63]
  ds_read_b64_tr_b16 a[48:49], v16 offset:61440
  ds_read_b64_tr_b16 a[50:51], v16 offset:62464
  v_mfma_f32_16x16x32_bf16 v[112:115], v[116:119], v[172:175], v[112:115]
  ds_read_b64_tr_b16 a[52:53], v17 offset:61440
  s_waitcnt lgkmcnt(7)
  v_mfma_f32_32x32x16_bf16 v[32:47], a[32:35], v[176:179], v[32:47]
  buffer_load_dwordx4 v8, s[16:19], s59 offen offset:2048 nt lds
  ds_read_b64_tr_b16 a[54:55], v17 offset:62464
  v_mfma_f32_32x32x16_bf16 v[48:63], a[36:39], v[176:179], v[48:63]
  ds_read_b64_tr_b16 a[56:57], v16 offset:63488
  ds_read_b64_tr_b16 a[58:59], v16 offset:64512
  v_mfma_f32_16x16x32_bf16 v[112:115], v[116:119], v[176:179], v[112:115]
  ds_read_b64_tr_b16 a[60:61], v17 offset:63488
  s_waitcnt lgkmcnt(7)
  v_mfma_f32_32x32x16_bf16 v[32:47], a[40:43], v[180:183], v[32:47]
  ds_read_b64_tr_b16 a[62:63], v17 offset:64512
  v_mfma_f32_32x32x16_bf16 v[48:63], a[44:47], v[180:183], v[48:63]
  s_waitcnt vmcnt(24)
  s_barrier
  ds_read_b64_tr_b16 a[0:1], v16 offset:0
  ds_read_b64_tr_b16 a[2:3], v16 offset:1024
  v_mfma_f32_16x16x32_bf16 v[112:115], v[116:119], v[180:183], v[112:115]
  ds_read_b64_tr_b16 a[4:5], v17 offset:0
  s_waitcnt lgkmcnt(7)
  v_mfma_f32_32x32x16_bf16 v[32:47], a[48:51], v[184:187], v[32:47]
  buffer_load_dwordx4 v9, s[16:19], s59 offen offset:3072 nt lds
  ds_read_b64_tr_b16 a[6:7], v17 offset:1024
  v_mfma_f32_32x32x16_bf16 v[48:63], a[52:55], v[184:187], v[48:63]
  ds_read_b64_tr_b16 a[8:9], v16 offset:2048
  ds_read_b64_tr_b16 a[10:11], v16 offset:3072
  v_mfma_f32_16x16x32_bf16 v[112:115], v[116:119], v[184:187], v[112:115]
  ds_read_b64_tr_b16 a[12:13], v17 offset:2048
  s_waitcnt lgkmcnt(7)
  v_mfma_f32_32x32x16_bf16 v[32:47], a[56:59], v[188:191], v[32:47]
  ds_read_b64_tr_b16 a[14:15], v17 offset:3072
  v_mfma_f32_32x32x16_bf16 v[48:63], a[60:63], v[188:191], v[48:63]
  ds_read_b64_tr_b16 a[16:17], v16 offset:4096
  ds_read_b64_tr_b16 a[18:19], v16 offset:5120
  v_mfma_f32_16x16x32_bf16 v[112:115], v[116:119], v[188:191], v[112:115]
  ds_read_b64_tr_b16 a[20:21], v17 offset:4096
  s_waitcnt lgkmcnt(7)
  v_mfma_f32_32x32x16_bf16 v[32:47], a[0:3], v[192:195], v[32:47]
  s_add_u32 s59, s5, 0
  s_and_b32 s59, s59, 3
  s_mul_i32 s59, s59, 163840
  s_lshl_b32 s60, s39, 2
  s_add_u32 s59, s59, s60
  s_add_u32 m0, s39, 143360
  s_add_u32 s59, s59, 0
  buffer_load_dwordx4 v10, s[24:27], s59 offen offset:0 lds
  v_mfma_f32_32x32x16_bf16 v[48:63], a[4:7], v[192:195], v[48:63]
  ds_read_b64_tr_b16 a[22:23], v17 offset:5120
  ds_read_b64_tr_b16 a[24:25], v16 offset:6144
  ds_read_b64_tr_b16 a[26:27], v16 offset:7168
  v_mfma_f32_16x16x32_bf16 v[112:115], v[116:119], v[192:195], v[112:115]
  ds_read_b64_tr_b16 a[28:29], v17 offset:6144
  s_waitcnt lgkmcnt(7)
  v_mfma_f32_32x32x16_bf16 v[32:47], a[8:11], v[196:199], v[32:47]
  ds_read_b64_tr_b16 a[30:31], v17 offset:7168
  v_mfma_f32_32x32x16_bf16 v[48:63], a[12:15], v[196:199], v[48:63]
  ds_read_b64_tr_b16 a[32:33], v16 offset:8192
  ds_read_b64_tr_b16 a[34:35], v16 offset:9216
  v_mfma_f32_16x16x32_bf16 v[112:115], v[116:119], v[196:199], v[112:115]
  ds_read_b64_tr_b16 a[36:37], v17 offset:8192
  s_waitcnt lgkmcnt(7)
  v_mfma_f32_32x32x16_bf16 v[32:47], a[16:19], v[200:203], v[32:47]
  buffer_load_dwordx4 v11, s[24:27], s59 offen offset:1024 lds
  ds_read_b64_tr_b16 a[38:39], v17 offset:9216
  v_mfma_f32_32x32x16_bf16 v[48:63], a[20:23], v[200:203], v[48:63]
  ds_read_b64_tr_b16 a[40:41], v16 offset:10240
  ds_read_b64_tr_b16 a[42:43], v16 offset:11264
  v_mfma_f32_16x16x32_bf16 v[112:115], v[116:119], v[200:203], v[112:115]
  ds_read_b64_tr_b16 a[44:45], v17 offset:10240
  s_waitcnt lgkmcnt(7)
  v_mfma_f32_32x32x16_bf16 v[32:47], a[24:27], v[204:207], v[32:47]
  ds_read_b64_tr_b16 a[46:47], v17 offset:11264
  v_mfma_f32_32x32x16_bf16 v[48:63], a[28:31], v[204:207], v[48:63]
  ds_read_b64_tr_b16 a[48:49], v16 offset:12288
  ds_read_b64_tr_b16 a[50:51], v16 offset:13312
  v_mfma_f32_16x16x32_bf16 v[112:115], v[116:119], v[204:207], v[112:115]
  ds_read_b64_tr_b16 a[52:53], v17 offset:12288
  s_waitcnt lgkmcnt(7)
  v_mfma_f32_32x32x16_bf16 v[32:47], a[32:35], v[208:211], v[32:47]
  buffer_load_dwordx4 v12, s[24:27], s59 offen offset:2048 lds
  ds_read_b64_tr_b16 a[54:55], v17 offset:13312
  v_mfma_f32_32x32x16_bf16 v[48:63], a[36:39], v[208:211], v[48:63]
  ds_read_b64_tr_b16 a[56:57], v16 offset:14336
  ds_read_b64_tr_b16 a[58:59], v16 offset:15360
  v_mfma_f32_16x16x32_bf16 v[112:115], v[116:119], v[208:211], v[112:115]
  ds_read_b64_tr_b16 a[60:61], v17 offset:14336
  s_waitcnt lgkmcnt(7)
  v_mfma_f32_32x32x16_bf16 v[32:47], a[40:43], v[212:215], v[32:47]
  ds_read_b64_tr_b16 a[62:63], v17 offset:15360
  v_mfma_f32_32x32x16_bf16 v[48:63], a[44:47], v[212:215], v[48:63]
  s_waitcnt vmcnt(24)
  s_barrier
  ds_read_b64_tr_b16 a[0:1], v16 offset:16384
  ds_read_b64_tr_b16 a[2:3], v16 offset:17408
  v_mfma_f32_16x16x32_bf16 v[112:115], v[116:119], v[212:215], v[112:115]
  ds_read_b64_tr_b16 a[4:5], v17 offset:16384
  s_waitcnt lgkmcnt(7)
  v_mfma_f32_32x32x16_bf16 v[32:47], a[48:51], v[216:219], v[32:47]
  buffer_load_dwordx4 v13, s[24:27], s59 offen offset:3072 lds
  ds_read_b64_tr_b16 a[6:7], v17 offset:17408
  v_mfma_f32_32x32x16_bf16 v[48:63], a[52:55], v[216:219], v[48:63]
  ds_read_b64_tr_b16 a[8:9], v16 offset:18432
  ds_read_b64_tr_b16 a[10:11], v16 offset:19456
  v_mfma_f32_16x16x32_bf16 v[112:115], v[116:119], v[216:219], v[112:115]
  ds_read_b64_tr_b16 a[12:13], v17 offset:18432
  s_waitcnt lgkmcnt(7)
  v_mfma_f32_32x32x16_bf16 v[32:47], a[56:59], v[220:223], v[32:47]
  ds_read_b64_tr_b16 a[14:15], v17 offset:19456
  v_mfma_f32_32x32x16_bf16 v[48:63], a[60:63], v[220:223], v[48:63]
  ds_read_b64_tr_b16 a[16:17], v16 offset:20480
  ds_read_b64_tr_b16 a[18:19], v16 offset:21504
  v_mfma_f32_16x16x32_bf16 v[112:115], v[116:119], v[220:223], v[112:115]
  ds_read_b64_tr_b16 a[20:21], v17 offset:20480
  s_waitcnt lgkmcnt(7)
  v_mfma_f32_32x32x16_bf16 v[32:47], a[0:3], v[224:227], v[32:47]
  s_add_u32 m0, s39, 147456
  s_nop 0
  buffer_load_dwordx4 v14, s[24:27], s59 offen offset:0 lds
  v_mfma_f32_32x32x16_bf16 v[48:63], a[4:7], v[224:227], v[48:63]
  ds_read_b64_tr_b16 a[22:23], v17 offset:21504
  ds_read_b64_tr_b16 a[24:25], v16 offset:22528
  ds_read_b64_tr_b16 a[26:27], v16 offset:23552
  v_mfma_f32_16x16x32_bf16 v[112:115], v[116:119], v[224:227], v[112:115]
  ds_read_b64_tr_b16 a[28:29], v17 offset:22528
  s_waitcnt lgkmcnt(7)
  v_mfma_f32_32x32x16_bf16 v[32:47], a[8:11], v[228:231], v[32:47]
  ds_read_b64_tr_b16 a[30:31], v17 offset:23552
  v_mfma_f32_32x32x16_bf16 v[48:63], a[12:15], v[228:231], v[48:63]
  ds_read_b64_tr_b16 a[32:33], v16 offset:24576
  ds_read_b64_tr_b16 a[34:35], v16 offset:25600
  v_mfma_f32_16x16x32_bf16 v[112:115], v[116:119], v[228:231], v[112:115]
  ds_read_b64_tr_b16 a[36:37], v17 offset:24576
  s_waitcnt lgkmcnt(7)
  v_mfma_f32_32x32x16_bf16 v[32:47], a[16:19], v[232:235], v[32:47]
  ds_read_b64_tr_b16 a[38:39], v17 offset:25600
  v_mfma_f32_32x32x16_bf16 v[48:63], a[20:23], v[232:235], v[48:63]
  ds_read_b64_tr_b16 a[40:41], v16 offset:26624
  ds_read_b64_tr_b16 a[42:43], v16 offset:27648
  v_mfma_f32_16x16x32_bf16 v[112:115], v[116:119], v[232:235], v[112:115]
  ds_read_b64_tr_b16 a[44:45], v17 offset:26624
  s_waitcnt lgkmcnt(7)
  v_mfma_f32_32x32x16_bf16 v[32:47], a[24:27], v[236:239], v[32:47]
  ds_read_b64_tr_b16 a[46:47], v17 offset:27648
  v_mfma_f32_32x32x16_bf16 v[48:63], a[28:31], v[236:239], v[48:63]
  ds_read_b64_tr_b16 a[48:49], v16 offset:28672
  ds_read_b64_tr_b16 a[50:51], v16 offset:29696
  v_mfma_f32_16x16x32_bf16 v[112:115], v[116:119], v[236:239], v[112:115]
  ds_read_b64_tr_b16 a[52:53], v17 offset:28672
  s_waitcnt lgkmcnt(7)
  v_mfma_f32_32x32x16_bf16 v[32:47], a[32:35], v[240:243], v[32:47]
  ds_read_b64_tr_b16 a[54:55], v17 offset:29696
  v_mfma_f32_32x32x16_bf16 v[48:63], a[36:39], v[240:243], v[48:63]
  ds_read_b64_tr_b16 a[56:57], v16 offset:30720
  ds_read_b64_tr_b16 a[58:59], v16 offset:31744
  v_mfma_f32_16x16x32_bf16 v[112:115], v[116:119], v[240:243], v[112:115]
  ds_read_b64_tr_b16 a[60:61], v17 offset:30720
  s_waitcnt lgkmcnt(7)
  v_mfma_f32_32x32x16_bf16 v[32:47], a[40:43], v[244:247], v[32:47]
  ds_read_b64_tr_b16 a[62:63], v17 offset:31744
  v_mfma_f32_32x32x16_bf16 v[48:63], a[44:47], v[244:247], v[48:63]
  s_waitcnt vmcnt(22)
  s_barrier
  ds_read_b64_tr_b16 a[0:1], v22 offset:32768
  ds_read_b64_tr_b16 a[2:3], v22 offset:33792
  v_mfma_f32_16x16x32_bf16 v[112:115], v[116:119], v[244:247], v[112:115]
  ds_read_b64_tr_b16 a[4:5], v23 offset:32768
  s_waitcnt lgkmcnt(7)
  v_mfma_f32_32x32x16_bf16 v[32:47], a[48:51], v[248:251], v[32:47]
  s_add_u32 s59, s5, 0
  s_and_b32 s59, s59, 3
  s_mul_i32 s59, s59, 163840
  s_lshl_b32 s60, s39, 2
  s_add_u32 s59, s59, s60
  s_add_u32 m0, s39, 122880
  s_add_u32 s59, s59, 81920
  buffer_load_dwordx4 v10, s[24:27], s59 offen offset:0 lds
  v_mfma_f32_32x32x16_bf16 v[48:63], a[52:55], v[248:251], v[48:63]
  ds_read_b64_tr_b16 a[6:7], v23 offset:33792
  ds_read_b64_tr_b16 a[8:9], v22 offset:34816
  ds_read_b64_tr_b16 a[10:11], v22 offset:35840
  v_mfma_f32_16x16x32_bf16 v[112:115], v[116:119], v[248:251], v[112:115]
  ds_read_b64_tr_b16 a[12:13], v23 offset:34816
  s_waitcnt lgkmcnt(7)
  v_mfma_f32_32x32x16_bf16 v[32:47], a[56:59], v[252:255], v[32:47]
  ds_read_b64_tr_b16 a[14:15], v23 offset:35840
  ds_read_b64_tr_b16 a[16:17], v22 offset:36864
  ds_read_b64_tr_b16 a[18:19], v22 offset:37888
  v_mfma_f32_32x32x16_bf16 v[48:63], a[60:63], v[252:255], v[48:63]
  ds_read_b64_tr_b16 a[20:21], v23 offset:36864
  ds_read_b64_tr_b16 a[22:23], v23 offset:37888
  ds_read_b64_tr_b16 a[24:25], v22 offset:38912
  v_mfma_f32_16x16x32_bf16 v[112:115], v[116:119], v[252:255], v[112:115]
  ds_read_b64_tr_b16 a[26:27], v22 offset:39936
  s_waitcnt lgkmcnt(8)
  v_mfma_f32_32x32x16_bf16 v[64:79], a[0:3], v[128:131], 0
  buffer_load_dwordx4 v11, s[24:27], s59 offen offset:1024 lds
  ds_read_b64_tr_b16 a[28:29], v23 offset:38912
  ds_read_b64_tr_b16 a[30:31], v23 offset:39936
  v_mfma_f32_32x32x16_bf16 v[80:95], a[4:7], v[128:131], 0
  ds_read_b64_tr_b16 a[32:33], v22 offset:40960
  ds_read_b64_tr_b16 a[34:35], v22 offset:41984
  ds_read_b64_tr_b16 a[36:37], v23 offset:40960
  v_mfma_f32_32x32x16_bf16 v[64:79], a[8:11], v[132:135], v[64:79]
  buffer_load_dwordx4 v12, s[24:27], s59 offen offset:2048 lds
  ds_read_b64_tr_b16 a[38:39], v23 offset:41984
  s_waitcnt lgkmcnt(8)
  v_mfma_f32_32x32x16_bf16 v[80:95], a[12:15], v[132:135], v[80:95]
  ds_read_b64_tr_b16 a[40:41], v22 offset:43008
  ds_read_b64_tr_b16 a[42:43], v22 offset:44032
  ds_read_b64_tr_b16 a[44:45], v23 offset:43008
  v_rcp_f32 v15, v112
  s_nop 0
  v_mul_f32 v32, v32, v15
  v_mul_f32 v33, v33, v15
  v_perm_b32 v96, v33, v32, s63
  v_mfma_f32_32x32x16_bf16 v[64:79], a[16:19], v[136:139], v[64:79]
  buffer_load_dwordx4 v13, s[24:27], s59 offen offset:3072 lds
  ds_read_b64_tr_b16 a[46:47], v23 offset:44032
  ds_read_b64_tr_b16 a[48:49], v22 offset:45056
  v_add_u32 v96, s51, v96
  v_and_or_b32 v96, v96, s50, v120
  v_mul_f32 v34, v34, v15
  v_mfma_f32_32x32x16_bf16 v[80:95], a[20:23], v[136:139], v[80:95]
  ds_read_b64_tr_b16 a[50:51], v22 offset:46080
  ds_read_b64_tr_b16 a[52:53], v23 offset:45056
  ds_read_b64_tr_b16 a[54:55], v23 offset:46080
  v_mul_f32 v35, v35, v15
  v_perm_b32 v97, v35, v34, s63
  v_add_u32 v97, s51, v97
  v_and_or_b32 v97, v97, s50, v121
  v_mul_f32 v36, v36, v15
  s_waitcnt lgkmcnt(10)
  v_mfma_f32_32x32x16_bf16 v[64:79], a[24:27], v[140:143], v[64:79]
  s_add_u32 m0, s39, 126976
  s_nop 0
  buffer_load_dwordx4 v14, s[24:27], s59 offen offset:0 lds
  v_mul_f32 v37, v37, v15
  v_perm_b32 v98, v37, v36, s63
  v_add_u32 v98, s51, v98
  v_mfma_f32_32x32x16_bf16 v[80:95], a[28:31], v[140:143], v[80:95]
  ds_read_b64_tr_b16 a[56:57], v22 offset:47104
  ds_read_b64_tr_b16 a[58:59], v22 offset:48128
  ds_read_b64_tr_b16 a[60:61], v23 offset:47104
  v_and_or_b32 v98, v98, s50, v122
  v_mul_f32 v38, v38, v15
  v_mul_f32 v39, v39, v15
  v_perm_b32 v99, v39, v38, s63
  v_add_u32 v99, s51, v99
  v_mfma_f32_32x32x16_bf16 v[64:79], a[32:35], v[144:147], v[64:79]
  s_add_u32 s59, s5, 1
  s_and_b32 s59, s59, 3
  s_mul_i32 s59, s59, 163840
  s_lshl_b32 s60, s39, 2
  s_add_u32 s59, s59, s60
  s_add_u32 m0, s39, 102400
  s_add_u32 s59, s59, 0
  buffer_load_dwordx4 v10, s[24:27], s59 offen offset:0 lds
  v_and_or_b32 v99, v99, s50, v123
  buffer_store_dwordx4 v[96:99], v1, s[32:35], s69 offen offset:0 sc1
  v_mul_f32 v40, v40, v15
  s_waitcnt lgkmcnt(7)
  v_mfma_f32_32x32x16_bf16 v[80:95], a[36:39], v[144:147], v[80:95]
  ds_read_b64_tr_b16 a[62:63], v23 offset:48128
  s_waitcnt vmcnt(25)
  s_barrier
  ds_read_b64_tr_b16 a[0:1], v22 offset:49152
  ds_read_b64_tr_b16 a[2:3], v22 offset:50176
  v_mul_f32 v41, v41, v15
  v_perm_b32 v100, v41, v40, s63
  v_add_u32 v100, s51, v100
  v_and_or_b32 v100, v100, s50, v120
  v_mul_f32 v42, v42, v15
  v_mfma_f32_32x32x16_bf16 v[64:79], a[40:43], v[148:151], v[64:79]
  buffer_load_dwordx4 v11, s[24:27], s59 offen offset:1024 lds
  ds_read_b64_tr_b16 a[4:5], v23 offset:49152
  ds_read_b64_tr_b16 a[6:7], v23 offset:50176
  v_mul_f32 v43, v43, v15
  v_perm_b32 v101, v43, v42, s63
  v_add_u32 v101, s51, v101
  v_mfma_f32_32x32x16_bf16 v[80:95], a[44:47], v[148:151], v[80:95]
  ds_read_b64_tr_b16 a[8:9], v22 offset:51200
  ds_read_b64_tr_b16 a[10:11], v22 offset:52224
  ds_read_b64_tr_b16 a[12:13], v23 offset:51200
  v_and_or_b32 v101, v101, s50, v121
  v_mul_f32 v44, v44, v15
  v_mul_f32 v45, v45, v15
  v_perm_b32 v102, v45, v44, s63
  v_add_u32 v102, s51, v102
  s_waitcnt lgkmcnt(9)
  v_mfma_f32_32x32x16_bf16 v[64:79], a[48:51], v[152:155], v[64:79]
  buffer_load_dwordx4 v12, s[24:27], s59 offen offset:2048 lds
  ds_read_b64_tr_b16 a[14:15], v23 offset:52224
  ds_read_b64_tr_b16 a[16:17], v22 offset:53248
  v_and_or_b32 v102, v102, s50, v122
  v_mul_f32 v46, v46, v15
  v_mul_f32 v47, v47, v15
  v_mfma_f32_32x32x16_bf16 v[80:95], a[52:55], v[152:155], v[80:95]
  ds_read_b64_tr_b16 a[18:19], v22 offset:54272
  ds_read_b64_tr_b16 a[20:21], v23 offset:53248
  ds_read_b64_tr_b16 a[22:23], v23 offset:54272
  v_perm_b32 v103, v47, v46, s63
  v_add_u32 v103, s51, v103
  v_and_or_b32 v103, v103, s50, v123
  buffer_store_dwordx4 v[100:103], v1, s[32:35], s69 offen offset:1024 sc1
  v_mul_f32 v48, v48, v15
  v_mfma_f32_32x32x16_bf16 v[64:79], a[56:59], v[156:159], v[64:79]
  buffer_load_dwordx4 v13, s[24:27], s59 offen offset:3072 lds
  ds_read_b64_tr_b16 a[24:25], v22 offset:55296
  v_mul_f32 v49, v49, v15
  v_perm_b32 v104, v49, v48, s63
  v_add_u32 v104, s51, v104
  s_waitcnt lgkmcnt(9)
  v_mfma_f32_32x32x16_bf16 v[80:95], a[60:63], v[156:159], v[80:95]
  ds_read_b64_tr_b16 a[26:27], v22 offset:56320
  ds_read_b64_tr_b16 a[28:29], v23 offset:55296
  ds_read_b64_tr_b16 a[30:31], v23 offset:56320
  v_and_or_b32 v104, v104, s50, v120
  v_mul_f32 v50, v50, v15
  v_mul_f32 v51, v51, v15
  v_perm_b32 v105, v51, v50, s63
  v_add_u32 v105, s51, v105
  v_mfma_f32_32x32x16_bf16 v[64:79], a[0:3], v[160:163], v[64:79]
  s_add_u32 m0, s39, 106496
  s_nop 0
  buffer_load_dwordx4 v14, s[24:27], s59 offen offset:0 lds
  v_and_or_b32 v105, v105, s50, v121
  v_mul_f32 v52, v52, v15
  v_mul_f32 v53, v53, v15
  v_mfma_f32_32x32x16_bf16 v[80:95], a[4:7], v[160:163], v[80:95]
  ds_read_b64_tr_b16 a[32:33], v22 offset:57344
  ds_read_b64_tr_b16 a[34:35], v22 offset:58368
  ds_read_b64_tr_b16 a[36:37], v23 offset:57344
  v_perm_b32 v106, v53, v52, s63
  v_add_u32 v106, s51, v106
  v_and_or_b32 v106, v106, s50, v122
  v_mul_f32 v54, v54, v15
  v_mul_f32 v55, v55, v15
  s_waitcnt lgkmcnt(9)
  v_mfma_f32_32x32x16_bf16 v[64:79], a[8:11], v[164:167], v[64:79]
  s_add_u32 s59, s5, 2
  s_and_b32 s59, s59, 3
  s_mul_i32 s59, s59, 163840
  s_lshl_b32 s60, s39, 2
  s_add_u32 s59, s59, s60
  s_add_u32 m0, s39, 81920
  s_add_u32 s59, s59, 0
  buffer_load_dwordx4 v10, s[24:27], s59 offen offset:0 lds
  v_perm_b32 v107, v55, v54, s63
  v_add_u32 v107, s51, v107
  v_and_or_b32 v107, v107, s50, v123
  v_mfma_f32_32x32x16_bf16 v[80:95], a[12:15], v[164:167], v[80:95]
  ds_read_b64_tr_b16 a[38:39], v23 offset:58368
  ds_read_b64_tr_b16 a[40:41], v22 offset:59392
  ds_read_b64_tr_b16 a[42:43], v22 offset:60416
  buffer_store_dwordx4 v[104:107], v1, s[32:35], s69 offen offset:2048 sc1
  v_mul_f32 v56, v56, v15
  v_mul_f32 v57, v57, v15
  v_perm_b32 v108, v57, v56, s63
  v_add_u32 v108, s51, v108
  v_mfma_f32_32x32x16_bf16 v[64:79], a[16:19], v[168:171], v[64:79]
  buffer_load_dwordx4 v11, s[24:27], s59 offen offset:1024 lds
  ds_read_b64_tr_b16 a[44:45], v23 offset:59392
  v_and_or_b32 v108, v108, s50, v120
  v_mul_f32 v58, v58, v15
  v_mul_f32 v59, v59, v15
  s_waitcnt lgkmcnt(7)
  v_mfma_f32_32x32x16_bf16 v[80:95], a[20:23], v[168:171], v[80:95]
  ds_read_b64_tr_b16 a[46:47], v23 offset:60416
  ds_read_b64_tr_b16 a[48:49], v22 offset:61440
  ds_read_b64_tr_b16 a[50:51], v22 offset:62464
  v_perm_b32 v109, v59, v58, s63
  v_add_u32 v109, s51, v109
  v_and_or_b32 v109, v109, s50, v121
  v_mul_f32 v60, v60, v15
  v_mul_f32 v61, v61, v15
  v_mfma_f32_32x32x16_bf16 v[64:79], a[24:27], v[172:175], v[64:79]
  buffer_load_dwordx4 v12, s[24:27], s59 offen offset:2048 lds
  ds_read_b64_tr_b16 a[52:53], v23 offset:61440
  ds_read_b64_tr_b16 a[54:55], v23 offset:62464
  v_perm_b32 v110, v61, v60, s63
  v_add_u32 v110, s51, v110
  v_and_or_b32 v110, v110, s50, v122
  v_mfma_f32_32x32x16_bf16 v[80:95], a[28:31], v[172:175], v[80:95]
  ds_read_b64_tr_b16 a[56:57], v22 offset:63488
  ds_read_b64_tr_b16 a[58:59], v22 offset:64512
  ds_read_b64_tr_b16 a[60:61], v23 offset:63488
  v_mul_f32 v62, v62, v15
  v_mul_f32 v63, v63, v15
  v_perm_b32 v111, v63, v62, s63
  v_add_u32 v111, s51, v111
  v_and_or_b32 v111, v111, s50, v123
  s_waitcnt lgkmcnt(9)
  v_mfma_f32_32x32x16_bf16 v[64:79], a[32:35], v[176:179], v[64:79]
  buffer_load_dwordx4 v13, s[24:27], s59 offen offset:3072 lds
  ds_read_b64_tr_b16 a[62:63], v23 offset:64512
  s_waitcnt vmcnt(26)
  s_barrier
  ds_read_b64_tr_b16 a[0:1], v22 offset:0
  v_mfma_f32_32x32x16_bf16 v[80:95], a[36:39], v[176:179], v[80:95]
  ds_read_b64_tr_b16 a[2:3], v22 offset:1024
  ds_read_b64_tr_b16 a[4:5], v23 offset:0
  ds_read_b64_tr_b16 a[6:7], v23 offset:1024
  buffer_store_dwordx4 v[108:111], v1, s[32:35], s69 offen offset:3072 sc1
  s_nop 0
  v_mfma_f32_32x32x16_bf16 v[64:79], a[40:43], v[180:183], v[64:79]
  s_add_u32 m0, s39, 86016
  s_nop 0
  buffer_load_dwordx4 v14, s[24:27], s59 offen offset:0 lds
  s_waitcnt lgkmcnt(8)
  v_mfma_f32_32x32x16_bf16 v[80:95], a[44:47], v[180:183], v[80:95]
  ds_read_b64_tr_b16 a[8:9], v22 offset:2048
  ds_read_b64_tr_b16 a[10:11], v22 offset:3072
  ds_read_b64_tr_b16 a[12:13], v23 offset:2048
  v_xor_b32 v96, v96, v120
  v_xor_b32 v97, v97, v121
  v_mfma_f32_32x32x16_bf16 v[64:79], a[48:51], v[184:187], v[64:79]
  ds_read_b64_tr_b16 a[14:15], v23 offset:3072
  ds_read_b64_tr_b16 a[16:17], v22 offset:4096
  ds_read_b64_tr_b16 a[18:19], v22 offset:5120
  v_xor_b32 v98, v98, v122
  v_xor_b32 v99, v99, v123
  v_mfma_f32_32x32x16_bf16 v[80:95], a[52:55], v[184:187], v[80:95]
  ds_read_b64_tr_b16 a[20:21], v23 offset:4096
  ds_read_b64_tr_b16 a[22:23], v23 offset:5120
  v_xor_b32 v100, v100, v120
  v_xor_b32 v101, v101, v121
  s_waitcnt lgkmcnt(10)
  v_mfma_f32_32x32x16_bf16 v[64:79], a[56:59], v[188:191], v[64:79]
  ds_read_b64_tr_b16 a[24:25], v22 offset:6144
  ds_read_b64_tr_b16 a[26:27], v22 offset:7168
  v_xor_b32 v102, v102, v122
  v_xor_b32 v103, v103, v123
  v_xor_b32 v104, v104, v120
  v_mfma_f32_32x32x16_bf16 v[80:95], a[60:63], v[188:191], v[80:95]
  ds_read_b64_tr_b16 a[28:29], v23 offset:6144
  ds_read_b64_tr_b16 a[30:31], v23 offset:7168
  v_xor_b32 v105, v105, v121
  v_xor_b32 v106, v106, v122
  v_xor_b32 v107, v107, v123
  v_mfma_f32_32x32x16_bf16 v[64:79], a[0:3], v[192:195], v[64:79]
  ds_read_b64_tr_b16 a[32:33], v22 offset:8192
  ds_read_b64_tr_b16 a[34:35], v22 offset:9216
  v_xor_b32 v108, v108, v120
  v_xor_b32 v109, v109, v121
  s_waitcnt lgkmcnt(10)
  v_mfma_f32_32x32x16_bf16 v[80:95], a[4:7], v[192:195], v[80:95]
  ds_read_b64_tr_b16 a[36:37], v23 offset:8192
  ds_read_b64_tr_b16 a[38:39], v23 offset:9216
  v_xor_b32 v110, v110, v122
  v_xor_b32 v111, v111, v123
  v_mfma_f32_32x32x16_bf16 v[64:79], a[8:11], v[196:199], v[64:79]
  ds_read_b64_tr_b16 a[40:41], v22 offset:10240
  ds_read_b64_tr_b16 a[42:43], v22 offset:11264
  v_mfma_f32_32x32x16_bf16 v[80:95], a[12:15], v[196:199], v[80:95]
  ds_read_b64_tr_b16 a[44:45], v23 offset:10240
  ds_read_b64_tr_b16 a[46:47], v23 offset:11264
  s_waitcnt lgkmcnt(10)
  v_mfma_f32_32x32x16_bf16 v[64:79], a[16:19], v[200:203], v[64:79]
  ds_read_b64_tr_b16 a[48:49], v22 offset:12288
  ds_read_b64_tr_b16 a[50:51], v22 offset:13312
  v_mfma_f32_32x32x16_bf16 v[80:95], a[20:23], v[200:203], v[80:95]
  ds_read_b64_tr_b16 a[52:53], v23 offset:12288
  ds_read_b64_tr_b16 a[54:55], v23 offset:13312
  v_mfma_f32_32x32x16_bf16 v[64:79], a[24:27], v[204:207], v[64:79]
  ds_read_b64_tr_b16 a[56:57], v22 offset:14336
  ds_read_b64_tr_b16 a[58:59], v22 offset:15360
  s_waitcnt lgkmcnt(10)
  v_mfma_f32_32x32x16_bf16 v[80:95], a[28:31], v[204:207], v[80:95]
  ds_read_b64_tr_b16 a[60:61], v23 offset:14336
  ds_read_b64_tr_b16 a[62:63], v23 offset:15360
  v_mfma_f32_32x32x16_bf16 v[64:79], a[32:35], v[208:211], v[64:79]
  s_waitcnt vmcnt(24)
  s_barrier
  ds_read_b64_tr_b16 a[0:1], v22 offset:16384
  ds_read_b64_tr_b16 a[2:3], v22 offset:17408
  v_mfma_f32_32x32x16_bf16 v[80:95], a[36:39], v[208:211], v[80:95]
  ds_read_b64_tr_b16 a[4:5], v23 offset:16384
  ds_read_b64_tr_b16 a[6:7], v23 offset:17408
  s_waitcnt lgkmcnt(10)
  v_mfma_f32_32x32x16_bf16 v[64:79], a[40:43], v[212:215], v[64:79]
  ds_read_b64_tr_b16 a[8:9], v22 offset:18432
  ds_read_b64_tr_b16 a[10:11], v22 offset:19456
  v_mfma_f32_32x32x16_bf16 v[80:95], a[44:47], v[212:215], v[80:95]
  ds_read_b64_tr_b16 a[12:13], v23 offset:18432
  ds_read_b64_tr_b16 a[14:15], v23 offset:19456
  v_mfma_f32_32x32x16_bf16 v[64:79], a[48:51], v[216:219], v[64:79]
  ds_read_b64_tr_b16 a[16:17], v22 offset:20480
  ds_read_b64_tr_b16 a[18:19], v22 offset:21504
  s_waitcnt lgkmcnt(10)
  v_mfma_f32_32x32x16_bf16 v[80:95], a[52:55], v[216:219], v[80:95]
  ds_read_b64_tr_b16 a[20:21], v23 offset:20480
  ds_read_b64_tr_b16 a[22:23], v23 offset:21504
  v_mfma_f32_32x32x16_bf16 v[64:79], a[56:59], v[220:223], v[64:79]
  ds_read_b64_tr_b16 a[24:25], v22 offset:22528
  ds_read_b64_tr_b16 a[26:27], v22 offset:23552
  v_mfma_f32_32x32x16_bf16 v[80:95], a[60:63], v[220:223], v[80:95]
  ds_read_b64_tr_b16 a[28:29], v23 offset:22528
  ds_read_b64_tr_b16 a[30:31], v23 offset:23552
  s_waitcnt lgkmcnt(10)
  v_mfma_f32_32x32x16_bf16 v[64:79], a[0:3], v[224:227], v[64:79]
  ds_read_b64_tr_b16 a[32:33], v22 offset:24576
  ds_read_b64_tr_b16 a[34:35], v22 offset:25600
  v_mfma_f32_32x32x16_bf16 v[80:95], a[4:7], v[224:227], v[80:95]
  ds_read_b64_tr_b16 a[36:37], v23 offset:24576
  ds_read_b64_tr_b16 a[38:39], v23 offset:25600
  v_mfma_f32_32x32x16_bf16 v[64:79], a[8:11], v[228:231], v[64:79]
  ds_read_b64_tr_b16 a[40:41], v22 offset:26624
  ds_read_b64_tr_b16 a[42:43], v22 offset:27648
  s_waitcnt lgkmcnt(10)
  v_mfma_f32_32x32x16_bf16 v[80:95], a[12:15], v[228:231], v[80:95]
  ds_read_b64_tr_b16 a[44:45], v23 offset:26624
  ds_read_b64_tr_b16 a[46:47], v23 offset:27648
  v_mfma_f32_32x32x16_bf16 v[64:79], a[16:19], v[232:235], v[64:79]
  ds_read_b64_tr_b16 a[48:49], v22 offset:28672
  ds_read_b64_tr_b16 a[50:51], v22 offset:29696
  v_mfma_f32_32x32x16_bf16 v[80:95], a[20:23], v[232:235], v[80:95]
  ds_read_b64_tr_b16 a[52:53], v23 offset:28672
  ds_read_b64_tr_b16 a[54:55], v23 offset:29696
  s_waitcnt lgkmcnt(10)
  v_mfma_f32_32x32x16_bf16 v[64:79], a[24:27], v[236:239], v[64:79]
  ds_read_b64_tr_b16 a[56:57], v22 offset:30720
  ds_read_b64_tr_b16 a[58:59], v22 offset:31744
  v_mfma_f32_32x32x16_bf16 v[80:95], a[28:31], v[236:239], v[80:95]
  ds_read_b64_tr_b16 a[60:61], v23 offset:30720
  ds_read_b64_tr_b16 a[62:63], v23 offset:31744
  v_mfma_f32_32x32x16_bf16 v[64:79], a[32:35], v[240:243], v[64:79]
  s_waitcnt vmcnt(19)
  s_barrier
  ds_read_b64_tr_b16 a[0:1], v20 offset:12288
  ds_read_b64_tr_b16 a[2:3], v20 offset:14848
  s_waitcnt lgkmcnt(10)
  v_mfma_f32_32x32x16_bf16 v[80:95], a[36:39], v[240:243], v[80:95]
  ds_read_b64_tr_b16 a[4:5], v20 offset:12352
  ds_read_b64_tr_b16 a[6:7], v20 offset:14912
  v_mfma_f32_32x32x16_bf16 v[64:79], a[40:43], v[244:247], v[64:79]
  ds_read_b64_tr_b16 a[8:9], v20 offset:12416
  ds_read_b64_tr_b16 a[10:11], v20 offset:14976
  v_mfma_f32_32x32x16_bf16 v[80:95], a[44:47], v[244:247], v[80:95]
  ds_read_b64_tr_b16 a[12:13], v20 offset:12480
  ds_read_b64_tr_b16 a[14:15], v20 offset:15040
  s_waitcnt lgkmcnt(10)
  v_mfma_f32_32x32x16_bf16 v[64:79], a[48:51], v[248:251], v[64:79]
  ds_read_b64_tr_b16 a[16:17], v20 offset:12544
  ds_read_b64_tr_b16 a[18:19], v20 offset:15104
  v_mfma_f32_32x32x16_bf16 v[80:95], a[52:55], v[248:251], v[80:95]
  ds_read_b64_tr_b16 a[20:21], v20 offset:17408
  ds_read_b64_tr_b16 a[22:23], v20 offset:19968
  v_mfma_f32_32x32x16_bf16 v[64:79], a[56:59], v[252:255], v[64:79]
  ds_read_b64_tr_b16 a[24:25], v20 offset:17472
  ds_read_b64_tr_b16 a[26:27], v20 offset:20032
  s_waitcnt lgkmcnt(10)
  v_mfma_f32_32x32x16_bf16 v[80:95], a[60:63], v[252:255], v[80:95]
  ds_read_b64_tr_b16 a[28:29], v20 offset:17536
  ds_read_b64_tr_b16 a[30:31], v20 offset:20096
  v_mfma_f32_32x32x16_bf16 v[144:159], a[0:3], v[96:99], 0
  ds_read_b64_tr_b16 a[32:33], v20 offset:17600
  ds_read_b64_tr_b16 a[34:35], v20 offset:20160
  v_mfma_f32_32x32x16_bf16 v[160:175], a[4:7], v[96:99], 0
  ds_read_b64_tr_b16 a[36:37], v20 offset:17664
  ds_read_b64_tr_b16 a[38:39], v20 offset:20224
  s_waitcnt lgkmcnt(10)
  v_mfma_f32_32x32x16_bf16 v[176:191], a[8:11], v[96:99], 0
  ds_read_b64_tr_b16 a[40:41], v20 offset:22528
  ds_read_b64_tr_b16 a[42:43], v20 offset:25088
  v_mfma_f32_32x32x16_bf16 v[192:207], a[12:15], v[96:99], 0
  ds_read_b64_tr_b16 a[44:45], v20 offset:22592
  ds_read_b64_tr_b16 a[46:47], v20 offset:25152
  s_add_u32 s69, s69, 4096
  v_mul_f32 v64, v64, v15
  v_mul_f32 v65, v65, v15
  v_perm_b32 v128, v65, v64, s63
  s_mov_b64 exec, 0xfff
  buffer_load_dwordx4 v[28:31], v125, s[32:35], 0 offen sc1
  s_mov_b64 exec, -1
  v_mfma_f32_32x32x16_bf16 v[208:223], a[16:19], v[96:99], 0
  ds_read_b64_tr_b16 a[48:49], v20 offset:22656
  ds_read_b64_tr_b16 a[50:51], v20 offset:25216
  v_add_u32 v128, s51, v128
  v_and_or_b32 v128, v128, s50, v120
  v_mul_f32 v66, v66, v15
  v_mul_f32 v67, v67, v15
  s_waitcnt lgkmcnt(10)
  v_mfma_f32_32x32x16_bf16 v[144:159], a[20:23], v[100:103], v[144:159]
  ds_read_b64_tr_b16 a[52:53], v20 offset:22720
  ds_read_b64_tr_b16 a[54:55], v20 offset:25280
  v_perm_b32 v129, v67, v66, s63
  v_add_u32 v129, s51, v129
  v_and_or_b32 v129, v129, s50, v121
  v_mul_f32 v68, v68, v15
  v_mfma_f32_32x32x16_bf16 v[160:175], a[24:27], v[100:103], v[160:175]
  ds_read_b64_tr_b16 a[56:57], v20 offset:22784
  ds_read_b64_tr_b16 a[58:59], v20 offset:25344
  v_mul_f32 v69, v69, v15
  v_perm_b32 v130, v69, v68, s63
  v_add_u32 v130, s51, v130
  v_and_or_b32 v130, v130, s50, v122
  v_mfma_f32_32x32x16_bf16 v[176:191], a[28:31], v[100:103], v[176:191]
  ds_read_b64_tr_b16 a[60:61], v20 offset:27648
  ds_read_b64_tr_b16 a[62:63], v20 offset:30208
  v_mul_f32 v70, v70, v15
  v_mul_f32 v71, v71, v15
  v_perm_b32 v131, v71, v70, s63
  v_add_u32 v131, s51, v131
  s_waitcnt lgkmcnt(10)
  v_mfma_f32_32x32x16_bf16 v[192:207], a[32:35], v[100:103], v[192:207]
  ds_read_b64_tr_b16 a[0:1], v20 offset:27712
  ds_read_b64_tr_b16 a[2:3], v20 offset:30272
  v_and_or_b32 v131, v131, s50, v123
  buffer_store_dwordx4 v[128:131], v1, s[32:35], s69 offen offset:0 sc1
  v_mul_f32 v72, v72, v15
  v_mul_f32 v73, v73, v15
  v_mfma_f32_32x32x16_bf16 v[208:223], a[36:39], v[100:103], v[208:223]
  ds_read_b64_tr_b16 a[4:5], v20 offset:27776
  ds_read_b64_tr_b16 a[6:7], v20 offset:30336
  v_perm_b32 v132, v73, v72, s63
  v_add_u32 v132, s51, v132
  v_and_or_b32 v132, v132, s50, v120
  v_mul_f32 v74, v74, v15
  v_mfma_f32_32x32x16_bf16 v[144:159], a[40:43], v[104:107], v[144:159]
  ds_read_b64_tr_b16 a[8:9], v20 offset:27840
  ds_read_b64_tr_b16 a[10:11], v20 offset:30400
  v_mul_f32 v75, v75, v15
  v_perm_b32 v133, v75, v74, s63
  v_add_u32 v133, s51, v133
  v_and_or_b32 v133, v133, s50, v121
  s_waitcnt lgkmcnt(10)
  v_mfma_f32_32x32x16_bf16 v[160:175], a[44:47], v[104:107], v[160:175]
  ds_read_b64_tr_b16 a[12:13], v20 offset:27904
  ds_read_b64_tr_b16 a[14:15], v20 offset:30464
  v_mul_f32 v76, v76, v15
  v_mul_f32 v77, v77, v15
  v_perm_b32 v134, v77, v76, s63
  v_add_u32 v134, s51, v134
  v_mfma_f32_32x32x16_bf16 v[176:191], a[48:51], v[104:107], v[176:191]
  s_waitcnt vmcnt(2)
  s_barrier
  ds_read_b64_tr_b16 a[16:17], v19 offset:57344
  ds_read_b64_tr_b16 a[18:19], v19 offset:59904
  v_and_or_b32 v134, v134, s50, v122
  v_mul_f32 v78, v78, v15
  v_mul_f32 v79, v79, v15
  v_perm_b32 v135, v79, v78, s63
  v_mfma_f32_32x32x16_bf16 v[192:207], a[52:55], v[104:107], v[192:207]
  ds_read_b64_tr_b16 a[20:21], v19 offset:57408
  ds_read_b64_tr_b16 a[22:23], v19 offset:59968
  v_add_u32 v135, s51, v135
  v_and_or_b32 v135, v135, s50, v123
  buffer_store_dwordx4 v[132:135], v1, s[32:35], s69 offen offset:1024 sc1
  v_mul_f32 v80, v80, v15
  s_waitcnt lgkmcnt(10)
  v_mfma_f32_32x32x16_bf16 v[208:223], a[56:59], v[104:107], v[208:223]
  ds_read_b64_tr_b16 a[24:25], v19 offset:57472
  ds_read_b64_tr_b16 a[26:27], v19 offset:60032
  v_mul_f32 v81, v81, v15
  v_perm_b32 v136, v81, v80, s63
  v_add_u32 v136, s51, v136
  v_and_or_b32 v136, v136, s50, v120
  v_mfma_f32_32x32x16_bf16 v[144:159], a[60:63], v[108:111], v[144:159]
  ds_read_b64_tr_b16 a[28:29], v19 offset:57536
  ds_read_b64_tr_b16 a[30:31], v19 offset:60096
  v_mul_f32 v82, v82, v15
  v_mul_f32 v83, v83, v15
  v_perm_b32 v137, v83, v82, s63
  v_add_u32 v137, s51, v137
  v_mfma_f32_32x32x16_bf16 v[160:175], a[0:3], v[108:111], v[160:175]
  ds_read_b64_tr_b16 a[32:33], v19 offset:57600
  ds_read_b64_tr_b16 a[34:35], v19 offset:60160
  v_and_or_b32 v137, v137, s50, v121
  v_mul_f32 v84, v84, v15
  v_mul_f32 v85, v85, v15
  v_perm_b32 v138, v85, v84, s63
  s_waitcnt lgkmcnt(10)
  v_mfma_f32_32x32x16_bf16 v[176:191], a[4:7], v[108:111], v[176:191]
  ds_read_b64_tr_b16 a[36:37], v19 offset:62464
  ds_read_b64_tr_b16 a[38:39], v19 offset:65024
  v_add_u32 v138, s51, v138
  v_and_or_b32 v138, v138, s50, v122
  v_mul_f32 v86, v86, v15
  v_mul_f32 v87, v87, v15
  v_mfma_f32_32x32x16_bf16 v[192:207], a[8:11], v[108:111], v[192:207]
  ds_read_b64_tr_b16 a[40:41], v19 offset:62528
  ds_read_b64_tr_b16 a[42:43], v19 offset:65088
  v_perm_b32 v139, v87, v86, s63
  v_add_u32 v139, s51, v139
  v_and_or_b32 v139, v139, s50, v123
  buffer_store_dwordx4 v[136:139], v1, s[32:35], s69 offen offset:2048 sc1
  v_mfma_f32_32x32x16_bf16 v[208:223], a[12:15], v[108:111], v[208:223]
  ds_read_b64_tr_b16 a[44:45], v19 offset:62592
  ds_read_b64_tr_b16 a[46:47], v19 offset:65152
  v_mul_f32 v88, v88, v15
  v_mul_f32 v89, v89, v15
  v_perm_b32 v140, v89, v88, s63
  v_add_u32 v140, s51, v140
  s_waitcnt vmcnt(3)
  v_xor_b32 v28, v28, v120
  v_xor_b32 v29, v29, v121
  v_or_b32 v124, v28, v29
  v_xor_b32 v30, v30, v122
  v_xor_b32 v31, v31, v123
  v_or3_b32 v124, v124, v30, v31
  v_and_b32 v124, s51, v124
  v_cmp_ne_u32 vcc, 0, v124
  s_nop 0
  s_and_b32 s68, vcc_lo, 15
  s_cselect_b32 s92, s96, s44
  s_and_b32 s68, vcc_lo, 240
  s_cselect_b32 s93, s96, s45
  s_and_b32 s68, vcc_lo, 3840
  s_cselect_b32 s94, s96, s46
  v_and_or_b32 v140, v140, s50, v120
  v_mul_f32 v90, v90, v15
  v_mul_f32 v91, v91, v15
  v_perm_b32 v141, v91, v90, s63
  v_add_u32 v141, s51, v141
  v_and_or_b32 v141, v141, s50, v121
  v_mul_f32 v92, v92, v15
  v_mul_f32 v93, v93, v15
  v_perm_b32 v142, v93, v92, s63
  v_add_u32 v142, s51, v142
  v_and_or_b32 v142, v142, s50, v122
  v_mul_f32 v94, v94, v15
  v_mul_f32 v95, v95, v15
  v_perm_b32 v143, v95, v94, s63
  v_add_u32 v143, s51, v143
  v_and_or_b32 v143, v143, s50, v123
  buffer_store_dwordx4 v[140:143], v1, s[32:35], s69 offen offset:3072 sc1
  s_nop 0
  v_xor_b32 v128, v128, v120
  v_xor_b32 v129, v129, v121
  v_xor_b32 v130, v130, v122
  v_xor_b32 v131, v131, v123
  v_xor_b32 v132, v132, v120
  v_xor_b32 v133, v133, v121
  v_xor_b32 v134, v134, v122
  v_xor_b32 v135, v135, v123
  v_xor_b32 v136, v136, v120
  v_xor_b32 v137, v137, v121
  v_xor_b32 v138, v138, v122
  v_xor_b32 v139, v139, v123
  v_xor_b32 v140, v140, v120
  v_xor_b32 v141, v141, v121
  v_xor_b32 v142, v142, v122
  v_xor_b32 v143, v143, v123
  s_waitcnt lgkmcnt(10)
  v_mfma_f32_32x32x16_bf16 v[144:159], a[16:19], v[128:131], v[144:159]
  buffer_load_dwordx4 v[32:35], v1, s[32:35], s92 offen offset:0 sc1
  ds_read_b64_tr_b16 a[48:49], v19 offset:62656
  ds_read_b64_tr_b16 a[50:51], v19 offset:65216
  v_mfma_f32_32x32x16_bf16 v[160:175], a[20:23], v[128:131], v[160:175]
  buffer_load_dwordx4 v[36:39], v1, s[32:35], s92 offen offset:1024 sc1
  ds_read_b64_tr_b16 a[52:53], v19 offset:62720
  ds_read_b64_tr_b16 a[54:55], v19 offset:65280
  v_mfma_f32_32x32x16_bf16 v[176:191], a[24:27], v[128:131], v[176:191]
  buffer_load_dwordx4 v[40:43], v1, s[32:35], s92 offen offset:2048 sc1
  ds_read_b64_tr_b16 a[56:57], v20 offset:2048
  s_waitcnt lgkmcnt(9)
  v_mfma_f32_32x32x16_bf16 v[192:207], a[28:31], v[128:131], v[192:207]
  buffer_load_dwordx4 v[44:47], v1, s[32:35], s92 offen offset:3072 sc1
  ds_read_b64_tr_b16 a[58:59], v20 offset:4608
  ds_read_b64_tr_b16 a[60:61], v20 offset:2112
  v_mfma_f32_32x32x16_bf16 v[208:223], a[32:35], v[128:131], v[208:223]
  buffer_load_dwordx4 v[48:51], v1, s[32:35], s93 offen offset:0 sc1
  ds_read_b64_tr_b16 a[62:63], v20 offset:4672
  ds_read_b64_tr_b16 a[0:1], v20 offset:2176
  v_mfma_f32_32x32x16_bf16 v[144:159], a[36:39], v[132:135], v[144:159]
  buffer_load_dwordx4 v[52:55], v1, s[32:35], s93 offen offset:1024 sc1
  ds_read_b64_tr_b16 a[2:3], v20 offset:4736
  s_waitcnt lgkmcnt(8)
  v_mfma_f32_32x32x16_bf16 v[160:175], a[40:43], v[132:135], v[160:175]
  buffer_load_dwordx4 v[56:59], v1, s[32:35], s93 offen offset:2048 sc1
  ds_read_b64_tr_b16 a[4:5], v20 offset:2240
  ds_read_b64_tr_b16 a[6:7], v20 offset:4800
  v_mfma_f32_32x32x16_bf16 v[176:191], a[44:47], v[132:135], v[176:191]
  buffer_load_dwordx4 v[60:63], v1, s[32:35], s93 offen offset:3072 sc1
  ds_read_b64_tr_b16 a[8:9], v20 offset:2304
  ds_read_b64_tr_b16 a[10:11], v20 offset:4864
  v_mfma_f32_32x32x16_bf16 v[192:207], a[48:51], v[132:135], v[192:207]
  buffer_load_dwordx4 v[224:227], v1, s[32:35], s94 offen offset:0 sc1
  ds_read_b64_tr_b16 a[12:13], v20 offset:7168
  s_waitcnt lgkmcnt(7)
  v_mfma_f32_32x32x16_bf16 v[208:223], a[52:55], v[132:135], v[208:223]
  buffer_load_dwordx4 v[228:231], v1, s[32:35], s94 offen offset:1024 sc1
  ds_read_b64_tr_b16 a[14:15], v20 offset:9728
  ds_read_b64_tr_b16 a[16:17], v20 offset:7232
  v_mfma_f32_32x32x16_bf16 v[144:159], a[56:59], v[136:139], v[144:159]
  buffer_load_dwordx4 v[232:235], v1, s[32:35], s94 offen offset:2048 sc1
  ds_read_b64_tr_b16 a[18:19], v20 offset:9792
  ds_read_b64_tr_b16 a[20:21], v20 offset:7296
  v_mfma_f32_32x32x16_bf16 v[160:175], a[60:63], v[136:139], v[160:175]
  buffer_load_dwordx4 v[236:239], v1, s[32:35], s94 offen offset:3072 sc1
  ds_read_b64_tr_b16 a[22:23], v20 offset:9856
  s_waitcnt lgkmcnt(6)
  v_mfma_f32_32x32x16_bf16 v[176:191], a[0:3], v[136:139], v[176:191]
  ds_read_b64_tr_b16 a[24:25], v20 offset:7360
  ds_read_b64_tr_b16 a[26:27], v20 offset:9920
  ds_read_b64_tr_b16 a[28:29], v20 offset:7424
  v_mfma_f32_32x32x16_bf16 v[192:207], a[4:7], v[136:139], v[192:207]
  ds_read_b64_tr_b16 a[30:31], v20 offset:9984
  ds_read_b64_tr_b16 a[32:33], v19 offset:36864
  ds_read_b64_tr_b16 a[34:35], v19 offset:39424
  v_mfma_f32_32x32x16_bf16 v[208:223], a[8:11], v[136:139], v[208:223]
  ds_read_b64_tr_b16 a[36:37], v19 offset:36928
  ds_read_b64_tr_b16 a[38:39], v19 offset:39488
  ds_read_b64_tr_b16 a[40:41], v19 offset:36992
  s_waitcnt lgkmcnt(9)
  v_mfma_f32_32x32x16_bf16 v[144:159], a[12:15], v[140:143], v[144:159]
  s_add_u32 s59, s5, 3
  s_and_b32 s59, s59, 3
  s_mul_i32 s59, s59, 163840
  s_lshl_b32 s60, s39, 2
  s_add_u32 s59, s59, s60
  s_add_u32 m0, s39, 61440
  s_add_u32 s59, s59, 0
  buffer_load_dwordx4 v10, s[24:27], s59 offen offset:0 lds
  v_mfma_f32_32x32x16_bf16 v[160:175], a[16:19], v[140:143], v[160:175]
  ds_read_b64_tr_b16 a[42:43], v19 offset:39552
  ds_read_b64_tr_b16 a[44:45], v19 offset:37056
  ds_read_b64_tr_b16 a[46:47], v19 offset:39616
  s_waitcnt vmcnt(9)
  v_xor_b32 v32, v32, v120
  v_xor_b32 v33, v33, v121
  v_mfma_f32_32x32x16_bf16 v[176:191], a[20:23], v[140:143], v[176:191]
  buffer_load_dwordx4 v11, s[24:27], s59 offen offset:1024 lds
  ds_read_b64_tr_b16 a[48:49], v19 offset:37120
  s_waitcnt lgkmcnt(7)
  v_mfma_f32_32x32x16_bf16 v[192:207], a[24:27], v[140:143], v[192:207]
  ds_read_b64_tr_b16 a[50:51], v19 offset:39680
  ds_read_b64_tr_b16 a[52:53], v19 offset:41984
  ds_read_b64_tr_b16 a[54:55], v19 offset:44544
  v_or_b32 v124, v32, v33
  v_xor_b32 v34, v34, v122
  v_mfma_f32_32x32x16_bf16 v[208:223], a[28:31], v[140:143], v[208:223]
  buffer_load_dwordx4 v12, s[24:27], s59 offen offset:2048 lds
  ds_read_b64_tr_b16 a[56:57], v19 offset:42048
  ds_read_b64_tr_b16 a[58:59], v19 offset:44608
  v_xor_b32 v35, v35, v123
  v_or3_b32 v124, v124, v34, v35
  v_xor_b32 v36, v36, v120
  v_xor_b32 v37, v37, v121
  v_or3_b32 v124, v124, v36, v37
  v_xor_b32 v38, v38, v122
  v_xor_b32 v39, v39, v123
  v_or3_b32 v124, v124, v38, v39
  v_xor_b32 v40, v40, v120
  v_xor_b32 v41, v41, v121
  v_or3_b32 v124, v124, v40, v41
  v_xor_b32 v42, v42, v122
  v_xor_b32 v43, v43, v123
  v_or3_b32 v124, v124, v42, v43
  v_xor_b32 v44, v44, v120
  v_xor_b32 v45, v45, v121
  v_or3_b32 v124, v124, v44, v45
  v_xor_b32 v46, v46, v122
  v_xor_b32 v47, v47, v123
  v_or3_b32 v124, v124, v46, v47
  v_and_b32 v124, s51, v124
  v_cmp_ne_u32 vcc, 0, v124
  s_cbranch_vccnz L_retry01
L_ok01:
  v_mfma_f32_32x32x16_bf16 v[144:159], a[32:35], v[32:35], v[144:159]
  ds_read_b64_tr_b16 a[60:61], v19 offset:42112
  ds_read_b64_tr_b16 a[62:63], v19 offset:44672
  ds_read_b64_tr_b16 a[0:1], v19 offset:42176
  s_waitcnt lgkmcnt(9)
  v_mfma_f32_32x32x16_bf16 v[160:175], a[36:39], v[32:35], v[160:175]
  buffer_load_dwordx4 v13, s[24:27], s59 offen offset:3072 lds
  ds_read_b64_tr_b16 a[2:3], v19 offset:44736
  ds_read_b64_tr_b16 a[4:5], v19 offset:42240
  v_mfma_f32_32x32x16_bf16 v[176:191], a[40:43], v[32:35], v[176:191]
  ds_read_b64_tr_b16 a[6:7], v19 offset:44800
  ds_read_b64_tr_b16 a[8:9], v19 offset:47104
  ds_read_b64_tr_b16 a[10:11], v19 offset:49664
  v_mfma_f32_32x32x16_bf16 v[192:207], a[44:47], v[32:35], v[192:207]
  s_add_u32 m0, s39, 65536
  s_nop 0
  buffer_load_dwordx4 v14, s[24:27], s59 offen offset:0 lds
  s_waitcnt lgkmcnt(8)
  v_mfma_f32_32x32x16_bf16 v[208:223], a[48:51], v[32:35], v[208:223]
  ds_read_b64_tr_b16 a[12:13], v19 offset:47168
  ds_read_b64_tr_b16 a[14:15], v19 offset:49728
  ds_read_b64_tr_b16 a[16:17], v19 offset:47232
  v_mfma_f32_32x32x16_bf16 v[144:159], a[52:55], v[36:39], v[144:159]
  s_add_u32 s59, s5, 1
  s_and_b32 s59, s59, 3
  s_mul_i32 s59, s59, 163840
  s_lshl_b32 s60, s39, 2
  s_add_u32 s59, s59, s60
  s_add_u32 m0, s39, 40960
  s_add_u32 s59, s59, 81920
  buffer_load_dwordx4 v10, s[24:27], s59 offen offset:0 lds
  v_mfma_f32_32x32x16_bf16 v[160:175], a[56:59], v[36:39], v[160:175]
  ds_read_b64_tr_b16 a[18:19], v19 offset:49792
  ds_read_b64_tr_b16 a[20:21], v19 offset:47296
  ds_read_b64_tr_b16 a[22:23], v19 offset:49856
  s_waitcnt lgkmcnt(8)
  v_mfma_f32_32x32x16_bf16 v[176:191], a[60:63], v[36:39], v[176:191]
  buffer_load_dwordx4 v11, s[24:27], s59 offen offset:1024 lds
  ds_read_b64_tr_b16 a[24:25], v19 offset:47360
  ds_read_b64_tr_b16 a[26:27], v19 offset:49920
  v_mfma_f32_32x32x16_bf16 v[192:207], a[0:3], v[36:39], v[192:207]
  ds_read_b64_tr_b16 a[28:29], v19 offset:52224
  ds_read_b64_tr_b16 a[30:31], v19 offset:54784
  ds_read_b64_tr_b16 a[32:33], v19 offset:52288
  v_mfma_f32_32x32x16_bf16 v[208:223], a[4:7], v[36:39], v[208:223]
  buffer_load_dwordx4 v12, s[24:27], s59 offen offset:2048 lds
  ds_read_b64_tr_b16 a[34:35], v19 offset:54848
  s_waitcnt lgkmcnt(8)
  v_mfma_f32_32x32x16_bf16 v[144:159], a[8:11], v[40:43], v[144:159]
  ds_read_b64_tr_b16 a[36:37], v19 offset:52352
  ds_read_b64_tr_b16 a[38:39], v19 offset:54912
  ds_read_b64_tr_b16 a[40:41], v19 offset:52416
  s_waitcnt vmcnt(12)
  v_xor_b32 v48, v48, v120
  v_xor_b32 v49, v49, v121
  v_mfma_f32_32x32x16_bf16 v[160:175], a[12:15], v[40:43], v[160:175]
  buffer_load_dwordx4 v13, s[24:27], s59 offen offset:3072 lds
  ds_read_b64_tr_b16 a[42:43], v19 offset:54976
  ds_read_b64_tr_b16 a[44:45], v19 offset:52480
  v_mfma_f32_32x32x16_bf16 v[176:191], a[16:19], v[40:43], v[176:191]
  ds_read_b64_tr_b16 a[46:47], v19 offset:55040
  ds_read_b64_tr_b16 a[48:49], v19 offset:16384
  ds_read_b64_tr_b16 a[50:51], v19 offset:18944
  v_or_b32 v124, v48, v49
  s_waitcnt lgkmcnt(10)
  v_mfma_f32_32x32x16_bf16 v[192:207], a[20:23], v[40:43], v[192:207]
  s_add_u32 m0, s39, 45056
  s_nop 0
  buffer_load_dwordx4 v14, s[24:27], s59 offen offset:0 lds
  v_mfma_f32_32x32x16_bf16 v[208:223], a[24:27], v[40:43], v[208:223]
  ds_read_b64_tr_b16 a[52:53], v19 offset:16448
  ds_read_b64_tr_b16 a[54:55], v19 offset:19008
  ds_read_b64_tr_b16 a[56:57], v19 offset:16512
  v_xor_b32 v50, v50, v122
  v_xor_b32 v51, v51, v123
  v_mfma_f32_32x32x16_bf16 v[144:159], a[28:31], v[44:47], v[144:159]
  ds_read_b64_tr_b16 a[58:59], v19 offset:19072
  ds_read_b64_tr_b16 a[60:61], v19 offset:16576
  ds_read_b64_tr_b16 a[62:63], v19 offset:19136
  v_or3_b32 v124, v124, v50, v51
  s_waitcnt lgkmcnt(10)
  v_mfma_f32_32x32x16_bf16 v[160:175], a[32:35], v[44:47], v[160:175]
  ds_read_b64_tr_b16 a[0:1], v19 offset:16640
  ds_read_b64_tr_b16 a[2:3], v19 offset:19200
  v_xor_b32 v52, v52, v120
  v_xor_b32 v53, v53, v121
  v_or3_b32 v124, v124, v52, v53
  v_mfma_f32_32x32x16_bf16 v[176:191], a[36:39], v[44:47], v[176:191]
  ds_read_b64_tr_b16 a[4:5], v19 offset:21504
  ds_read_b64_tr_b16 a[6:7], v19 offset:24064
  v_xor_b32 v54, v54, v122
  v_xor_b32 v55, v55, v123
  v_or3_b32 v124, v124, v54, v55
  v_mfma_f32_32x32x16_bf16 v[192:207], a[40:43], v[44:47], v[192:207]
  ds_read_b64_tr_b16 a[8:9], v19 offset:21568
  ds_read_b64_tr_b16 a[10:11], v19 offset:24128
  v_xor_b32 v56, v56, v120
  v_xor_b32 v57, v57, v121
  s_waitcnt lgkmcnt(10)
  v_mfma_f32_32x32x16_bf16 v[208:223], a[44:47], v[44:47], v[208:223]
  ds_read_b64_tr_b16 a[12:13], v19 offset:21632
  ds_read_b64_tr_b16 a[14:15], v19 offset:24192
  v_or3_b32 v124, v124, v56, v57
  v_xor_b32 v58, v58, v122
  v_xor_b32 v59, v59, v123
  v_or3_b32 v124, v124, v58, v59
  v_xor_b32 v60, v60, v120
  v_xor_b32 v61, v61, v121
  v_or3_b32 v124, v124, v60, v61
  v_xor_b32 v62, v62, v122
  v_xor_b32 v63, v63, v123
  v_or3_b32 v124, v124, v62, v63
  v_and_b32 v124, s51, v124
  v_cmp_ne_u32 vcc, 0, v124
  s_cbranch_vccnz L_retry02
L_ok02:
  s_mov_b32 s92, s47
  s_mov_b32 s93, s48
  s_mov_b32 s94, s49
  v_mfma_f32_32x32x16_bf16 v[144:159], a[48:51], v[48:51], v[144:159]
  buffer_load_dwordx4 v[64:67], v1, s[32:35], s92 offen offset:0 sc1
  ds_read_b64_tr_b16 a[16:17], v19 offset:21696
  ds_read_b64_tr_b16 a[18:19], v19 offset:24256
  v_mfma_f32_32x32x16_bf16 v[160:175], a[52:55], v[48:51], v[160:175]
  ds_read_b64_tr_b16 a[20:21], v19 offset:21760
  ds_read_b64_tr_b16 a[22:23], v19 offset:24320
  s_waitcnt lgkmcnt(10)
  v_mfma_f32_32x32x16_bf16 v[176:191], a[56:59], v[48:51], v[176:191]
  buffer_load_dwordx4 v[68:71], v1, s[32:35], s92 offen offset:1024 sc1
  ds_read_b64_tr_b16 a[24:25], v19 offset:26624
  ds_read_b64_tr_b16 a[26:27], v19 offset:29184
  v_mfma_f32_32x32x16_bf16 v[192:207], a[60:63], v[48:51], v[192:207]
  ds_read_b64_tr_b16 a[28:29], v19 offset:26688
  ds_read_b64_tr_b16 a[30:31], v19 offset:29248
  v_mfma_f32_32x32x16_bf16 v[208:223], a[0:3], v[48:51], v[208:223]
  buffer_load_dwordx4 v[72:75], v1, s[32:35], s92 offen offset:2048 sc1
  ds_read_b64_tr_b16 a[32:33], v19 offset:26752
  s_waitcnt lgkmcnt(9)
  v_mfma_f32_32x32x16_bf16 v[144:159], a[4:7], v[52:55], v[144:159]
  ds_read_b64_tr_b16 a[34:35], v19 offset:29312
  ds_read_b64_tr_b16 a[36:37], v19 offset:26816
  ds_read_b64_tr_b16 a[38:39], v19 offset:29376
  v_mfma_f32_32x32x16_bf16 v[160:175], a[8:11], v[52:55], v[160:175]
  buffer_load_dwordx4 v[76:79], v1, s[32:35], s92 offen offset:3072 sc1
  ds_read_b64_tr_b16 a[40:41], v19 offset:26880
  ds_read_b64_tr_b16 a[42:43], v19 offset:29440
  v_mfma_f32_32x32x16_bf16 v[176:191], a[12:15], v[52:55], v[176:191]
  ds_read_b64_tr_b16 a[44:45], v19 offset:31744
  ds_read_b64_tr_b16 a[46:47], v19 offset:34304
  s_waitcnt lgkmcnt(10)
  v_mfma_f32_32x32x16_bf16 v[192:207], a[16:19], v[52:55], v[192:207]
  buffer_load_dwordx4 v[80:83], v1, s[32:35], s93 offen offset:0 sc1
  ds_read_b64_tr_b16 a[48:49], v19 offset:31808
  ds_read_b64_tr_b16 a[50:51], v19 offset:34368
  v_mfma_f32_32x32x16_bf16 v[208:223], a[20:23], v[52:55], v[208:223]
  ds_read_b64_tr_b16 a[52:53], v19 offset:31872
  ds_read_b64_tr_b16 a[54:55], v19 offset:34432
  v_mfma_f32_32x32x16_bf16 v[144:159], a[24:27], v[56:59], v[144:159]
  buffer_load_dwordx4 v[84:87], v1, s[32:35], s93 offen offset:1024 sc1
  ds_read_b64_tr_b16 a[56:57], v19 offset:31936
  s_waitcnt lgkmcnt(9)
  v_mfma_f32_32x32x16_bf16 v[160:175], a[28:31], v[56:59], v[160:175]
  ds_read_b64_tr_b16 a[58:59], v19 offset:34496
  ds_read_b64_tr_b16 a[60:61], v19 offset:32000
  ds_read_b64_tr_b16 a[62:63], v19 offset:34560
  s_waitcnt vmcnt(16)
  v_xor_b32 v224, v224, v120
  v_xor_b32 v225, v225, v121
  v_mfma_f32_32x32x16_bf16 v[176:191], a[32:35], v[56:59], v[176:191]
  buffer_load_dwordx4 v[88:91], v1, s[32:35], s93 offen offset:2048 sc1
  s_waitcnt vmcnt(7)
  s_barrier
  ds_read_b64_tr_b16 a[0:1], v18 offset:61440
  ds_read_b64_tr_b16 a[2:3], v18 offset:64000
  v_mfma_f32_32x32x16_bf16 v[192:207], a[36:39], v[56:59], v[192:207]
  ds_read_b64_tr_b16 a[4:5], v18 offset:61504
  ds_read_b64_tr_b16 a[6:7], v18 offset:64064
  v_or_b32 v124, v224, v225
  v_xor_b32 v226, v226, v122
  s_waitcnt lgkmcnt(10)
  v_mfma_f32_32x32x16_bf16 v[208:223], a[40:43], v[56:59], v[208:223]
  buffer_load_dwordx4 v[92:95], v1, s[32:35], s93 offen offset:3072 sc1
  ds_read_b64_tr_b16 a[8:9], v18 offset:61568
  ds_read_b64_tr_b16 a[10:11], v18 offset:64128
  v_mfma_f32_32x32x16_bf16 v[144:159], a[44:47], v[60:63], v[144:159]
  ds_read_b64_tr_b16 a[12:13], v18 offset:61632
  ds_read_b64_tr_b16 a[14:15], v18 offset:64192
  v_xor_b32 v227, v227, v123
  v_or3_b32 v124, v124, v226, v227
  v_xor_b32 v228, v228, v120
  v_mfma_f32_32x32x16_bf16 v[160:175], a[48:51], v[60:63], v[160:175]
  buffer_load_dwordx4 v[240:243], v1, s[32:35], s94 offen offset:0 sc1
  ds_read_b64_tr_b16 a[16:17], v18 offset:61696
  s_waitcnt lgkmcnt(9)
  v_mfma_f32_32x32x16_bf16 v[176:191], a[52:55], v[60:63], v[176:191]
  ds_read_b64_tr_b16 a[18:19], v18 offset:64256
  ds_read_b64_tr_b16 a[20:21], v19 offset:1024
  ds_read_b64_tr_b16 a[22:23], v19 offset:3584
  v_xor_b32 v229, v229, v121
  v_or3_b32 v124, v124, v228, v229
  v_mfma_f32_32x32x16_bf16 v[192:207], a[56:59], v[60:63], v[192:207]
  buffer_load_dwordx4 v[244:247], v1, s[32:35], s94 offen offset:1024 sc1
  ds_read_b64_tr_b16 a[24:25], v19 offset:1088
  ds_read_b64_tr_b16 a[26:27], v19 offset:3648
  v_mfma_f32_32x32x16_bf16 v[208:223], a[60:63], v[60:63], v[208:223]
  ds_read_b64_tr_b16 a[28:29], v19 offset:1152
  ds_read_b64_tr_b16 a[30:31], v19 offset:3712
  v_xor_b32 v230, v230, v122
  v_xor_b32 v231, v231, v123
  v_or3_b32 v124, v124, v230, v231
  v_xor_b32 v232, v232, v120
  v_xor_b32 v233, v233, v121
  v_or3_b32 v124, v124, v232, v233
  v_xor_b32 v234, v234, v122
  v_xor_b32 v235, v235, v123
  v_or3_b32 v124, v124, v234, v235
  v_xor_b32 v236, v236, v120
  v_xor_b32 v237, v237, v121
  v_or3_b32 v124, v124, v236, v237
  v_xor_b32 v238, v238, v122
  v_xor_b32 v239, v239, v123
  v_or3_b32 v124, v124, v238, v239
  v_and_b32 v124, s51, v124
  v_cmp_ne_u32 vcc, 0, v124
  s_cbranch_vccnz L_retry03
L_ok03:
  s_waitcnt lgkmcnt(10)
  v_mfma_f32_32x32x16_bf16 v[144:159], a[0:3], v[224:227], v[144:159]
  buffer_load_dwordx4 v[248:251], v1, s[32:35], s94 offen offset:2048 sc1
  ds_read_b64_tr_b16 a[32:33], v19 offset:1216
  ds_read_b64_tr_b16 a[34:35], v19 offset:3776
  v_mfma_f32_32x32x16_bf16 v[160:175], a[4:7], v[224:227], v[160:175]
  ds_read_b64_tr_b16 a[36:37], v19 offset:1280
  ds_read_b64_tr_b16 a[38:39], v19 offset:3840
  v_mfma_f32_32x32x16_bf16 v[176:191], a[8:11], v[224:227], v[176:191]
  buffer_load_dwordx4 v[252:255], v1, s[32:35], s94 offen offset:3072 sc1
  ds_read_b64_tr_b16 a[40:41], v19 offset:6144
  s_waitcnt lgkmcnt(9)
  v_mfma_f32_32x32x16_bf16 v[192:207], a[12:15], v[224:227], v[192:207]
  ds_read_b64_tr_b16 a[42:43], v19 offset:8704
  ds_read_b64_tr_b16 a[44:45], v19 offset:6208
  ds_read_b64_tr_b16 a[46:47], v19 offset:8768
  v_mfma_f32_32x32x16_bf16 v[208:223], a[16:19], v[224:227], v[208:223]
  s_add_u32 s59, s5, 2
  s_and_b32 s59, s59, 3
  s_mul_i32 s59, s59, 163840
  s_lshl_b32 s60, s39, 2
  s_add_u32 s59, s59, s60
  s_add_u32 m0, s39, 20480
  s_add_u32 s59, s59, 81920
  buffer_load_dwordx4 v10, s[24:27], s59 offen offset:0 lds
  v_mfma_f32_32x32x16_bf16 v[144:159], a[20:23], v[228:231], v[144:159]
  ds_read_b64_tr_b16 a[48:49], v19 offset:6272
  ds_read_b64_tr_b16 a[50:51], v19 offset:8832
  ds_read_b64_tr_b16 a[52:53], v19 offset:6336
  s_waitcnt lgkmcnt(9)
  v_mfma_f32_32x32x16_bf16 v[160:175], a[24:27], v[228:231], v[160:175]
  buffer_load_dwordx4 v11, s[24:27], s59 offen offset:1024 lds
  ds_read_b64_tr_b16 a[54:55], v19 offset:8896
  ds_read_b64_tr_b16 a[56:57], v19 offset:6400
  v_mfma_f32_32x32x16_bf16 v[176:191], a[28:31], v[228:231], v[176:191]
  ds_read_b64_tr_b16 a[58:59], v19 offset:8960
  ds_read_b64_tr_b16 a[60:61], v19 offset:11264
  ds_read_b64_tr_b16 a[62:63], v19 offset:13824
  v_mfma_f32_32x32x16_bf16 v[192:207], a[32:35], v[228:231], v[192:207]
  buffer_load_dwordx4 v12, s[24:27], s59 offen offset:2048 lds
  ds_read_b64_tr_b16 a[0:1], v19 offset:11328
  s_waitcnt lgkmcnt(9)
  v_mfma_f32_32x32x16_bf16 v[208:223], a[36:39], v[228:231], v[208:223]
  ds_read_b64_tr_b16 a[2:3], v19 offset:13888
  ds_read_b64_tr_b16 a[4:5], v19 offset:11392
  ds_read_b64_tr_b16 a[6:7], v19 offset:13952
  v_mfma_f32_32x32x16_bf16 v[144:159], a[40:43], v[232:235], v[144:159]
  buffer_load_dwordx4 v13, s[24:27], s59 offen offset:3072 lds
  ds_read_b64_tr_b16 a[8:9], v19 offset:11456
  ds_read_b64_tr_b16 a[10:11], v19 offset:14016
  v_mfma_f32_32x32x16_bf16 v[160:175], a[44:47], v[232:235], v[160:175]
  ds_read_b64_tr_b16 a[12:13], v19 offset:11520
  ds_read_b64_tr_b16 a[14:15], v19 offset:14080
  s_waitcnt lgkmcnt(10)
  v_mfma_f32_32x32x16_bf16 v[176:191], a[48:51], v[232:235], v[176:191]
  s_add_u32 m0, s39, 24576
  s_nop 0
  buffer_load_dwordx4 v14, s[24:27], s59 offen offset:0 lds
  v_mfma_f32_32x32x16_bf16 v[192:207], a[52:55], v[232:235], v[192:207]
  ds_read_b64_tr_b16 a[16:17], v18 offset:40960
  ds_read_b64_tr_b16 a[18:19], v18 offset:43520
  ds_read_b64_tr_b16 a[20:21], v18 offset:41024
  v_mfma_f32_32x32x16_bf16 v[208:223], a[56:59], v[232:235], v[208:223]
  s_add_u32 s59, s5, 3
  s_and_b32 s59, s59, 3
  s_mul_i32 s59, s59, 163840
  s_lshl_b32 s60, s39, 2
  s_add_u32 s59, s59, s60
  s_add_u32 m0, s39, 0
  s_add_u32 s59, s59, 81920
  buffer_load_dwordx4 v10, s[24:27], s59 offen offset:0 lds
  s_waitcnt lgkmcnt(7)
  v_mfma_f32_32x32x16_bf16 v[144:159], a[60:63], v[236:239], v[144:159]
  ds_read_b64_tr_b16 a[22:23], v18 offset:43584
  ds_read_b64_tr_b16 a[24:25], v18 offset:41088
  ds_read_b64_tr_b16 a[26:27], v18 offset:43648
  s_waitcnt vmcnt(14)
  v_xor_b32 v64, v64, v120
  v_xor_b32 v65, v65, v121
  v_mfma_f32_32x32x16_bf16 v[160:175], a[0:3], v[236:239], v[160:175]
  buffer_load_dwordx4 v11, s[24:27], s59 offen offset:1024 lds
  ds_read_b64_tr_b16 a[28:29], v18 offset:41152
  ds_read_b64_tr_b16 a[30:31], v18 offset:43712
  v_mfma_f32_32x32x16_bf16 v[176:191], a[4:7], v[236:239], v[176:191]
  ds_read_b64_tr_b16 a[32:33], v18 offset:41216
  ds_read_b64_tr_b16 a[34:35], v18 offset:43776
  ds_read_b64_tr_b16 a[36:37], v18 offset:46080
  v_or_b32 v124, v64, v65
  s_waitcnt lgkmcnt(9)
  v_mfma_f32_32x32x16_bf16 v[192:207], a[8:11], v[236:239], v[192:207]
  buffer_load_dwordx4 v12, s[24:27], s59 offen offset:2048 lds
  ds_read_b64_tr_b16 a[38:39], v18 offset:48640
  ds_read_b64_tr_b16 a[40:41], v18 offset:46144
  v_mfma_f32_32x32x16_bf16 v[208:223], a[12:15], v[236:239], v[208:223]
  ds_read_b64_tr_b16 a[42:43], v18 offset:48704
  ds_read_b64_tr_b16 a[44:45], v18 offset:46208
  ds_read_b64_tr_b16 a[46:47], v18 offset:48768
  v_xor_b32 v66, v66, v122
  v_xor_b32 v67, v67, v123
  v_or3_b32 v124, v124, v66, v67
  v_xor_b32 v68, v68, v120
  v_xor_b32 v69, v69, v121
  v_or3_b32 v124, v124, v68, v69
  v_xor_b32 v70, v70, v122
  v_xor_b32 v71, v71, v123
  v_or3_b32 v124, v124, v70, v71
  v_xor_b32 v72, v72, v120
  v_xor_b32 v73, v73, v121
  v_or3_b32 v124, v124, v72, v73
  v_xor_b32 v74, v74, v122
  v_xor_b32 v75, v75, v123
  v_or3_b32 v124, v124, v74, v75
  v_xor_b32 v76, v76, v120
  v_xor_b32 v77, v77, v121
  v_or3_b32 v124, v124, v76, v77
  v_xor_b32 v78, v78, v122
  v_xor_b32 v79, v79, v123
  v_or3_b32 v124, v124, v78, v79
  v_and_b32 v124, s51, v124
  v_cmp_ne_u32 vcc, 0, v124
  s_cbranch_vccnz L_retry11
L_ok11:
  v_mfma_f32_32x32x16_bf16 v[144:159], a[16:19], v[64:67], v[144:159]
  buffer_load_dwordx4 v13, s[24:27], s59 offen offset:3072 lds
  ds_read_b64_tr_b16 a[48:49], v18 offset:46272
  s_waitcnt lgkmcnt(9)
  v_mfma_f32_32x32x16_bf16 v[160:175], a[20:23], v[64:67], v[160:175]
  ds_read_b64_tr_b16 a[50:51], v18 offset:48832
  ds_read_b64_tr_b16 a[52:53], v18 offset:46336
  ds_read_b64_tr_b16 a[54:55], v18 offset:48896
  v_mfma_f32_32x32x16_bf16 v[176:191], a[24:27], v[64:67], v[176:191]
  s_add_u32 m0, s39, 4096
  s_nop 0
  buffer_load_dwordx4 v14, s[24:27], s59 offen offset:0 lds
  v_mfma_f32_32x32x16_bf16 v[192:207], a[28:31], v[64:67], v[192:207]
  ds_read_b64_tr_b16 a[56:57], v18 offset:51200
  ds_read_b64_tr_b16 a[58:59], v18 offset:53760
  ds_read_b64_tr_b16 a[60:61], v18 offset:51264
  s_waitcnt lgkmcnt(9)
  v_mfma_f32_32x32x16_bf16 v[208:223], a[32:35], v[64:67], v[208:223]
  ds_read_b64_tr_b16 a[62:63], v18 offset:53824
  ds_read_b64_tr_b16 a[0:1], v18 offset:51328
  ds_read_b64_tr_b16 a[2:3], v18 offset:53888
  v_mfma_f32_32x32x16_bf16 v[144:159], a[36:39], v[68:71], v[144:159]
  ds_read_b64_tr_b16 a[4:5], v18 offset:51392
  ds_read_b64_tr_b16 a[6:7], v18 offset:53952
  s_waitcnt vmcnt(14)
  v_xor_b32 v80, v80, v120
  v_xor_b32 v81, v81, v121
  v_or_b32 v124, v80, v81
  v_mfma_f32_32x32x16_bf16 v[160:175], a[40:43], v[68:71], v[160:175]
  ds_read_b64_tr_b16 a[8:9], v18 offset:51456
  ds_read_b64_tr_b16 a[10:11], v18 offset:54016
  v_xor_b32 v82, v82, v122
  v_xor_b32 v83, v83, v123
  s_waitcnt lgkmcnt(10)
  v_mfma_f32_32x32x16_bf16 v[176:191], a[44:47], v[68:71], v[176:191]
  ds_read_b64_tr_b16 a[12:13], v18 offset:56320
  ds_read_b64_tr_b16 a[14:15], v18 offset:58880
  v_or3_b32 v124, v124, v82, v83
  v_xor_b32 v84, v84, v120
  v_xor_b32 v85, v85, v121
  v_mfma_f32_32x32x16_bf16 v[192:207], a[48:51], v[68:71], v[192:207]
  ds_read_b64_tr_b16 a[16:17], v18 offset:56384
  ds_read_b64_tr_b16 a[18:19], v18 offset:58944
  v_or3_b32 v124, v124, v84, v85
  v_xor_b32 v86, v86, v122
  v_xor_b32 v87, v87, v123
  v_mfma_f32_32x32x16_bf16 v[208:223], a[52:55], v[68:71], v[208:223]
  ds_read_b64_tr_b16 a[20:21], v18 offset:56448
  ds_read_b64_tr_b16 a[22:23], v18 offset:59008
  v_or3_b32 v124, v124, v86, v87
  v_xor_b32 v88, v88, v120
  s_waitcnt lgkmcnt(10)
  v_mfma_f32_32x32x16_bf16 v[144:159], a[56:59], v[72:75], v[144:159]
  ds_read_b64_tr_b16 a[24:25], v18 offset:56512
  ds_read_b64_tr_b16 a[26:27], v18 offset:59072
  v_xor_b32 v89, v89, v121
  v_or3_b32 v124, v124, v88, v89
  v_xor_b32 v90, v90, v122
  v_mfma_f32_32x32x16_bf16 v[160:175], a[60:63], v[72:75], v[160:175]
  ds_read_b64_tr_b16 a[28:29], v18 offset:56576
  ds_read_b64_tr_b16 a[30:31], v18 offset:59136
  v_xor_b32 v91, v91, v123
  v_or3_b32 v124, v124, v90, v91
  v_xor_b32 v92, v92, v120
  v_mfma_f32_32x32x16_bf16 v[176:191], a[0:3], v[72:75], v[176:191]
  s_waitcnt vmcnt(0)
  s_barrier
  ds_read_b64_tr_b16 a[32:33], v18 offset:20480
  ds_read_b64_tr_b16 a[34:35], v18 offset:23040
  v_xor_b32 v93, v93, v121
  v_or3_b32 v124, v124, v92, v93
  s_waitcnt lgkmcnt(10)
  v_mfma_f32_32x32x16_bf16 v[192:207], a[4:7], v[72:75], v[192:207]
  ds_read_b64_tr_b16 a[36:37], v18 offset:25600
  ds_read_b64_tr_b16 a[38:39], v18 offset:28160
  v_xor_b32 v94, v94, v122
  v_xor_b32 v95, v95, v123
  v_or3_b32 v124, v124, v94, v95
  v_mfma_f32_32x32x16_bf16 v[208:223], a[8:11], v[72:75], v[208:223]
  ds_read_b64_tr_b16 a[40:41], v18 offset:30720
  ds_read_b64_tr_b16 a[42:43], v18 offset:33280
  v_and_b32 v124, s51, v124
  v_cmp_ne_u32 vcc, 0, v124
  s_cbranch_vccnz L_retry12
L_ok12:
  v_xor_b32 v240, v240, v120
  v_mfma_f32_32x32x16_bf16 v[144:159], a[12:15], v[76:79], v[144:159]
  ds_read_b64_tr_b16 a[44:45], v18 offset:35840
  ds_read_b64_tr_b16 a[46:47], v18 offset:38400
  v_xor_b32 v241, v241, v121
  v_or_b32 v124, v240, v241
  s_waitcnt lgkmcnt(10)
  v_mfma_f32_32x32x16_bf16 v[160:175], a[16:19], v[76:79], v[160:175]
  ds_read_b64_tr_b16 a[48:49], v18 offset:0
  ds_read_b64_tr_b16 a[50:51], v18 offset:2560
  v_xor_b32 v242, v242, v122
  v_xor_b32 v243, v243, v123
  v_or3_b32 v124, v124, v242, v243
  v_mfma_f32_32x32x16_bf16 v[176:191], a[20:23], v[76:79], v[176:191]
  ds_read_b64_tr_b16 a[52:53], v18 offset:5120
  ds_read_b64_tr_b16 a[54:55], v18 offset:7680
  v_xor_b32 v244, v244, v120
  v_xor_b32 v245, v245, v121
  v_or3_b32 v124, v124, v244, v245
  v_mfma_f32_32x32x16_bf16 v[192:207], a[24:27], v[76:79], v[192:207]
  ds_read_b64_tr_b16 a[56:57], v18 offset:10240
  ds_read_b64_tr_b16 a[58:59], v18 offset:12800
  v_xor_b32 v246, v246, v122
  v_xor_b32 v247, v247, v123
  s_waitcnt lgkmcnt(10)
  v_mfma_f32_32x32x16_bf16 v[208:223], a[28:31], v[76:79], v[208:223]
  ds_read_b64_tr_b16 a[60:61], v18 offset:15360
  ds_read_b64_tr_b16 a[62:63], v18 offset:17920
  v_or3_b32 v124, v124, v246, v247
  v_xor_b32 v248, v248, v120
  v_xor_b32 v249, v249, v121
  v_or3_b32 v124, v124, v248, v249
  v_xor_b32 v250, v250, v122
  v_xor_b32 v251, v251, v123
  v_or3_b32 v124, v124, v250, v251
  v_xor_b32 v252, v252, v120
  v_xor_b32 v253, v253, v121
  v_or3_b32 v124, v124, v252, v253
  v_xor_b32 v254, v254, v122
  v_xor_b32 v255, v255, v123
  v_or3_b32 v124, v124, v254, v255
  v_and_b32 v124, s51, v124
  v_cmp_ne_u32 vcc, 0, v124
  s_cbranch_vccnz L_retry13
L_ok13:
  v_mfma_f32_32x32x16_bf16 v[144:159], a[32:35], v[80:83], v[144:159]
  ds_read_b64_tr_b16 a[0:1], v18 offset:20544
  ds_read_b64_tr_b16 a[2:3], v18 offset:23104
  v_mfma_f32_32x32x16_bf16 v[144:159], a[36:39], v[84:87], v[144:159]
  ds_read_b64_tr_b16 a[4:5], v18 offset:25664
  ds_read_b64_tr_b16 a[6:7], v18 offset:28224
  v_accvgpr_read_b32 v116, a232
  v_accvgpr_read_b32 v117, a233
  s_waitcnt lgkmcnt(10)
  v_mfma_f32_32x32x16_bf16 v[144:159], a[40:43], v[88:91], v[144:159]
  ds_read_b64_tr_b16 a[8:9], v18 offset:30784
  ds_read_b64_tr_b16 a[10:11], v18 offset:33344
  v_accvgpr_read_b32 v118, a234
  v_accvgpr_read_b32 v119, a235
  v_accvgpr_read_b32 v24, a236
  v_mfma_f32_32x32x16_bf16 v[144:159], a[44:47], v[92:95], v[144:159]
  ds_read_b64_tr_b16 a[12:13], v18 offset:35904
  ds_read_b64_tr_b16 a[14:15], v18 offset:38464
  v_accvgpr_read_b32 v125, a237
  s_mov_b32 s66, 0
  v_mfma_f32_32x32x16_bf16 v[144:159], a[48:51], v[240:243], v[144:159]
  ds_read_b64_tr_b16 a[16:17], v18 offset:64
  ds_read_b64_tr_b16 a[18:19], v18 offset:2624
  s_waitcnt lgkmcnt(10)
  v_mfma_f32_32x32x16_bf16 v[144:159], a[52:55], v[244:247], v[144:159]
  ds_read_b64_tr_b16 a[20:21], v18 offset:5184
  ds_read_b64_tr_b16 a[22:23], v18 offset:7744
  v_mfma_f32_32x32x16_bf16 v[144:159], a[56:59], v[248:251], v[144:159]
  ds_read_b64_tr_b16 a[24:25], v18 offset:10304
  ds_read_b64_tr_b16 a[26:27], v18 offset:12864
  v_mfma_f32_32x32x16_bf16 v[144:159], a[60:63], v[252:255], v[144:159]
  ds_read_b64_tr_b16 a[28:29], v18 offset:15424
  ds_read_b64_tr_b16 a[30:31], v18 offset:17984
  s_waitcnt lgkmcnt(10)
  v_mfma_f32_32x32x16_bf16 v[160:175], a[0:3], v[80:83], v[160:175]
  ds_read_b64_tr_b16 a[32:33], v18 offset:20608
  ds_read_b64_tr_b16 a[34:35], v18 offset:23168
  v_mfma_f32_32x32x16_bf16 v[160:175], a[4:7], v[84:87], v[160:175]
  ds_read_b64_tr_b16 a[36:37], v18 offset:25728
  ds_read_b64_tr_b16 a[38:39], v18 offset:28288
  v_mfma_f32_32x32x16_bf16 v[160:175], a[8:11], v[88:91], v[160:175]
  ds_read_b64_tr_b16 a[40:41], v18 offset:30848
  ds_read_b64_tr_b16 a[42:43], v18 offset:33408
  s_waitcnt lgkmcnt(10)
  v_mfma_f32_32x32x16_bf16 v[160:175], a[12:15], v[92:95], v[160:175]
  ds_read_b64_tr_b16 a[44:45], v18 offset:35968
  ds_read_b64_tr_b16 a[46:47], v18 offset:38528
  v_perm_b32 v32, v145, v144, s63
  v_add_u32 v32, s51, v32
  v_and_or_b32 v32, v32, s50, v120
  v_mfma_f32_32x32x16_bf16 v[160:175], a[16:19], v[240:243], v[160:175]
  ds_read_b64_tr_b16 a[48:49], v18 offset:128
  ds_read_b64_tr_b16 a[50:51], v18 offset:2688
  v_perm_b32 v33, v147, v146, s63
  v_add_u32 v33, s51, v33
  v_and_or_b32 v33, v33, s50, v121
  v_mfma_f32_32x32x16_bf16 v[160:175], a[20:23], v[244:247], v[160:175]
  ds_read_b64_tr_b16 a[52:53], v18 offset:5248
  ds_read_b64_tr_b16 a[54:55], v18 offset:7808
  v_perm_b32 v34, v149, v148, s63
  v_add_u32 v34, s51, v34
  s_waitcnt lgkmcnt(10)
  v_mfma_f32_32x32x16_bf16 v[160:175], a[24:27], v[248:251], v[160:175]
  ds_read_b64_tr_b16 a[56:57], v18 offset:10368
  ds_read_b64_tr_b16 a[58:59], v18 offset:12928
  v_and_or_b32 v34, v34, s50, v122
  v_perm_b32 v35, v151, v150, s63
  v_add_u32 v35, s51, v35
  v_mfma_f32_32x32x16_bf16 v[160:175], a[28:31], v[252:255], v[160:175]
  ds_read_b64_tr_b16 a[60:61], v18 offset:15488
  ds_read_b64_tr_b16 a[62:63], v18 offset:18048
  v_and_or_b32 v35, v35, s50, v123
  buffer_store_dwordx4 v[32:35], v1, s[32:35], s40 offen offset:0 sc1
  v_perm_b32 v36, v153, v152, s63
  v_mfma_f32_32x32x16_bf16 v[176:191], a[32:35], v[80:83], v[176:191]
  ds_read_b64_tr_b16 a[0:1], v18 offset:20672
  ds_read_b64_tr_b16 a[2:3], v18 offset:23232
  v_add_u32 v36, s51, v36
  v_and_or_b32 v36, v36, s50, v120
  s_waitcnt lgkmcnt(10)
  v_mfma_f32_32x32x16_bf16 v[176:191], a[36:39], v[84:87], v[176:191]
  ds_read_b64_tr_b16 a[4:5], v18 offset:25792
  ds_read_b64_tr_b16 a[6:7], v18 offset:28352
  v_perm_b32 v37, v155, v154, s63
  v_add_u32 v37, s51, v37
  v_and_or_b32 v37, v37, s50, v121
  v_mfma_f32_32x32x16_bf16 v[176:191], a[40:43], v[88:91], v[176:191]
  ds_read_b64_tr_b16 a[8:9], v18 offset:30912
  ds_read_b64_tr_b16 a[10:11], v18 offset:33472
  v_perm_b32 v38, v157, v156, s63
  v_add_u32 v38, s51, v38
  v_and_or_b32 v38, v38, s50, v122
  v_mfma_f32_32x32x16_bf16 v[176:191], a[44:47], v[92:95], v[176:191]
  ds_read_b64_tr_b16 a[12:13], v18 offset:36032
  ds_read_b64_tr_b16 a[14:15], v18 offset:38592
  v_perm_b32 v39, v159, v158, s63
  v_add_u32 v39, s51, v39
  s_waitcnt lgkmcnt(10)
  v_mfma_f32_32x32x16_bf16 v[176:191], a[48:51], v[240:243], v[176:191]
  ds_read_b64_tr_b16 a[16:17], v18 offset:192
  ds_read_b64_tr_b16 a[18:19], v18 offset:2752
  v_and_or_b32 v39, v39, s50, v123
  buffer_store_dwordx4 v[36:39], v1, s[32:35], s41 offen offset:0 sc1
  v_perm_b32 v40, v161, v160, s63
  v_mfma_f32_32x32x16_bf16 v[176:191], a[52:55], v[244:247], v[176:191]
  ds_read_b64_tr_b16 a[20:21], v18 offset:5312
  ds_read_b64_tr_b16 a[22:23], v18 offset:7872
  v_add_u32 v40, s51, v40
  v_and_or_b32 v40, v40, s50, v120
  v_perm_b32 v41, v163, v162, s63
  v_mfma_f32_32x32x16_bf16 v[176:191], a[56:59], v[248:251], v[176:191]
  ds_read_b64_tr_b16 a[24:25], v18 offset:10432
  ds_read_b64_tr_b16 a[26:27], v18 offset:12992
  v_add_u32 v41, s51, v41
  v_and_or_b32 v41, v41, s50, v121
  s_waitcnt lgkmcnt(10)
  v_mfma_f32_32x32x16_bf16 v[176:191], a[60:63], v[252:255], v[176:191]
  ds_read_b64_tr_b16 a[28:29], v18 offset:15552
  ds_read_b64_tr_b16 a[30:31], v18 offset:18112
  v_perm_b32 v42, v165, v164, s63
  v_add_u32 v42, s51, v42
  v_and_or_b32 v42, v42, s50, v122
  v_mfma_f32_32x32x16_bf16 v[192:207], a[0:3], v[80:83], v[192:207]
  ds_read_b64_tr_b16 a[32:33], v18 offset:20736
  ds_read_b64_tr_b16 a[34:35], v18 offset:23296
  v_perm_b32 v43, v167, v166, s63
  v_add_u32 v43, s51, v43
  v_and_or_b32 v43, v43, s50, v123
  v_mfma_f32_32x32x16_bf16 v[192:207], a[4:7], v[84:87], v[192:207]
  ds_read_b64_tr_b16 a[36:37], v18 offset:25856
  ds_read_b64_tr_b16 a[38:39], v18 offset:28416
  buffer_store_dwordx4 v[40:43], v1, s[32:35], s40 offen offset:1024 sc1
  v_perm_b32 v44, v169, v168, s63
  s_waitcnt lgkmcnt(10)
  v_mfma_f32_32x32x16_bf16 v[192:207], a[8:11], v[88:91], v[192:207]
  ds_read_b64_tr_b16 a[40:41], v18 offset:30976
  ds_read_b64_tr_b16 a[42:43], v18 offset:33536
  v_add_u32 v44, s51, v44
  v_and_or_b32 v44, v44, s50, v120
  v_perm_b32 v45, v171, v170, s63
  v_mfma_f32_32x32x16_bf16 v[192:207], a[12:15], v[92:95], v[192:207]
  ds_read_b64_tr_b16 a[44:45], v18 offset:36096
  ds_read_b64_tr_b16 a[46:47], v18 offset:38656
  v_add_u32 v45, s51, v45
  v_and_or_b32 v45, v45, s50, v121
  v_perm_b32 v46, v173, v172, s63
  v_mfma_f32_32x32x16_bf16 v[192:207], a[16:19], v[240:243], v[192:207]
  ds_read_b64_tr_b16 a[48:49], v18 offset:256
  ds_read_b64_tr_b16 a[50:51], v18 offset:2816
  v_add_u32 v46, s51, v46
  v_and_or_b32 v46, v46, s50, v122
  s_waitcnt lgkmcnt(10)
  v_mfma_f32_32x32x16_bf16 v[192:207], a[20:23], v[244:247], v[192:207]
  ds_read_b64_tr_b16 a[52:53], v18 offset:5376
  ds_read_b64_tr_b16 a[54:55], v18 offset:7936
  v_perm_b32 v47, v175, v174, s63
  v_add_u32 v47, s51, v47
  v_and_or_b32 v47, v47, s50, v123
  v_mfma_f32_32x32x16_bf16 v[192:207], a[24:27], v[248:251], v[192:207]
  ds_read_b64_tr_b16 a[56:57], v18 offset:10496
  ds_read_b64_tr_b16 a[58:59], v18 offset:13056
  buffer_store_dwordx4 v[44:47], v1, s[32:35], s41 offen offset:1024 sc1
  v_perm_b32 v48, v177, v176, s63
  v_add_u32 v48, s51, v48
  v_mfma_f32_32x32x16_bf16 v[192:207], a[28:31], v[252:255], v[192:207]
  ds_read_b64_tr_b16 a[60:61], v18 offset:15616
  ds_read_b64_tr_b16 a[62:63], v18 offset:18176
  v_and_or_b32 v48, v48, s50, v120
  v_perm_b32 v49, v179, v178, s63
  s_waitcnt lgkmcnt(10)
  v_mfma_f32_32x32x16_bf16 v[208:223], a[32:35], v[80:83], v[208:223]
  v_add_u32 v49, s51, v49
  v_and_or_b32 v49, v49, s50, v121
  v_perm_b32 v50, v181, v180, s63
  v_add_u32 v50, s51, v50
  v_and_or_b32 v50, v50, s50, v122
  v_mfma_f32_32x32x16_bf16 v[208:223], a[36:39], v[84:87], v[208:223]
  v_perm_b32 v51, v183, v182, s63
  v_add_u32 v51, s51, v51
  v_and_or_b32 v51, v51, s50, v123
  buffer_store_dwordx4 v[48:51], v1, s[32:35], s40 offen offset:2048 sc1
  v_perm_b32 v52, v185, v184, s63
  v_mfma_f32_32x32x16_bf16 v[208:223], a[40:43], v[88:91], v[208:223]
  v_add_u32 v52, s51, v52
  v_and_or_b32 v52, v52, s50, v120
  v_perm_b32 v53, v187, v186, s63
  v_add_u32 v53, s51, v53
  s_waitcnt lgkmcnt(4)
  v_mfma_f32_32x32x16_bf16 v[208:223], a[44:47], v[92:95], v[208:223]
  v_and_or_b32 v53, v53, s50, v121
  v_perm_b32 v54, v189, v188, s63
  v_add_u32 v54, s51, v54
  v_and_or_b32 v54, v54, s50, v122
  v_perm_b32 v55, v191, v190, s63
  v_mfma_f32_32x32x16_bf16 v[208:223], a[48:51], v[240:243], v[208:223]
  v_add_u32 v55, s51, v55
  v_and_or_b32 v55, v55, s50, v123
  buffer_store_dwordx4 v[52:55], v1, s[32:35], s41 offen offset:2048 sc1
  v_perm_b32 v56, v193, v192, s63
  v_add_u32 v56, s51, v56
  v_mfma_f32_32x32x16_bf16 v[208:223], a[52:55], v[244:247], v[208:223]
  v_and_or_b32 v56, v56, s50, v120
  v_perm_b32 v57, v195, v194, s63
  v_add_u32 v57, s51, v57
  v_and_or_b32 v57, v57, s50, v121
  s_waitcnt lgkmcnt(0)
  v_mfma_f32_32x32x16_bf16 v[208:223], a[56:59], v[248:251], v[208:223]
  v_perm_b32 v58, v197, v196, s63
  v_add_u32 v58, s51, v58
  v_and_or_b32 v58, v58, s50, v122
  v_perm_b32 v59, v199, v198, s63
  v_add_u32 v59, s51, v59
  v_mfma_f32_32x32x16_bf16 v[208:223], a[60:63], v[252:255], v[208:223]
  v_and_or_b32 v59, v59, s50, v123
  buffer_store_dwordx4 v[56:59], v1, s[32:35], s40 offen offset:3072 sc1
  v_perm_b32 v60, v201, v200, s63
  v_add_u32 v60, s51, v60
  v_and_or_b32 v60, v60, s50, v120
  v_perm_b32 v61, v203, v202, s63
  v_add_u32 v61, s51, v61
  v_and_or_b32 v61, v61, s50, v121
  v_perm_b32 v62, v205, v204, s63
  v_add_u32 v62, s51, v62
  v_and_or_b32 v62, v62, s50, v122
  v_perm_b32 v63, v207, v206, s63
  v_add_u32 v63, s51, v63
  v_and_or_b32 v63, v63, s50, v123
  buffer_store_dwordx4 v[60:63], v1, s[32:35], s41 offen offset:3072 sc1
  s_nop 11
  v_perm_b32 v224, v209, v208, s63
  v_add_u32 v224, s51, v224
  v_and_or_b32 v224, v224, s50, v120
  v_perm_b32 v225, v211, v210, s63
  v_add_u32 v225, s51, v225
  v_and_or_b32 v225, v225, s50, v121
  v_perm_b32 v226, v213, v212, s63
  v_add_u32 v226, s51, v226
  v_and_or_b32 v226, v226, s50, v122
  v_perm_b32 v227, v215, v214, s63
  v_add_u32 v227, s51, v227
  v_and_or_b32 v227, v227, s50, v123
  buffer_store_dwordx4 v[224:227], v1, s[32:35], s42 offen offset:0 sc1
  v_perm_b32 v228, v217, v216, s63
  v_add_u32 v228, s51, v228
  v_and_or_b32 v228, v228, s50, v120
  v_perm_b32 v229, v219, v218, s63
  v_add_u32 v229, s51, v229
  v_and_or_b32 v229, v229, s50, v121
  v_perm_b32 v230, v221, v220, s63
  v_add_u32 v230, s51, v230
  v_and_or_b32 v230, v230, s50, v122
  v_perm_b32 v231, v223, v222, s63
  v_add_u32 v231, s51, v231
  v_and_or_b32 v231, v231, s50, v123
  buffer_store_dwordx4 v[228:231], v1, s[32:35], s43 offen offset:0 sc1
  s_cmp_eq_u32 s3, 0
  s_cbranch_scc1 L_fin2
L_fin1:
  s_mov_b64 exec, 0xffffffff
L_pp0:
  buffer_load_dwordx4 v[104:107], v125, s[32:35], s54 offen sc1
  s_add_u32 s66, s66, 1
  s_waitcnt vmcnt(0)
  v_xor_b32 v104, v104, v120
  v_xor_b32 v105, v105, v121
  v_or_b32 v124, v104, v105
  v_xor_b32 v106, v106, v122
  v_xor_b32 v107, v107, v123
  v_or3_b32 v124, v124, v106, v107
  v_and_b32 v124, s51, v124
  v_cmp_ne_u32 vcc, 0, v124
  s_cbranch_vccz L_pq0
  s_cmp_lt_u32 s66, 20000
  s_cbranch_scc1 L_pp0
L_pq0:
  s_mov_b64 exec, -1
  buffer_load_dwordx4 v[128:131], v1, s[32:35], s54 offen sc1
  s_add_u32 s59, s54, 5120
  buffer_load_dwordx4 v[132:135], v1, s[32:35], s59 offen sc1
  s_add_u32 s59, s54, 10240
  buffer_load_dwordx4 v[136:139], v1, s[32:35], s59 offen sc1
  s_add_u32 s59, s54, 15360
  buffer_load_dwordx4 v[140:143], v1, s[32:35], s59 offen sc1
  s_add_u32 s59, s54, 20480
  buffer_load_dwordx4 v[144:147], v1, s[32:35], s59 offen sc1
  s_add_u32 s59, s54, 25600
  buffer_load_dwordx4 v[148:151], v1, s[32:35], s59 offen sc1
  s_add_u32 s59, s54, 30720
  buffer_load_dwordx4 v[152:155], v1, s[32:35], s59 offen sc1
  s_add_u32 s59, s54, 35840
  buffer_load_dwordx4 v[156:159], v1, s[32:35], s59 offen sc1
L_w0_0:
  s_waitcnt vmcnt(7)
  v_xor_b32 v128, v128, v120
  v_xor_b32 v129, v129, v121
  v_or_b32 v124, v128, v129
  v_xor_b32 v130, v130, v122
  v_xor_b32 v131, v131, v123
  v_or3_b32 v124, v124, v130, v131
  v_and_b32 v124, s51, v124
  v_cmp_ne_u32 vcc, 0, v124
  s_cbranch_vccnz L_re0_0
L_go0_0:
  v_mfma_f32_32x32x16_bf16 v[64:79], v[116:119], v[128:131], 0
L_w0_1:
  s_waitcnt vmcnt(6)
  v_xor_b32 v132, v132, v120
  v_xor_b32 v133, v133, v121
  v_or_b32 v124, v132, v133
  v_xor_b32 v134, v134, v122
  v_xor_b32 v135, v135, v123
  v_or3_b32 v124, v124, v134, v135
  v_and_b32 v124, s51, v124
  v_cmp_ne_u32 vcc, 0, v124
  s_cbranch_vccnz L_re0_1
L_go0_1:
  v_mfma_f32_32x32x16_bf16 v[64:79], v[116:119], v[132:135], v[64:79]
L_w0_2:
  s_waitcnt vmcnt(5)
  v_xor_b32 v136, v136, v120
  v_xor_b32 v137, v137, v121
  v_or_b32 v124, v136, v137
  v_xor_b32 v138, v138, v122
  v_xor_b32 v139, v139, v123
  v_or3_b32 v124, v124, v138, v139
  v_and_b32 v124, s51, v124
  v_cmp_ne_u32 vcc, 0, v124
  s_cbranch_vccnz L_re0_2
L_go0_2:
  v_mfma_f32_32x32x16_bf16 v[64:79], v[116:119], v[136:139], v[64:79]
L_w0_3:
  s_waitcnt vmcnt(4)
  v_xor_b32 v140, v140, v120
  v_xor_b32 v141, v141, v121
  v_or_b32 v124, v140, v141
  v_xor_b32 v142, v142, v122
  v_xor_b32 v143, v143, v123
  v_or3_b32 v124, v124, v142, v143
  v_and_b32 v124, s51, v124
  v_cmp_ne_u32 vcc, 0, v124
  s_cbranch_vccnz L_re0_3
L_go0_3:
  v_mfma_f32_32x32x16_bf16 v[64:79], v[116:119], v[140:143], v[64:79]
L_w0_4:
  s_waitcnt vmcnt(3)
  v_xor_b32 v144, v144, v120
  v_xor_b32 v145, v145, v121
  v_or_b32 v124, v144, v145
  v_xor_b32 v146, v146, v122
  v_xor_b32 v147, v147, v123
  v_or3_b32 v124, v124, v146, v147
  v_and_b32 v124, s51, v124
  v_cmp_ne_u32 vcc, 0, v124
  s_cbranch_vccnz L_re0_4
L_go0_4:
  v_mfma_f32_32x32x16_bf16 v[64:79], v[116:119], v[144:147], v[64:79]
L_w0_5:
  s_waitcnt vmcnt(2)
  v_xor_b32 v148, v148, v120
  v_xor_b32 v149, v149, v121
  v_or_b32 v124, v148, v149
  v_xor_b32 v150, v150, v122
  v_xor_b32 v151, v151, v123
  v_or3_b32 v124, v124, v150, v151
  v_and_b32 v124, s51, v124
  v_cmp_ne_u32 vcc, 0, v124
  s_cbranch_vccnz L_re0_5
L_go0_5:
  v_mfma_f32_32x32x16_bf16 v[64:79], v[116:119], v[148:151], v[64:79]
L_w0_6:
  s_waitcnt vmcnt(1)
  v_xor_b32 v152, v152, v120
  v_xor_b32 v153, v153, v121
  v_or_b32 v124, v152, v153
  v_xor_b32 v154, v154, v122
  v_xor_b32 v155, v155, v123
  v_or3_b32 v124, v124, v154, v155
  v_and_b32 v124, s51, v124
  v_cmp_ne_u32 vcc, 0, v124
  s_cbranch_vccnz L_re0_6
L_go0_6:
  v_mfma_f32_32x32x16_bf16 v[64:79], v[116:119], v[152:155], v[64:79]
L_w0_7:
  s_waitcnt vmcnt(0)
  v_xor_b32 v156, v156, v120
  v_xor_b32 v157, v157, v121
  v_or_b32 v124, v156, v157
  v_xor_b32 v158, v158, v122
  v_xor_b32 v159, v159, v123
  v_or3_b32 v124, v124, v158, v159
  v_and_b32 v124, s51, v124
  v_cmp_ne_u32 vcc, 0, v124
  s_cbranch_vccnz L_re0_7
L_go0_7:
  v_mfma_f32_32x32x16_bf16 v[64:79], v[116:119], v[156:159], v[64:79]
  s_nop 11
  v_cvt_pk_bf16_f32 v96, v64, v65
  v_cvt_pk_bf16_f32 v97, v66, v67
  v_cvt_pk_bf16_f32 v98, v68, v69
  v_cvt_pk_bf16_f32 v99, v70, v71
  buffer_store_dwordx4 v[96:99], v24, s[28:31], s55 offen sc1
  s_branch L_find
L_fin2:
  s_mov_b64 exec, 0xffffffff
L_pp1:
  buffer_load_dwordx4 v[104:107], v125, s[32:35], s52 offen sc1
  s_add_u32 s66, s66, 1
  s_waitcnt vmcnt(0)
  v_xor_b32 v104, v104, v120
  v_xor_b32 v105, v105, v121
  v_or_b32 v124, v104, v105
  v_xor_b32 v106, v106, v122
  v_xor_b32 v107, v107, v123
  v_or3_b32 v124, v124, v106, v107
  v_and_b32 v124, s51, v124
  v_cmp_ne_u32 vcc, 0, v124
  s_cbranch_vccz L_pq1
  s_cmp_lt_u32 s66, 20000
  s_cbranch_scc1 L_pp1
L_pq1:
  s_mov_b64 exec, -1
  buffer_load_dwordx4 v[128:131], v1, s[32:35], s54 offen sc1
  buffer_load_dwordx4 v[160:163], v1, s[32:35], s52 offen sc1
  s_add_u32 s59, s54, 5120
  buffer_load_dwordx4 v[132:135], v1, s[32:35], s59 offen sc1
  s_add_u32 s59, s52, 5120
  buffer_load_dwordx4 v[164:167], v1, s[32:35], s59 offen sc1
  s_add_u32 s59, s54, 10240
  buffer_load_dwordx4 v[136:139], v1, s[32:35], s59 offen sc1
  s_add_u32 s59, s52, 10240
  buffer_load_dwordx4 v[168:171], v1, s[32:35], s59 offen sc1
  s_add_u32 s59, s54, 15360
  buffer_load_dwordx4 v[140:143], v1, s[32:35], s59 offen sc1
  s_add_u32 s59, s52, 15360
  buffer_load_dwordx4 v[172:175], v1, s[32:35], s59 offen sc1
  s_add_u32 s59, s54, 20480
  buffer_load_dwordx4 v[144:147], v1, s[32:35], s59 offen sc1
  s_add_u32 s59, s52, 20480
  buffer_load_dwordx4 v[176:179], v1, s[32:35], s59 offen sc1
  s_add_u32 s59, s54, 25600
  buffer_load_dwordx4 v[148:151], v1, s[32:35], s59 offen sc1
  s_add_u32 s59, s52, 25600
  buffer_load_dwordx4 v[180:183], v1, s[32:35], s59 offen sc1
  s_add_u32 s59, s54, 30720
  buffer_load_dwordx4 v[152:155], v1, s[32:35], s59 offen sc1
  s_add_u32 s59, s52, 30720
  buffer_load_dwordx4 v[184:187], v1, s[32:35], s59 offen sc1
  s_add_u32 s59, s54, 35840
  buffer_load_dwordx4 v[156:159], v1, s[32:35], s59 offen sc1
  s_add_u32 s59, s52, 35840
  buffer_load_dwordx4 v[188:191], v1, s[32:35], s59 offen sc1
L_w1_0:
  s_waitcnt vmcnt(14)
  v_xor_b32 v128, v128, v120
  v_xor_b32 v129, v129, v121
  v_or_b32 v124, v128, v129
  v_xor_b32 v130, v130, v122
  v_xor_b32 v131, v131, v123
  v_or3_b32 v124, v124, v130, v131
  v_xor_b32 v160, v160, v120
  v_xor_b32 v161, v161, v121
  v_or3_b32 v124, v124, v160, v161
  v_xor_b32 v162, v162, v122
  v_xor_b32 v163, v163, v123
  v_or3_b32 v124, v124, v162, v163
  v_and_b32 v124, s51, v124
  v_cmp_ne_u32 vcc, 0, v124
  s_cbranch_vccnz L_re1_0
L_go1_0:
  v_mfma_f32_32x32x16_bf16 v[64:79], v[116:119], v[128:131], 0
  v_mfma_f32_32x32x16_bf16 v[80:95], v[116:119], v[160:163], 0
L_w1_1:
  s_waitcnt vmcnt(12)
  v_xor_b32 v132, v132, v120
  v_xor_b32 v133, v133, v121
  v_or_b32 v124, v132, v133
  v_xor_b32 v134, v134, v122
  v_xor_b32 v135, v135, v123
  v_or3_b32 v124, v124, v134, v135
  v_xor_b32 v164, v164, v120
  v_xor_b32 v165, v165, v121
  v_or3_b32 v124, v124, v164, v165
  v_xor_b32 v166, v166, v122
  v_xor_b32 v167, v167, v123
  v_or3_b32 v124, v124, v166, v167
  v_and_b32 v124, s51, v124
  v_cmp_ne_u32 vcc, 0, v124
  s_cbranch_vccnz L_re1_1
L_go1_1:
  v_mfma_f32_32x32x16_bf16 v[64:79], v[116:119], v[132:135], v[64:79]
  v_mfma_f32_32x32x16_bf16 v[80:95], v[116:119], v[164:167], v[80:95]
L_w1_2:
  s_waitcnt vmcnt(10)
  v_xor_b32 v136, v136, v120
  v_xor_b32 v137, v137, v121
  v_or_b32 v124, v136, v137
  v_xor_b32 v138, v138, v122
  v_xor_b32 v139, v139, v123
  v_or3_b32 v124, v124, v138, v139
  v_xor_b32 v168, v168, v120
  v_xor_b32 v169, v169, v121
  v_or3_b32 v124, v124, v168, v169
  v_xor_b32 v170, v170, v122
  v_xor_b32 v171, v171, v123
  v_or3_b32 v124, v124, v170, v171
  v_and_b32 v124, s51, v124
  v_cmp_ne_u32 vcc, 0, v124
  s_cbranch_vccnz L_re1_2
L_go1_2:
  v_mfma_f32_32x32x16_bf16 v[64:79], v[116:119], v[136:139], v[64:79]
  v_mfma_f32_32x32x16_bf16 v[80:95], v[116:119], v[168:171], v[80:95]
L_w1_3:
  s_waitcnt vmcnt(8)
  v_xor_b32 v140, v140, v120
  v_xor_b32 v141, v141, v121
  v_or_b32 v124, v140, v141
  v_xor_b32 v142, v142, v122
  v_xor_b32 v143, v143, v123
  v_or3_b32 v124, v124, v142, v143
  v_xor_b32 v172, v172, v120
  v_xor_b32 v173, v173, v121
  v_or3_b32 v124, v124, v172, v173
  v_xor_b32 v174, v174, v122
  v_xor_b32 v175, v175, v123
  v_or3_b32 v124, v124, v174, v175
  v_and_b32 v124, s51, v124
  v_cmp_ne_u32 vcc, 0, v124
  s_cbranch_vccnz L_re1_3
L_go1_3:
  v_mfma_f32_32x32x16_bf16 v[64:79], v[116:119], v[140:143], v[64:79]
  v_mfma_f32_32x32x16_bf16 v[80:95], v[116:119], v[172:175], v[80:95]
L_w1_4:
  s_waitcnt vmcnt(6)
  v_xor_b32 v144, v144, v120
  v_xor_b32 v145, v145, v121
  v_or_b32 v124, v144, v145
  v_xor_b32 v146, v146, v122
  v_xor_b32 v147, v147, v123
  v_or3_b32 v124, v124, v146, v147
  v_xor_b32 v176, v176, v120
  v_xor_b32 v177, v177, v121
  v_or3_b32 v124, v124, v176, v177
  v_xor_b32 v178, v178, v122
  v_xor_b32 v179, v179, v123
  v_or3_b32 v124, v124, v178, v179
  v_and_b32 v124, s51, v124
  v_cmp_ne_u32 vcc, 0, v124
  s_cbranch_vccnz L_re1_4
L_go1_4:
  v_mfma_f32_32x32x16_bf16 v[64:79], v[116:119], v[144:147], v[64:79]
  v_mfma_f32_32x32x16_bf16 v[80:95], v[116:119], v[176:179], v[80:95]
L_w1_5:
  s_waitcnt vmcnt(4)
  v_xor_b32 v148, v148, v120
  v_xor_b32 v149, v149, v121
  v_or_b32 v124, v148, v149
  v_xor_b32 v150, v150, v122
  v_xor_b32 v151, v151, v123
  v_or3_b32 v124, v124, v150, v151
  v_xor_b32 v180, v180, v120
  v_xor_b32 v181, v181, v121
  v_or3_b32 v124, v124, v180, v181
  v_xor_b32 v182, v182, v122
  v_xor_b32 v183, v183, v123
  v_or3_b32 v124, v124, v182, v183
  v_and_b32 v124, s51, v124
  v_cmp_ne_u32 vcc, 0, v124
  s_cbranch_vccnz L_re1_5
L_go1_5:
  v_mfma_f32_32x32x16_bf16 v[64:79], v[116:119], v[148:151], v[64:79]
  v_mfma_f32_32x32x16_bf16 v[80:95], v[116:119], v[180:183], v[80:95]
L_w1_6:
  s_waitcnt vmcnt(2)
  v_xor_b32 v152, v152, v120
  v_xor_b32 v153, v153, v121
  v_or_b32 v124, v152, v153
  v_xor_b32 v154, v154, v122
  v_xor_b32 v155, v155, v123
  v_or3_b32 v124, v124, v154, v155
  v_xor_b32 v184, v184, v120
  v_xor_b32 v185, v185, v121
  v_or3_b32 v124, v124, v184, v185
  v_xor_b32 v186, v186, v122
  v_xor_b32 v187, v187, v123
  v_or3_b32 v124, v124, v186, v187
  v_and_b32 v124, s51, v124
  v_cmp_ne_u32 vcc, 0, v124
  s_cbranch_vccnz L_re1_6
L_go1_6:
  v_mfma_f32_32x32x16_bf16 v[64:79], v[116:119], v[152:155], v[64:79]
  v_mfma_f32_32x32x16_bf16 v[80:95], v[116:119], v[184:187], v[80:95]
L_w1_7:
  s_waitcnt vmcnt(0)
  v_xor_b32 v156, v156, v120
  v_xor_b32 v157, v157, v121
  v_or_b32 v124, v156, v157
  v_xor_b32 v158, v158, v122
  v_xor_b32 v159, v159, v123
  v_or3_b32 v124, v124, v158, v159
  v_xor_b32 v188, v188, v120
  v_xor_b32 v189, v189, v121
  v_or3_b32 v124, v124, v188, v189
  v_xor_b32 v190, v190, v122
  v_xor_b32 v191, v191, v123
  v_or3_b32 v124, v124, v190, v191
  v_and_b32 v124, s51, v124
  v_cmp_ne_u32 vcc, 0, v124
  s_cbranch_vccnz L_re1_7
L_go1_7:
  v_mfma_f32_32x32x16_bf16 v[64:79], v[116:119], v[156:159], v[64:79]
  v_mfma_f32_32x32x16_bf16 v[80:95], v[116:119], v[188:191], v[80:95]
  s_nop 11
  v_cvt_pk_bf16_f32 v96, v64, v65
  v_cvt_pk_bf16_f32 v97, v66, v67
  v_cvt_pk_bf16_f32 v98, v68, v69
  v_cvt_pk_bf16_f32 v99, v70, v71
  buffer_store_dwordx4 v[96:99], v24, s[28:31], s55 offen sc1
  v_cvt_pk_bf16_f32 v100, v80, v81
  v_cvt_pk_bf16_f32 v101, v82, v83
  v_cvt_pk_bf16_f32 v102, v84, v85
  v_cvt_pk_bf16_f32 v103, v86, v87
  buffer_store_dwordx4 v[100:103], v24, s[28:31], 0 offen offset:256 sc1
  s_cmp_eq_u32 s7, 0
  s_cbranch_scc0 L_find
  s_lshl_b32 s59, s6, 7
  v_mov_b32 v26, s37
  v_mov_b32 v27, 0
  s_mov_b64 exec, 1
  buffer_store_dword v26, v27, s[32:35], s59 offen sc1
  s_mov_b64 exec, -1
L_find:
L_end:
  s_endpgm
L_retry01:
  s_mov_b32 s66, 0
L_rl01:
  s_mov_b64 exec, 15
L_rs01:
  buffer_load_dwordx4 v[28:31], v125, s[32:35], 0 offen sc1
  s_add_u32 s66, s66, 1
  s_waitcnt vmcnt(0)
  v_xor_b32 v28, v28, v120
  v_xor_b32 v29, v29, v121
  v_or_b32 v124, v28, v29
  v_xor_b32 v30, v30, v122
  v_xor_b32 v31, v31, v123
  v_or3_b32 v124, v124, v30, v31
  v_and_b32 v124, s51, v124
  v_cmp_ne_u32 vcc, 0, v124
  s_cbranch_vccz L_rg01
  s_sleep 4
  s_cmp_lt_u32 s66, 20000
  s_cbranch_scc1 L_rs01
L_rg01:
  s_mov_b64 exec, -1
  buffer_load_dwordx4 v[32:35], v1, s[32:35], s44 offen offset:0 sc1
  buffer_load_dwordx4 v[36:39], v1, s[32:35], s44 offen offset:1024 sc1
  buffer_load_dwordx4 v[40:43], v1, s[32:35], s44 offen offset:2048 sc1
  buffer_load_dwordx4 v[44:47], v1, s[32:35], s44 offen offset:3072 sc1
  s_waitcnt vmcnt(0)
  v_xor_b32 v32, v32, v120
  v_xor_b32 v33, v33, v121
  v_or_b32 v124, v32, v33
  v_xor_b32 v34, v34, v122
  v_xor_b32 v35, v35, v123
  v_or3_b32 v124, v124, v34, v35
  v_xor_b32 v36, v36, v120
  v_xor_b32 v37, v37, v121
  v_or3_b32 v124, v124, v36, v37
  v_xor_b32 v38, v38, v122
  v_xor_b32 v39, v39, v123
  v_or3_b32 v124, v124, v38, v39
  v_xor_b32 v40, v40, v120
  v_xor_b32 v41, v41, v121
  v_or3_b32 v124, v124, v40, v41
  v_xor_b32 v42, v42, v122
  v_xor_b32 v43, v43, v123
  v_or3_b32 v124, v124, v42, v43
  v_xor_b32 v44, v44, v120
  v_xor_b32 v45, v45, v121
  v_or3_b32 v124, v124, v44, v45
  v_xor_b32 v46, v46, v122
  v_xor_b32 v47, v47, v123
  v_or3_b32 v124, v124, v46, v47
  v_and_b32 v124, s51, v124
  v_cmp_ne_u32 vcc, 0, v124
  s_cmp_ge_u32 s66, 20000
  s_cbranch_scc1 L_ok01
  s_cbranch_vccnz L_rl01
  s_branch L_ok01
L_retry02:
  s_mov_b32 s66, 0
L_rl02:
  s_mov_b64 exec, 240
L_rs02:
  buffer_load_dwordx4 v[28:31], v125, s[32:35], 0 offen sc1
  s_add_u32 s66, s66, 1
  s_waitcnt vmcnt(0)
  v_xor_b32 v28, v28, v120
  v_xor_b32 v29, v29, v121
  v_or_b32 v124, v28, v29
  v_xor_b32 v30, v30, v122
  v_xor_b32 v31, v31, v123
  v_or3_b32 v124, v124, v30, v31
  v_and_b32 v124, s51, v124
  v_cmp_ne_u32 vcc, 0, v124
  s_cbranch_vccz L_rg02
  s_sleep 4
  s_cmp_lt_u32 s66, 20000
  s_cbranch_scc1 L_rs02
L_rg02:
  s_mov_b64 exec, -1
  buffer_load_dwordx4 v[48:51], v1, s[32:35], s45 offen offset:0 sc1
  buffer_load_dwordx4 v[52:55], v1, s[32:35], s45 offen offset:1024 sc1
  buffer_load_dwordx4 v[56:59], v1, s[32:35], s45 offen offset:2048 sc1
  buffer_load_dwordx4 v[60:63], v1, s[32:35], s45 offen offset:3072 sc1
  s_waitcnt vmcnt(0)
  v_xor_b32 v48, v48, v120
  v_xor_b32 v49, v49, v121
  v_or_b32 v124, v48, v49
  v_xor_b32 v50, v50, v122
  v_xor_b32 v51, v51, v123
  v_or3_b32 v124, v124, v50, v51
  v_xor_b32 v52, v52, v120
  v_xor_b32 v53, v53, v121
  v_or3_b32 v124, v124, v52, v53
  v_xor_b32 v54, v54, v122
  v_xor_b32 v55, v55, v123
  v_or3_b32 v124, v124, v54, v55
  v_xor_b32 v56, v56, v120
  v_xor_b32 v57, v57, v121
  v_or3_b32 v124, v124, v56, v57
  v_xor_b32 v58, v58, v122
  v_xor_b32 v59, v59, v123
  v_or3_b32 v124, v124, v58, v59
  v_xor_b32 v60, v60, v120
  v_xor_b32 v61, v61, v121
  v_or3_b32 v124, v124, v60, v61
  v_xor_b32 v62, v62, v122
  v_xor_b32 v63, v63, v123
  v_or3_b32 v124, v124, v62, v63
  v_and_b32 v124, s51, v124
  v_cmp_ne_u32 vcc, 0, v124
  s_cmp_ge_u32 s66, 20000
  s_cbranch_scc1 L_ok02
  s_cbranch_vccnz L_rl02
  s_branch L_ok02
L_retry03:
  s_mov_b32 s66, 0
L_rl03:
  s_mov_b64 exec, 3840
L_rs03:
  buffer_load_dwordx4 v[28:31], v125, s[32:35], 0 offen sc1
  s_add_u32 s66, s66, 1
  s_waitcnt vmcnt(0)
  v_xor_b32 v28, v28, v120
  v_xor_b32 v29, v29, v121
  v_or_b32 v124, v28, v29
  v_xor_b32 v30, v30, v122
  v_xor_b32 v31, v31, v123
  v_or3_b32 v124, v124, v30, v31
  v_and_b32 v124, s51, v124
  v_cmp_ne_u32 vcc, 0, v124
  s_cbranch_vccz L_rg03
  s_sleep 4
  s_cmp_lt_u32 s66, 20000
  s_cbranch_scc1 L_rs03
L_rg03:
  s_mov_b64 exec, -1
  buffer_load_dwordx4 v[224:227], v1, s[32:35], s46 offen offset:0 sc1
  buffer_load_dwordx4 v[228:231], v1, s[32:35], s46 offen offset:1024 sc1
  buffer_load_dwordx4 v[232:235], v1, s[32:35], s46 offen offset:2048 sc1
  buffer_load_dwordx4 v[236:239], v1, s[32:35], s46 offen offset:3072 sc1
  s_waitcnt vmcnt(0)
  v_xor_b32 v224, v224, v120
  v_xor_b32 v225, v225, v121
  v_or_b32 v124, v224, v225
  v_xor_b32 v226, v226, v122
  v_xor_b32 v227, v227, v123
  v_or3_b32 v124, v124, v226, v227
  v_xor_b32 v228, v228, v120
  v_xor_b32 v229, v229, v121
  v_or3_b32 v124, v124, v228, v229
  v_xor_b32 v230, v230, v122
  v_xor_b32 v231, v231, v123
  v_or3_b32 v124, v124, v230, v231
  v_xor_b32 v232, v232, v120
  v_xor_b32 v233, v233, v121
  v_or3_b32 v124, v124, v232, v233
  v_xor_b32 v234, v234, v122
  v_xor_b32 v235, v235, v123
  v_or3_b32 v124, v124, v234, v235
  v_xor_b32 v236, v236, v120
  v_xor_b32 v237, v237, v121
  v_or3_b32 v124, v124, v236, v237
  v_xor_b32 v238, v238, v122
  v_xor_b32 v239, v239, v123
  v_or3_b32 v124, v124, v238, v239
  v_and_b32 v124, s51, v124
  v_cmp_ne_u32 vcc, 0, v124
  s_cmp_ge_u32 s66, 20000
  s_cbranch_scc1 L_ok03
  s_cbranch_vccnz L_rl03
  s_branch L_ok03
L_retry11:
  s_mov_b32 s66, 0
L_rl11:
  s_mov_b64 exec, 15
L_rs11:
  buffer_load_dwordx4 v[28:31], v125, s[32:35], s95 offen sc1
  s_add_u32 s66, s66, 1
  s_waitcnt vmcnt(0)
  v_xor_b32 v28, v28, v120
  v_xor_b32 v29, v29, v121
  v_or_b32 v124, v28, v29
  v_xor_b32 v30, v30, v122
  v_xor_b32 v31, v31, v123
  v_or3_b32 v124, v124, v30, v31
  v_and_b32 v124, s51, v124
  v_cmp_ne_u32 vcc, 0, v124
  s_cbranch_vccz L_rg11
  s_sleep 4
  s_cmp_lt_u32 s66, 20000
  s_cbranch_scc1 L_rs11
L_rg11:
  s_mov_b64 exec, -1
  buffer_load_dwordx4 v[64:67], v1, s[32:35], s47 offen offset:0 sc1
  buffer_load_dwordx4 v[68:71], v1, s[32:35], s47 offen offset:1024 sc1
  buffer_load_dwordx4 v[72:75], v1, s[32:35], s47 offen offset:2048 sc1
  buffer_load_dwordx4 v[76:79], v1, s[32:35], s47 offen offset:3072 sc1
  s_waitcnt vmcnt(0)
  v_xor_b32 v64, v64, v120
  v_xor_b32 v65, v65, v121
  v_or_b32 v124, v64, v65
  v_xor_b32 v66, v66, v122
  v_xor_b32 v67, v67, v123
  v_or3_b32 v124, v124, v66, v67
  v_xor_b32 v68, v68, v120
  v_xor_b32 v69, v69, v121
  v_or3_b32 v124, v124, v68, v69
  v_xor_b32 v70, v70, v122
  v_xor_b32 v71, v71, v123
  v_or3_b32 v124, v124, v70, v71
  v_xor_b32 v72, v72, v120
  v_xor_b32 v73, v73, v121
  v_or3_b32 v124, v124, v72, v73
  v_xor_b32 v74, v74, v122
  v_xor_b32 v75, v75, v123
  v_or3_b32 v124, v124, v74, v75
  v_xor_b32 v76, v76, v120
  v_xor_b32 v77, v77, v121
  v_or3_b32 v124, v124, v76, v77
  v_xor_b32 v78, v78, v122
  v_xor_b32 v79, v79, v123
  v_or3_b32 v124, v124, v78, v79
  v_and_b32 v124, s51, v124
  v_cmp_ne_u32 vcc, 0, v124
  s_cmp_ge_u32 s66, 20000
  s_cbranch_scc1 L_ok11
  s_cbranch_vccnz L_rl11
  s_branch L_ok11
L_retry12:
  s_mov_b32 s66, 0
L_rl12:
  s_mov_b64 exec, 240
L_rs12:
  buffer_load_dwordx4 v[28:31], v125, s[32:35], s95 offen sc1
  s_add_u32 s66, s66, 1
  s_waitcnt vmcnt(0)
  v_xor_b32 v28, v28, v120
  v_xor_b32 v29, v29, v121
  v_or_b32 v124, v28, v29
  v_xor_b32 v30, v30, v122
  v_xor_b32 v31, v31, v123
  v_or3_b32 v124, v124, v30, v31
  v_and_b32 v124, s51, v124
  v_cmp_ne_u32 vcc, 0, v124
  s_cbranch_vccz L_rg12
  s_sleep 4
  s_cmp_lt_u32 s66, 20000
  s_cbranch_scc1 L_rs12
L_rg12:
  s_mov_b64 exec, -1
  buffer_load_dwordx4 v[80:83], v1, s[32:35], s48 offen offset:0 sc1
  buffer_load_dwordx4 v[84:87], v1, s[32:35], s48 offen offset:1024 sc1
  buffer_load_dwordx4 v[88:91], v1, s[32:35], s48 offen offset:2048 sc1
  buffer_load_dwordx4 v[92:95], v1, s[32:35], s48 offen offset:3072 sc1
  s_waitcnt vmcnt(0)
  v_xor_b32 v80, v80, v120
  v_xor_b32 v81, v81, v121
  v_or_b32 v124, v80, v81
  v_xor_b32 v82, v82, v122
  v_xor_b32 v83, v83, v123
  v_or3_b32 v124, v124, v82, v83
  v_xor_b32 v84, v84, v120
  v_xor_b32 v85, v85, v121
  v_or3_b32 v124, v124, v84, v85
  v_xor_b32 v86, v86, v122
  v_xor_b32 v87, v87, v123
  v_or3_b32 v124, v124, v86, v87
  v_xor_b32 v88, v88, v120
  v_xor_b32 v89, v89, v121
  v_or3_b32 v124, v124, v88, v89
  v_xor_b32 v90, v90, v122
  v_xor_b32 v91, v91, v123
  v_or3_b32 v124, v124, v90, v91
  v_xor_b32 v92, v92, v120
  v_xor_b32 v93, v93, v121
  v_or3_b32 v124, v124, v92, v93
  v_xor_b32 v94, v94, v122
  v_xor_b32 v95, v95, v123
  v_or3_b32 v124, v124, v94, v95
  v_and_b32 v124, s51, v124
  v_cmp_ne_u32 vcc, 0, v124
  s_cmp_ge_u32 s66, 20000
  s_cbranch_scc1 L_ok12
  s_cbranch_vccnz L_rl12
  s_branch L_ok12
L_retry13:
  s_mov_b32 s66, 0
L_rl13:
  s_mov_b64 exec, 3840
L_rs13:
  buffer_load_dwordx4 v[28:31], v125, s[32:35], s95 offen sc1
  s_add_u32 s66, s66, 1
  s_waitcnt vmcnt(0)
  v_xor_b32 v28, v28, v120
  v_xor_b32 v29, v29, v121
  v_or_b32 v124, v28, v29
  v_xor_b32 v30, v30, v122
  v_xor_b32 v31, v31, v123
  v_or3_b32 v124, v124, v30, v31
  v_and_b32 v124, s51, v124
  v_cmp_ne_u32 vcc, 0, v124
  s_cbranch_vccz L_rg13
  s_sleep 4
  s_cmp_lt_u32 s66, 20000
  s_cbranch_scc1 L_rs13
L_rg13:
  s_mov_b64 exec, -1
  buffer_load_dwordx4 v[240:243], v1, s[32:35], s49 offen offset:0 sc1
  buffer_load_dwordx4 v[244:247], v1, s[32:35], s49 offen offset:1024 sc1
  buffer_load_dwordx4 v[248:251], v1, s[32:35], s49 offen offset:2048 sc1
  buffer_load_dwordx4 v[252:255], v1, s[32:35], s49 offen offset:3072 sc1
  s_waitcnt vmcnt(0)
  v_xor_b32 v240, v240, v120
  v_xor_b32 v241, v241, v121
  v_or_b32 v124, v240, v241
  v_xor_b32 v242, v242, v122
  v_xor_b32 v243, v243, v123
  v_or3_b32 v124, v124, v242, v243
  v_xor_b32 v244, v244, v120
  v_xor_b32 v245, v245, v121
  v_or3_b32 v124, v124, v244, v245
  v_xor_b32 v246, v246, v122
  v_xor_b32 v247, v247, v123
  v_or3_b32 v124, v124, v246, v247
  v_xor_b32 v248, v248, v120
  v_xor_b32 v249, v249, v121
  v_or3_b32 v124, v124, v248, v249
  v_xor_b32 v250, v250, v122
  v_xor_b32 v251, v251, v123
  v_or3_b32 v124, v124, v250, v251
  v_xor_b32 v252, v252, v120
  v_xor_b32 v253, v253, v121
  v_or3_b32 v124, v124, v252, v253
  v_xor_b32 v254, v254, v122
  v_xor_b32 v255, v255, v123
  v_or3_b32 v124, v124, v254, v255
  v_and_b32 v124, s51, v124
  v_cmp_ne_u32 vcc, 0, v124
  s_cmp_ge_u32 s66, 20000
  s_cbranch_scc1 L_ok13
  s_cbranch_vccnz L_rl13
  s_branch L_ok13
L_re0_0:
  s_mov_b64 exec, 15
  s_add_u32 s59, s54, 0
L_sp0_0:
  s_sleep 2
  buffer_load_dwordx4 v[104:107], v1, s[32:35], s59 offen sc1
  s_add_u32 s66, s66, 1
  s_waitcnt vmcnt(0)
  v_xor_b32 v104, v104, v120
  v_xor_b32 v105, v105, v121
  v_or_b32 v124, v104, v105
  v_xor_b32 v106, v106, v122
  v_xor_b32 v107, v107, v123
  v_or3_b32 v124, v124, v106, v107
  v_and_b32 v124, s51, v124
  v_cmp_ne_u32 vcc, 0, v124
  s_cmp_ge_u32 s66, 20000
  s_cbranch_scc1 L_sd0_0
  s_cbranch_vccnz L_sp0_0
L_sd0_0:
  s_mov_b64 exec, -1
  s_cmp_ge_u32 s66, 20000
  s_cbranch_scc1 L_go0_0
  s_waitcnt vmcnt(40)
  buffer_load_dwordx4 v[128:131], v1, s[32:35], s54 offen sc1
  s_add_u32 s59, s54, 5120
  buffer_load_dwordx4 v[132:135], v1, s[32:35], s59 offen sc1
  s_add_u32 s59, s54, 10240
  buffer_load_dwordx4 v[136:139], v1, s[32:35], s59 offen sc1
  s_add_u32 s59, s54, 15360
  buffer_load_dwordx4 v[140:143], v1, s[32:35], s59 offen sc1
  s_add_u32 s59, s54, 20480
  buffer_load_dwordx4 v[144:147], v1, s[32:35], s59 offen sc1
  s_add_u32 s59, s54, 25600
  buffer_load_dwordx4 v[148:151], v1, s[32:35], s59 offen sc1
  s_add_u32 s59, s54, 30720
  buffer_load_dwordx4 v[152:155], v1, s[32:35], s59 offen sc1
  s_add_u32 s59, s54, 35840
  buffer_load_dwordx4 v[156:159], v1, s[32:35], s59 offen sc1
  s_branch L_w0_0
L_re0_1:
  s_mov_b64 exec, 15
  s_add_u32 s59, s54, 5120
L_sp0_1:
  s_sleep 2
  buffer_load_dwordx4 v[104:107], v1, s[32:35], s59 offen sc1
  s_add_u32 s66, s66, 1
  s_waitcnt vmcnt(0)
  v_xor_b32 v104, v104, v120
  v_xor_b32 v105, v105, v121
  v_or_b32 v124, v104, v105
  v_xor_b32 v106, v106, v122
  v_xor_b32 v107, v107, v123
  v_or3_b32 v124, v124, v106, v107
  v_and_b32 v124, s51, v124
  v_cmp_ne_u32 vcc, 0, v124
  s_cmp_ge_u32 s66, 20000
  s_cbranch_scc1 L_sd0_1
  s_cbranch_vccnz L_sp0_1
L_sd0_1:
  s_mov_b64 exec, -1
  s_cmp_ge_u32 s66, 20000
  s_cbranch_scc1 L_go0_1
  s_waitcnt vmcnt(40)
  s_add_u32 s59, s54, 5120
  buffer_load_dwordx4 v[132:135], v1, s[32:35], s59 offen sc1
  s_add_u32 s59, s54, 10240
  buffer_load_dwordx4 v[136:139], v1, s[32:35], s59 offen sc1
  s_add_u32 s59, s54, 15360
  buffer_load_dwordx4 v[140:143], v1, s[32:35], s59 offen sc1
  s_add_u32 s59, s54, 20480
  buffer_load_dwordx4 v[144:147], v1, s[32:35], s59 offen sc1
  s_add_u32 s59, s54, 25600
  buffer_load_dwordx4 v[148:151], v1, s[32:35], s59 offen sc1
  s_add_u32 s59, s54, 30720
  buffer_load_dwordx4 v[152:155], v1, s[32:35], s59 offen sc1
  s_add_u32 s59, s54, 35840
  buffer_load_dwordx4 v[156:159], v1, s[32:35], s59 offen sc1
  s_branch L_w0_1
L_re0_2:
  s_mov_b64 exec, 15
  s_add_u32 s59, s54, 10240
L_sp0_2:
  s_sleep 2
  buffer_load_dwordx4 v[104:107], v1, s[32:35], s59 offen sc1
  s_add_u32 s66, s66, 1
  s_waitcnt vmcnt(0)
  v_xor_b32 v104, v104, v120
  v_xor_b32 v105, v105, v121
  v_or_b32 v124, v104, v105
  v_xor_b32 v106, v106, v122
  v_xor_b32 v107, v107, v123
  v_or3_b32 v124, v124, v106, v107
  v_and_b32 v124, s51, v124
  v_cmp_ne_u32 vcc, 0, v124
  s_cmp_ge_u32 s66, 20000
  s_cbranch_scc1 L_sd0_2
  s_cbranch_vccnz L_sp0_2
L_sd0_2:
  s_mov_b64 exec, -1
  s_cmp_ge_u32 s66, 20000
  s_cbranch_scc1 L_go0_2
  s_waitcnt vmcnt(40)
  s_add_u32 s59, s54, 10240
  buffer_load_dwordx4 v[136:139], v1, s[32:35], s59 offen sc1
  s_add_u32 s59, s54, 15360
  buffer_load_dwordx4 v[140:143], v1, s[32:35], s59 offen sc1
  s_add_u32 s59, s54, 20480
  buffer_load_dwordx4 v[144:147], v1, s[32:35], s59 offen sc1
  s_add_u32 s59, s54, 25600
  buffer_load_dwordx4 v[148:151], v1, s[32:35], s59 offen sc1
  s_add_u32 s59, s54, 30720
  buffer_load_dwordx4 v[152:155], v1, s[32:35], s59 offen sc1
  s_add_u32 s59, s54, 35840
  buffer_load_dwordx4 v[156:159], v1, s[32:35], s59 offen sc1
  s_branch L_w0_2
L_re0_3:
  s_mov_b64 exec, 15
  s_add_u32 s59, s54, 15360
L_sp0_3:
  s_sleep 2
  buffer_load_dwordx4 v[104:107], v1, s[32:35], s59 offen sc1
  s_add_u32 s66, s66, 1
  s_waitcnt vmcnt(0)
  v_xor_b32 v104, v104, v120
  v_xor_b32 v105, v105, v121
  v_or_b32 v124, v104, v105
  v_xor_b32 v106, v106, v122
  v_xor_b32 v107, v107, v123
  v_or3_b32 v124, v124, v106, v107
  v_and_b32 v124, s51, v124
  v_cmp_ne_u32 vcc, 0, v124
  s_cmp_ge_u32 s66, 20000
  s_cbranch_scc1 L_sd0_3
  s_cbranch_vccnz L_sp0_3
L_sd0_3:
  s_mov_b64 exec, -1
  s_cmp_ge_u32 s66, 20000
  s_cbranch_scc1 L_go0_3
  s_waitcnt vmcnt(40)
  s_add_u32 s59, s54, 15360
  buffer_load_dwordx4 v[140:143], v1, s[32:35], s59 offen sc1
  s_add_u32 s59, s54, 20480
  buffer_load_dwordx4 v[144:147], v1, s[32:35], s59 offen sc1
  s_add_u32 s59, s54, 25600
  buffer_load_dwordx4 v[148:151], v1, s[32:35], s59 offen sc1
  s_add_u32 s59, s54, 30720
  buffer_load_dwordx4 v[152:155], v1, s[32:35], s59 offen sc1
  s_add_u32 s59, s54, 35840
  buffer_load_dwordx4 v[156:159], v1, s[32:35], s59 offen sc1
  s_branch L_w0_3
L_re0_4:
  s_mov_b64 exec, 15
  s_add_u32 s59, s54, 20480
L_sp0_4:
  s_sleep 2
  buffer_load_dwordx4 v[104:107], v1, s[32:35], s59 offen sc1
  s_add_u32 s66, s66, 1
  s_waitcnt vmcnt(0)
  v_xor_b32 v104, v104, v120
  v_xor_b32 v105, v105, v121
  v_or_b32 v124, v104, v105
  v_xor_b32 v106, v106, v122
  v_xor_b32 v107, v107, v123
  v_or3_b32 v124, v124, v106, v107
  v_and_b32 v124, s51, v124
  v_cmp_ne_u32 vcc, 0, v124
  s_cmp_ge_u32 s66, 20000
  s_cbranch_scc1 L_sd0_4
  s_cbranch_vccnz L_sp0_4
L_sd0_4:
  s_mov_b64 exec, -1
  s_cmp_ge_u32 s66, 20000
  s_cbranch_scc1 L_go0_4
  s_waitcnt vmcnt(40)
  s_add_u32 s59, s54, 20480
  buffer_load_dwordx4 v[144:147], v1, s[32:35], s59 offen sc1
  s_add_u32 s59, s54, 25600
  buffer_load_dwordx4 v[148:151], v1, s[32:35], s59 offen sc1
  s_add_u32 s59, s54, 30720
  buffer_load_dwordx4 v[152:155], v1, s[32:35], s59 offen sc1
  s_add_u32 s59, s54, 35840
  buffer_load_dwordx4 v[156:159], v1, s[32:35], s59 offen sc1
  s_branch L_w0_4
L_re0_5:
  s_mov_b64 exec, 15
  s_add_u32 s59, s54, 25600
L_sp0_5:
  s_sleep 2
  buffer_load_dwordx4 v[104:107], v1, s[32:35], s59 offen sc1
  s_add_u32 s66, s66, 1
  s_waitcnt vmcnt(0)
  v_xor_b32 v104, v104, v120
  v_xor_b32 v105, v105, v121
  v_or_b32 v124, v104, v105
  v_xor_b32 v106, v106, v122
  v_xor_b32 v107, v107, v123
  v_or3_b32 v124, v124, v106, v107
  v_and_b32 v124, s51, v124
  v_cmp_ne_u32 vcc, 0, v124
  s_cmp_ge_u32 s66, 20000
  s_cbranch_scc1 L_sd0_5
  s_cbranch_vccnz L_sp0_5
L_sd0_5:
  s_mov_b64 exec, -1
  s_cmp_ge_u32 s66, 20000
  s_cbranch_scc1 L_go0_5
  s_waitcnt vmcnt(40)
  s_add_u32 s59, s54, 25600
  buffer_load_dwordx4 v[148:151], v1, s[32:35], s59 offen sc1
  s_add_u32 s59, s54, 30720
  buffer_load_dwordx4 v[152:155], v1, s[32:35], s59 offen sc1
  s_add_u32 s59, s54, 35840
  buffer_load_dwordx4 v[156:159], v1, s[32:35], s59 offen sc1
  s_branch L_w0_5
L_re0_6:
  s_mov_b64 exec, 15
  s_add_u32 s59, s54, 30720
L_sp0_6:
  s_sleep 2
  buffer_load_dwordx4 v[104:107], v1, s[32:35], s59 offen sc1
  s_add_u32 s66, s66, 1
  s_waitcnt vmcnt(0)
  v_xor_b32 v104, v104, v120
  v_xor_b32 v105, v105, v121
  v_or_b32 v124, v104, v105
  v_xor_b32 v106, v106, v122
  v_xor_b32 v107, v107, v123
  v_or3_b32 v124, v124, v106, v107
  v_and_b32 v124, s51, v124
  v_cmp_ne_u32 vcc, 0, v124
  s_cmp_ge_u32 s66, 20000
  s_cbranch_scc1 L_sd0_6
  s_cbranch_vccnz L_sp0_6
L_sd0_6:
  s_mov_b64 exec, -1
  s_cmp_ge_u32 s66, 20000
  s_cbranch_scc1 L_go0_6
  s_waitcnt vmcnt(40)
  s_add_u32 s59, s54, 30720
  buffer_load_dwordx4 v[152:155], v1, s[32:35], s59 offen sc1
  s_add_u32 s59, s54, 35840
  buffer_load_dwordx4 v[156:159], v1, s[32:35], s59 offen sc1
  s_branch L_w0_6
L_re0_7:
  s_mov_b64 exec, 15
  s_add_u32 s59, s54, 35840
L_sp0_7:
  s_sleep 2
  buffer_load_dwordx4 v[104:107], v1, s[32:35], s59 offen sc1
  s_add_u32 s66, s66, 1
  s_waitcnt vmcnt(0)
  v_xor_b32 v104, v104, v120
  v_xor_b32 v105, v105, v121
  v_or_b32 v124, v104, v105
  v_xor_b32 v106, v106, v122
  v_xor_b32 v107, v107, v123
  v_or3_b32 v124, v124, v106, v107
  v_and_b32 v124, s51, v124
  v_cmp_ne_u32 vcc, 0, v124
  s_cmp_ge_u32 s66, 20000
  s_cbranch_scc1 L_sd0_7
  s_cbranch_vccnz L_sp0_7
L_sd0_7:
  s_mov_b64 exec, -1
  s_cmp_ge_u32 s66, 20000
  s_cbranch_scc1 L_go0_7
  s_waitcnt vmcnt(40)
  s_add_u32 s59, s54, 35840
  buffer_load_dwordx4 v[156:159], v1, s[32:35], s59 offen sc1
  s_branch L_w0_7
L_re1_0:
  s_mov_b64 exec, 15
  s_add_u32 s59, s52, 0
L_sp1_0:
  s_sleep 2
  buffer_load_dwordx4 v[104:107], v1, s[32:35], s59 offen sc1
  s_add_u32 s66, s66, 1
  s_waitcnt vmcnt(0)
  v_xor_b32 v104, v104, v120
  v_xor_b32 v105, v105, v121
  v_or_b32 v124, v104, v105
  v_xor_b32 v106, v106, v122
  v_xor_b32 v107, v107, v123
  v_or3_b32 v124, v124, v106, v107
  v_and_b32 v124, s51, v124
  v_cmp_ne_u32 vcc, 0, v124
  s_cmp_ge_u32 s66, 20000
  s_cbranch_scc1 L_sd1_0
  s_cbranch_vccnz L_sp1_0
L_sd1_0:
  s_mov_b64 exec, -1
  s_cmp_ge_u32 s66, 20000
  s_cbranch_scc1 L_go1_0
  s_waitcnt vmcnt(40)
  buffer_load_dwordx4 v[128:131], v1, s[32:35], s54 offen sc1
  buffer_load_dwordx4 v[160:163], v1, s[32:35], s52 offen sc1
  s_add_u32 s59, s54, 5120
  buffer_load_dwordx4 v[132:135], v1, s[32:35], s59 offen sc1
  s_add_u32 s59, s52, 5120
  buffer_load_dwordx4 v[164:167], v1, s[32:35], s59 offen sc1
  s_add_u32 s59, s54, 10240
  buffer_load_dwordx4 v[136:139], v1, s[32:35], s59 offen sc1
  s_add_u32 s59, s52, 10240
  buffer_load_dwordx4 v[168:171], v1, s[32:35], s59 offen sc1
  s_add_u32 s59, s54, 15360
  buffer_load_dwordx4 v[140:143], v1, s[32:35], s59 offen sc1
  s_add_u32 s59, s52, 15360
  buffer_load_dwordx4 v[172:175], v1, s[32:35], s59 offen sc1
  s_add_u32 s59, s54, 20480
  buffer_load_dwordx4 v[144:147], v1, s[32:35], s59 offen sc1
  s_add_u32 s59, s52, 20480
  buffer_load_dwordx4 v[176:179], v1, s[32:35], s59 offen sc1
  s_add_u32 s59, s54, 25600
  buffer_load_dwordx4 v[148:151], v1, s[32:35], s59 offen sc1
  s_add_u32 s59, s52, 25600
  buffer_load_dwordx4 v[180:183], v1, s[32:35], s59 offen sc1
  s_add_u32 s59, s54, 30720
  buffer_load_dwordx4 v[152:155], v1, s[32:35], s59 offen sc1
  s_add_u32 s59, s52, 30720
  buffer_load_dwordx4 v[184:187], v1, s[32:35], s59 offen sc1
  s_add_u32 s59, s54, 35840
  buffer_load_dwordx4 v[156:159], v1, s[32:35], s59 offen sc1
  s_add_u32 s59, s52, 35840
  buffer_load_dwordx4 v[188:191], v1, s[32:35], s59 offen sc1
  s_branch L_w1_0
L_re1_1:
  s_mov_b64 exec, 15
  s_add_u32 s59, s52, 5120
L_sp1_1:
  s_sleep 2
  buffer_load_dwordx4 v[104:107], v1, s[32:35], s59 offen sc1
  s_add_u32 s66, s66, 1
  s_waitcnt vmcnt(0)
  v_xor_b32 v104, v104, v120
  v_xor_b32 v105, v105, v121
  v_or_b32 v124, v104, v105
  v_xor_b32 v106, v106, v122
  v_xor_b32 v107, v107, v123
  v_or3_b32 v124, v124, v106, v107
  v_and_b32 v124, s51, v124
  v_cmp_ne_u32 vcc, 0, v124
  s_cmp_ge_u32 s66, 20000
  s_cbranch_scc1 L_sd1_1
  s_cbranch_vccnz L_sp1_1
L_sd1_1:
  s_mov_b64 exec, -1
  s_cmp_ge_u32 s66, 20000
  s_cbranch_scc1 L_go1_1
  s_waitcnt vmcnt(40)
  s_add_u32 s59, s54, 5120
  buffer_load_dwordx4 v[132:135], v1, s[32:35], s59 offen sc1
  s_add_u32 s59, s52, 5120
  buffer_load_dwordx4 v[164:167], v1, s[32:35], s59 offen sc1
  s_add_u32 s59, s54, 10240
  buffer_load_dwordx4 v[136:139], v1, s[32:35], s59 offen sc1
  s_add_u32 s59, s52, 10240
  buffer_load_dwordx4 v[168:171], v1, s[32:35], s59 offen sc1
  s_add_u32 s59, s54, 15360
  buffer_load_dwordx4 v[140:143], v1, s[32:35], s59 offen sc1
  s_add_u32 s59, s52, 15360
  buffer_load_dwordx4 v[172:175], v1, s[32:35], s59 offen sc1
  s_add_u32 s59, s54, 20480
  buffer_load_dwordx4 v[144:147], v1, s[32:35], s59 offen sc1
  s_add_u32 s59, s52, 20480
  buffer_load_dwordx4 v[176:179], v1, s[32:35], s59 offen sc1
  s_add_u32 s59, s54, 25600
  buffer_load_dwordx4 v[148:151], v1, s[32:35], s59 offen sc1
  s_add_u32 s59, s52, 25600
  buffer_load_dwordx4 v[180:183], v1, s[32:35], s59 offen sc1
  s_add_u32 s59, s54, 30720
  buffer_load_dwordx4 v[152:155], v1, s[32:35], s59 offen sc1
  s_add_u32 s59, s52, 30720
  buffer_load_dwordx4 v[184:187], v1, s[32:35], s59 offen sc1
  s_add_u32 s59, s54, 35840
  buffer_load_dwordx4 v[156:159], v1, s[32:35], s59 offen sc1
  s_add_u32 s59, s52, 35840
  buffer_load_dwordx4 v[188:191], v1, s[32:35], s59 offen sc1
  s_branch L_w1_1
L_re1_2:
  s_mov_b64 exec, 15
  s_add_u32 s59, s52, 10240
L_sp1_2:
  s_sleep 2
  buffer_load_dwordx4 v[104:107], v1, s[32:35], s59 offen sc1
  s_add_u32 s66, s66, 1
  s_waitcnt vmcnt(0)
  v_xor_b32 v104, v104, v120
  v_xor_b32 v105, v105, v121
  v_or_b32 v124, v104, v105
  v_xor_b32 v106, v106, v122
  v_xor_b32 v107, v107, v123
  v_or3_b32 v124, v124, v106, v107
  v_and_b32 v124, s51, v124
  v_cmp_ne_u32 vcc, 0, v124
  s_cmp_ge_u32 s66, 20000
  s_cbranch_scc1 L_sd1_2
  s_cbranch_vccnz L_sp1_2
L_sd1_2:
  s_mov_b64 exec, -1
  s_cmp_ge_u32 s66, 20000
  s_cbranch_scc1 L_go1_2
  s_waitcnt vmcnt(40)
  s_add_u32 s59, s54, 10240
  buffer_load_dwordx4 v[136:139], v1, s[32:35], s59 offen sc1
  s_add_u32 s59, s52, 10240
  buffer_load_dwordx4 v[168:171], v1, s[32:35], s59 offen sc1
  s_add_u32 s59, s54, 15360
  buffer_load_dwordx4 v[140:143], v1, s[32:35], s59 offen sc1
  s_add_u32 s59, s52, 15360
  buffer_load_dwordx4 v[172:175], v1, s[32:35], s59 offen sc1
  s_add_u32 s59, s54, 20480
  buffer_load_dwordx4 v[144:147], v1, s[32:35], s59 offen sc1
  s_add_u32 s59, s52, 20480
  buffer_load_dwordx4 v[176:179], v1, s[32:35], s59 offen sc1
  s_add_u32 s59, s54, 25600
  buffer_load_dwordx4 v[148:151], v1, s[32:35], s59 offen sc1
  s_add_u32 s59, s52, 25600
  buffer_load_dwordx4 v[180:183], v1, s[32:35], s59 offen sc1
  s_add_u32 s59, s54, 30720
  buffer_load_dwordx4 v[152:155], v1, s[32:35], s59 offen sc1
  s_add_u32 s59, s52, 30720
  buffer_load_dwordx4 v[184:187], v1, s[32:35], s59 offen sc1
  s_add_u32 s59, s54, 35840
  buffer_load_dwordx4 v[156:159], v1, s[32:35], s59 offen sc1
  s_add_u32 s59, s52, 35840
  buffer_load_dwordx4 v[188:191], v1, s[32:35], s59 offen sc1
  s_branch L_w1_2
L_re1_3:
  s_mov_b64 exec, 15
  s_add_u32 s59, s52, 15360
L_sp1_3:
  s_sleep 2
  buffer_load_dwordx4 v[104:107], v1, s[32:35], s59 offen sc1
  s_add_u32 s66, s66, 1
  s_waitcnt vmcnt(0)
  v_xor_b32 v104, v104, v120
  v_xor_b32 v105, v105, v121
  v_or_b32 v124, v104, v105
  v_xor_b32 v106, v106, v122
  v_xor_b32 v107, v107, v123
  v_or3_b32 v124, v124, v106, v107
  v_and_b32 v124, s51, v124
  v_cmp_ne_u32 vcc, 0, v124
  s_cmp_ge_u32 s66, 20000
  s_cbranch_scc1 L_sd1_3
  s_cbranch_vccnz L_sp1_3
L_sd1_3:
  s_mov_b64 exec, -1
  s_cmp_ge_u32 s66, 20000
  s_cbranch_scc1 L_go1_3
  s_waitcnt vmcnt(40)
  s_add_u32 s59, s54, 15360
  buffer_load_dwordx4 v[140:143], v1, s[32:35], s59 offen sc1
  s_add_u32 s59, s52, 15360
  buffer_load_dwordx4 v[172:175], v1, s[32:35], s59 offen sc1
  s_add_u32 s59, s54, 20480
  buffer_load_dwordx4 v[144:147], v1, s[32:35], s59 offen sc1
  s_add_u32 s59, s52, 20480
  buffer_load_dwordx4 v[176:179], v1, s[32:35], s59 offen sc1
  s_add_u32 s59, s54, 25600
  buffer_load_dwordx4 v[148:151], v1, s[32:35], s59 offen sc1
  s_add_u32 s59, s52, 25600
  buffer_load_dwordx4 v[180:183], v1, s[32:35], s59 offen sc1
  s_add_u32 s59, s54, 30720
  buffer_load_dwordx4 v[152:155], v1, s[32:35], s59 offen sc1
  s_add_u32 s59, s52, 30720
  buffer_load_dwordx4 v[184:187], v1, s[32:35], s59 offen sc1
  s_add_u32 s59, s54, 35840
  buffer_load_dwordx4 v[156:159], v1, s[32:35], s59 offen sc1
  s_add_u32 s59, s52, 35840
  buffer_load_dwordx4 v[188:191], v1, s[32:35], s59 offen sc1
  s_branch L_w1_3
L_re1_4:
  s_mov_b64 exec, 15
  s_add_u32 s59, s52, 20480
L_sp1_4:
  s_sleep 2
  buffer_load_dwordx4 v[104:107], v1, s[32:35], s59 offen sc1
  s_add_u32 s66, s66, 1
  s_waitcnt vmcnt(0)
  v_xor_b32 v104, v104, v120
  v_xor_b32 v105, v105, v121
  v_or_b32 v124, v104, v105
  v_xor_b32 v106, v106, v122
  v_xor_b32 v107, v107, v123
  v_or3_b32 v124, v124, v106, v107
  v_and_b32 v124, s51, v124
  v_cmp_ne_u32 vcc, 0, v124
  s_cmp_ge_u32 s66, 20000
  s_cbranch_scc1 L_sd1_4
  s_cbranch_vccnz L_sp1_4
L_sd1_4:
  s_mov_b64 exec, -1
  s_cmp_ge_u32 s66, 20000
  s_cbranch_scc1 L_go1_4
  s_waitcnt vmcnt(40)
  s_add_u32 s59, s54, 20480
  buffer_load_dwordx4 v[144:147], v1, s[32:35], s59 offen sc1
  s_add_u32 s59, s52, 20480
  buffer_load_dwordx4 v[176:179], v1, s[32:35], s59 offen sc1
  s_add_u32 s59, s54, 25600
  buffer_load_dwordx4 v[148:151], v1, s[32:35], s59 offen sc1
  s_add_u32 s59, s52, 25600
  buffer_load_dwordx4 v[180:183], v1, s[32:35], s59 offen sc1
  s_add_u32 s59, s54, 30720
  buffer_load_dwordx4 v[152:155], v1, s[32:35], s59 offen sc1
  s_add_u32 s59, s52, 30720
  buffer_load_dwordx4 v[184:187], v1, s[32:35], s59 offen sc1
  s_add_u32 s59, s54, 35840
  buffer_load_dwordx4 v[156:159], v1, s[32:35], s59 offen sc1
  s_add_u32 s59, s52, 35840
  buffer_load_dwordx4 v[188:191], v1, s[32:35], s59 offen sc1
  s_branch L_w1_4
L_re1_5:
  s_mov_b64 exec, 15
  s_add_u32 s59, s52, 25600
L_sp1_5:
  s_sleep 2
  buffer_load_dwordx4 v[104:107], v1, s[32:35], s59 offen sc1
  s_add_u32 s66, s66, 1
  s_waitcnt vmcnt(0)
  v_xor_b32 v104, v104, v120
  v_xor_b32 v105, v105, v121
  v_or_b32 v124, v104, v105
  v_xor_b32 v106, v106, v122
  v_xor_b32 v107, v107, v123
  v_or3_b32 v124, v124, v106, v107
  v_and_b32 v124, s51, v124
  v_cmp_ne_u32 vcc, 0, v124
  s_cmp_ge_u32 s66, 20000
  s_cbranch_scc1 L_sd1_5
  s_cbranch_vccnz L_sp1_5
L_sd1_5:
  s_mov_b64 exec, -1
  s_cmp_ge_u32 s66, 20000
  s_cbranch_scc1 L_go1_5
  s_waitcnt vmcnt(40)
  s_add_u32 s59, s54, 25600
  buffer_load_dwordx4 v[148:151], v1, s[32:35], s59 offen sc1
  s_add_u32 s59, s52, 25600
  buffer_load_dwordx4 v[180:183], v1, s[32:35], s59 offen sc1
  s_add_u32 s59, s54, 30720
  buffer_load_dwordx4 v[152:155], v1, s[32:35], s59 offen sc1
  s_add_u32 s59, s52, 30720
  buffer_load_dwordx4 v[184:187], v1, s[32:35], s59 offen sc1
  s_add_u32 s59, s54, 35840
  buffer_load_dwordx4 v[156:159], v1, s[32:35], s59 offen sc1
  s_add_u32 s59, s52, 35840
  buffer_load_dwordx4 v[188:191], v1, s[32:35], s59 offen sc1
  s_branch L_w1_5
L_re1_6:
  s_mov_b64 exec, 15
  s_add_u32 s59, s52, 30720
L_sp1_6:
  s_sleep 2
  buffer_load_dwordx4 v[104:107], v1, s[32:35], s59 offen sc1
  s_add_u32 s66, s66, 1
  s_waitcnt vmcnt(0)
  v_xor_b32 v104, v104, v120
  v_xor_b32 v105, v105, v121
  v_or_b32 v124, v104, v105
  v_xor_b32 v106, v106, v122
  v_xor_b32 v107, v107, v123
  v_or3_b32 v124, v124, v106, v107
  v_and_b32 v124, s51, v124
  v_cmp_ne_u32 vcc, 0, v124
  s_cmp_ge_u32 s66, 20000
  s_cbranch_scc1 L_sd1_6
  s_cbranch_vccnz L_sp1_6
L_sd1_6:
  s_mov_b64 exec, -1
  s_cmp_ge_u32 s66, 20000
  s_cbranch_scc1 L_go1_6
  s_waitcnt vmcnt(40)
  s_add_u32 s59, s54, 30720
  buffer_load_dwordx4 v[152:155], v1, s[32:35], s59 offen sc1
  s_add_u32 s59, s52, 30720
  buffer_load_dwordx4 v[184:187], v1, s[32:35], s59 offen sc1
  s_add_u32 s59, s54, 35840
  buffer_load_dwordx4 v[156:159], v1, s[32:35], s59 offen sc1
  s_add_u32 s59, s52, 35840
  buffer_load_dwordx4 v[188:191], v1, s[32:35], s59 offen sc1
  s_branch L_w1_6
L_re1_7:
  s_mov_b64 exec, 15
  s_add_u32 s59, s52, 35840
L_sp1_7:
  s_sleep 2
  buffer_load_dwordx4 v[104:107], v1, s[32:35], s59 offen sc1
  s_add_u32 s66, s66, 1
  s_waitcnt vmcnt(0)
  v_xor_b32 v104, v104, v120
  v_xor_b32 v105, v105, v121
  v_or_b32 v124, v104, v105
  v_xor_b32 v106, v106, v122
  v_xor_b32 v107, v107, v123
  v_or3_b32 v124, v124, v106, v107
  v_and_b32 v124, s51, v124
  v_cmp_ne_u32 vcc, 0, v124
  s_cmp_ge_u32 s66, 20000
  s_cbranch_scc1 L_sd1_7
  s_cbranch_vccnz L_sp1_7
L_sd1_7:
  s_mov_b64 exec, -1
  s_cmp_ge_u32 s66, 20000
  s_cbranch_scc1 L_go1_7
  s_waitcnt vmcnt(40)
  s_add_u32 s59, s54, 35840
  buffer_load_dwordx4 v[156:159], v1, s[32:35], s59 offen sc1
  s_add_u32 s59, s52, 35840
  buffer_load_dwordx4 v[188:191], v1, s[32:35], s59 offen sc1
  s_branch L_w1_7
L_codeend:
L_rarev0_1:
  v_max3_f32 v24, v80, v81, v82
  v_max3_f32 v24, v24, v83, v84
  v_max3_f32 v24, v24, v85, v86
  v_max3_f32 v24, v24, v87, v88
  v_max3_f32 v24, v24, v89, v90
  v_max3_f32 v24, v24, v91, v92
  v_max3_f32 v24, v24, v93, v94
  v_max_f32 v24, v24, v95
  s_call_b64 s[64:65], L_rescale
  v_exp_f32 v24, v80
  v_exp_f32 v25, v81
  v_exp_f32 v26, v82
  v_cvt_pk_bf16_f32 v136, v24, v25
  v_exp_f32 v27, v83
  v_exp_f32 v24, v84
  v_cvt_pk_bf16_f32 v137, v26, v27
  v_exp_f32 v25, v85
  v_exp_f32 v26, v86
  v_cvt_pk_bf16_f32 v138, v24, v25
  v_exp_f32 v27, v87
  v_exp_f32 v24, v88
  v_cvt_pk_bf16_f32 v139, v26, v27
  v_exp_f32 v25, v89
  v_exp_f32 v26, v90
  v_cvt_pk_bf16_f32 v140, v24, v25
  v_exp_f32 v27, v91
  v_exp_f32 v24, v92
  v_cvt_pk_bf16_f32 v141, v26, v27
  v_exp_f32 v25, v93
  v_exp_f32 v26, v94
  v_cvt_pk_bf16_f32 v142, v24, v25
  v_exp_f32 v27, v95
  v_or3_b32 v15, v136, v137, v138
  v_cvt_pk_bf16_f32 v143, v26, v27
  s_nop 1
  s_branch L_backv0_1
L_rarev0_2:
  v_max3_f32 v24, v112, v113, v114
  v_max3_f32 v24, v24, v115, v116
  v_max3_f32 v24, v24, v117, v118
  v_max3_f32 v24, v24, v119, v120
  v_max3_f32 v24, v24, v121, v122
  v_max3_f32 v24, v24, v123, v124
  v_max3_f32 v24, v24, v125, v126
  v_max_f32 v24, v24, v127
  s_call_b64 s[64:65], L_rescale
  v_exp_f32 v24, v112
  v_exp_f32 v25, v113
  v_exp_f32 v26, v114
  v_cvt_pk_bf16_f32 v144, v24, v25
  v_exp_f32 v27, v115
  v_exp_f32 v24, v116
  v_cvt_pk_bf16_f32 v145, v26, v27
  v_exp_f32 v25, v117
  v_exp_f32 v26, v118
  v_cvt_pk_bf16_f32 v146, v24, v25
  v_exp_f32 v27, v119
  v_exp_f32 v24, v120
  v_cvt_pk_bf16_f32 v147, v26, v27
  v_exp_f32 v25, v121
  v_exp_f32 v26, v122
  v_cvt_pk_bf16_f32 v148, v24, v25
  v_exp_f32 v27, v123
  v_exp_f32 v24, v124
  v_cvt_pk_bf16_f32 v149, v26, v27
  v_exp_f32 v25, v125
  v_exp_f32 v26, v126
  v_cvt_pk_bf16_f32 v150, v24, v25
  v_exp_f32 v27, v127
  v_or3_b32 v15, v144, v145, v146
  v_cvt_pk_bf16_f32 v151, v26, v27
  s_nop 1
  s_branch L_backv0_2
L_rarev0_3:
  v_max3_f32 v24, v64, v65, v66
  v_max3_f32 v24, v24, v67, v68
  v_max3_f32 v24, v24, v69, v70
  v_max3_f32 v24, v24, v71, v72
  v_max3_f32 v24, v24, v73, v74
  v_max3_f32 v24, v24, v75, v76
  v_max3_f32 v24, v24, v77, v78
  v_max_f32 v24, v24, v79
  s_call_b64 s[64:65], L_rescale
  v_exp_f32 v24, v64
  v_exp_f32 v25, v65
  v_exp_f32 v26, v66
  v_cvt_pk_bf16_f32 v152, v24, v25
  v_exp_f32 v27, v67
  v_exp_f32 v24, v68
  v_cvt_pk_bf16_f32 v153, v26, v27
  v_exp_f32 v25, v69
  v_exp_f32 v26, v70
  v_cvt_pk_bf16_f32 v154, v24, v25
  v_exp_f32 v27, v71
  v_exp_f32 v24, v72
  v_cvt_pk_bf16_f32 v155, v26, v27
  v_exp_f32 v25, v73
  v_exp_f32 v26, v74
  v_cvt_pk_bf16_f32 v156, v24, v25
  v_exp_f32 v27, v75
  v_exp_f32 v24, v76
  v_cvt_pk_bf16_f32 v157, v26, v27
  v_exp_f32 v25, v77
  v_exp_f32 v26, v78
  v_cvt_pk_bf16_f32 v158, v24, v25
  v_exp_f32 v27, v79
  v_or3_b32 v15, v152, v153, v154
  v_cvt_pk_bf16_f32 v159, v26, v27
  s_nop 1
  s_branch L_backv0_3
L_rarev0_4:
  v_max3_f32 v24, v80, v81, v82
  v_max3_f32 v24, v24, v83, v84
  v_max3_f32 v24, v24, v85, v86
  v_max3_f32 v24, v24, v87, v88
  v_max3_f32 v24, v24, v89, v90
  v_max3_f32 v24, v24, v91, v92
  v_max3_f32 v24, v24, v93, v94
  v_max_f32 v24, v24, v95
  s_call_b64 s[64:65], L_rescale
  v_exp_f32 v24, v80
  v_exp_f32 v25, v81
  v_exp_f32 v26, v82
  v_cvt_pk_bf16_f32 v160, v24, v25
  v_exp_f32 v27, v83
  v_exp_f32 v24, v84
  v_cvt_pk_bf16_f32 v161, v26, v27
  v_exp_f32 v25, v85
  v_exp_f32 v26, v86
  v_cvt_pk_bf16_f32 v162, v24, v25
  v_exp_f32 v27, v87
  v_exp_f32 v24, v88
  v_cvt_pk_bf16_f32 v163, v26, v27
  v_exp_f32 v25, v89
  v_exp_f32 v26, v90
  v_cvt_pk_bf16_f32 v164, v24, v25
  v_exp_f32 v27, v91
  v_exp_f32 v24, v92
  v_cvt_pk_bf16_f32 v165, v26, v27
  v_exp_f32 v25, v93
  v_exp_f32 v26, v94
  v_cvt_pk_bf16_f32 v166, v24, v25
  v_exp_f32 v27, v95
  v_or3_b32 v15, v160, v161, v162
  v_cvt_pk_bf16_f32 v167, v26, v27
  s_nop 1
  s_branch L_backv0_4
L_rarev0_5:
  v_max3_f32 v24, v112, v113, v114
  v_max3_f32 v24, v24, v115, v116
  v_max3_f32 v24, v24, v117, v118
  v_max3_f32 v24, v24, v119, v120
  v_max3_f32 v24, v24, v121, v122
  v_max3_f32 v24, v24, v123, v124
  v_max3_f32 v24, v24, v125, v126
  v_max_f32 v24, v24, v127
  s_call_b64 s[64:65], L_rescale
  v_exp_f32 v24, v112
  v_exp_f32 v25, v113
  v_exp_f32 v26, v114
  v_cvt_pk_bf16_f32 v168, v24, v25
  v_exp_f32 v27, v115
  v_exp_f32 v24, v116
  v_cvt_pk_bf16_f32 v169, v26, v27
  v_exp_f32 v25, v117
  v_exp_f32 v26, v118
  v_cvt_pk_bf16_f32 v170, v24, v25
  v_exp_f32 v27, v119
  v_exp_f32 v24, v120
  v_cvt_pk_bf16_f32 v171, v26, v27
  v_exp_f32 v25, v121
  v_exp_f32 v26, v122
  v_cvt_pk_bf16_f32 v172, v24, v25
  v_exp_f32 v27, v123
  v_exp_f32 v24, v124
  v_cvt_pk_bf16_f32 v173, v26, v27
  v_exp_f32 v25, v125
  v_exp_f32 v26, v126
  v_cvt_pk_bf16_f32 v174, v24, v25
  v_exp_f32 v27, v127
  v_or3_b32 v15, v168, v169, v170
  v_cvt_pk_bf16_f32 v175, v26, v27
  s_nop 1
  s_branch L_backv0_5
L_rarev0_6:
  v_max3_f32 v24, v64, v65, v66
  v_max3_f32 v24, v24, v67, v68
  v_max3_f32 v24, v24, v69, v70
  v_max3_f32 v24, v24, v71, v72
  v_max3_f32 v24, v24, v73, v74
  v_max3_f32 v24, v24, v75, v76
  v_max3_f32 v24, v24, v77, v78
  v_max_f32 v24, v24, v79
  s_call_b64 s[64:65], L_rescale
  v_exp_f32 v24, v64
  v_exp_f32 v25, v65
  v_exp_f32 v26, v66
  v_cvt_pk_bf16_f32 v176, v24, v25
  v_exp_f32 v27, v67
  v_exp_f32 v24, v68
  v_cvt_pk_bf16_f32 v177, v26, v27
  v_exp_f32 v25, v69
  v_exp_f32 v26, v70
  v_cvt_pk_bf16_f32 v178, v24, v25
  v_exp_f32 v27, v71
  v_exp_f32 v24, v72
  v_cvt_pk_bf16_f32 v179, v26, v27
  v_exp_f32 v25, v73
  v_exp_f32 v26, v74
  v_cvt_pk_bf16_f32 v180, v24, v25
  v_exp_f32 v27, v75
  v_exp_f32 v24, v76
  v_cvt_pk_bf16_f32 v181, v26, v27
  v_exp_f32 v25, v77
  v_exp_f32 v26, v78
  v_cvt_pk_bf16_f32 v182, v24, v25
  v_exp_f32 v27, v79
  v_or3_b32 v15, v176, v177, v178
  v_cvt_pk_bf16_f32 v183, v26, v27
  s_nop 1
  s_branch L_backv0_6
L_rarev0_7:
  v_max3_f32 v24, v80, v81, v82
  v_max3_f32 v24, v24, v83, v84
  v_max3_f32 v24, v24, v85, v86
  v_max3_f32 v24, v24, v87, v88
  v_max3_f32 v24, v24, v89, v90
  v_max3_f32 v24, v24, v91, v92
  v_max3_f32 v24, v24, v93, v94
  v_max_f32 v24, v24, v95
  s_call_b64 s[64:65], L_rescale
  v_exp_f32 v24, v80
  v_exp_f32 v25, v81
  v_exp_f32 v26, v82
  v_cvt_pk_bf16_f32 v184, v24, v25
  v_exp_f32 v27, v83
  v_exp_f32 v24, v84
  v_cvt_pk_bf16_f32 v185, v26, v27
  v_exp_f32 v25, v85
  v_exp_f32 v26, v86
  v_cvt_pk_bf16_f32 v186, v24, v25
  v_exp_f32 v27, v87
  v_exp_f32 v24, v88
  v_cvt_pk_bf16_f32 v187, v26, v27
  v_exp_f32 v25, v89
  v_exp_f32 v26, v90
  v_cvt_pk_bf16_f32 v188, v24, v25
  v_exp_f32 v27, v91
  v_exp_f32 v24, v92
  v_cvt_pk_bf16_f32 v189, v26, v27
  v_exp_f32 v25, v93
  v_exp_f32 v26, v94
  v_cvt_pk_bf16_f32 v190, v24, v25
  v_exp_f32 v27, v95
  v_or3_b32 v15, v184, v185, v186
  v_cvt_pk_bf16_f32 v191, v26, v27
  s_nop 1
  s_branch L_backv0_7
L_rarev0_8:
  v_max3_f32 v24, v112, v113, v114
  v_max3_f32 v24, v24, v115, v116
  v_max3_f32 v24, v24, v117, v118
  v_max3_f32 v24, v24, v119, v120
  v_max3_f32 v24, v24, v121, v122
  v_max3_f32 v24, v24, v123, v124
  v_max3_f32 v24, v24, v125, v126
  v_max_f32 v24, v24, v127
  s_call_b64 s[64:65], L_rescale
  v_exp_f32 v24, v112
  v_exp_f32 v25, v113
  v_exp_f32 v26, v114
  v_cvt_pk_bf16_f32 v192, v24, v25
  v_exp_f32 v27, v115
  v_exp_f32 v24, v116
  v_cvt_pk_bf16_f32 v193, v26, v27
  v_exp_f32 v25, v117
  v_exp_f32 v26, v118
  v_cvt_pk_bf16_f32 v194, v24, v25
  v_exp_f32 v27, v119
  v_exp_f32 v24, v120
  v_cvt_pk_bf16_f32 v195, v26, v27
  v_exp_f32 v25, v121
  v_exp_f32 v26, v122
  v_cvt_pk_bf16_f32 v196, v24, v25
  v_exp_f32 v27, v123
  v_exp_f32 v24, v124
  v_cvt_pk_bf16_f32 v197, v26, v27
  v_exp_f32 v25, v125
  v_exp_f32 v26, v126
  v_cvt_pk_bf16_f32 v198, v24, v25
  v_exp_f32 v27, v127
  v_or3_b32 v15, v192, v193, v194
  v_cvt_pk_bf16_f32 v199, v26, v27
  s_nop 1
  s_branch L_backv0_8
L_rarev0_9:
  v_max3_f32 v24, v64, v65, v66
  v_max3_f32 v24, v24, v67, v68
  v_max3_f32 v24, v24, v69, v70
  v_max3_f32 v24, v24, v71, v72
  v_max3_f32 v24, v24, v73, v74
  v_max3_f32 v24, v24, v75, v76
  v_max3_f32 v24, v24, v77, v78
  v_max_f32 v24, v24, v79
  s_call_b64 s[64:65], L_rescale
  v_exp_f32 v24, v64
  v_exp_f32 v25, v65
  v_exp_f32 v26, v66
  v_cvt_pk_bf16_f32 v200, v24, v25
  v_exp_f32 v27, v67
  v_exp_f32 v24, v68
  v_cvt_pk_bf16_f32 v201, v26, v27
  v_exp_f32 v25, v69
  v_exp_f32 v26, v70
  v_cvt_pk_bf16_f32 v202, v24, v25
  v_exp_f32 v27, v71
  v_exp_f32 v24, v72
  v_cvt_pk_bf16_f32 v203, v26, v27
  v_exp_f32 v25, v73
  v_exp_f32 v26, v74
  v_cvt_pk_bf16_f32 v204, v24, v25
  v_exp_f32 v27, v75
  v_exp_f32 v24, v76
  v_cvt_pk_bf16_f32 v205, v26, v27
  v_exp_f32 v25, v77
  v_exp_f32 v26, v78
  v_cvt_pk_bf16_f32 v206, v24, v25
  v_exp_f32 v27, v79
  v_or3_b32 v15, v200, v201, v202
  v_cvt_pk_bf16_f32 v207, v26, v27
  s_nop 1
  s_branch L_backv0_9
L_rarev0_10:
  v_max3_f32 v24, v80, v81, v82
  v_max3_f32 v24, v24, v83, v84
  v_max3_f32 v24, v24, v85, v86
  v_max3_f32 v24, v24, v87, v88
  v_max3_f32 v24, v24, v89, v90
  v_max3_f32 v24, v24, v91, v92
  v_max3_f32 v24, v24, v93, v94
  v_max_f32 v24, v24, v95
  s_call_b64 s[64:65], L_rescale
  v_exp_f32 v24, v80
  v_exp_f32 v25, v81
  v_exp_f32 v26, v82
  v_cvt_pk_bf16_f32 v208, v24, v25
  v_exp_f32 v27, v83
  v_exp_f32 v24, v84
  v_cvt_pk_bf16_f32 v209, v26, v27
  v_exp_f32 v25, v85
  v_exp_f32 v26, v86
  v_cvt_pk_bf16_f32 v210, v24, v25
  v_exp_f32 v27, v87
  v_exp_f32 v24, v88
  v_cvt_pk_bf16_f32 v211, v26, v27
  v_exp_f32 v25, v89
  v_exp_f32 v26, v90
  v_cvt_pk_bf16_f32 v212, v24, v25
  v_exp_f32 v27, v91
  v_exp_f32 v24, v92
  v_cvt_pk_bf16_f32 v213, v26, v27
  v_exp_f32 v25, v93
  v_exp_f32 v26, v94
  v_cvt_pk_bf16_f32 v214, v24, v25
  v_exp_f32 v27, v95
  v_or3_b32 v15, v208, v209, v210
  v_cvt_pk_bf16_f32 v215, v26, v27
  s_nop 1
  s_branch L_backv0_10
L_rarev0_11:
  v_max3_f32 v24, v112, v113, v114
  v_max3_f32 v24, v24, v115, v116
  v_max3_f32 v24, v24, v117, v118
  v_max3_f32 v24, v24, v119, v120
  v_max3_f32 v24, v24, v121, v122
  v_max3_f32 v24, v24, v123, v124
  v_max3_f32 v24, v24, v125, v126
  v_max_f32 v24, v24, v127
  s_call_b64 s[64:65], L_rescale
  v_exp_f32 v24, v112
  v_exp_f32 v25, v113
  v_exp_f32 v26, v114
  v_cvt_pk_bf16_f32 v216, v24, v25
  v_exp_f32 v27, v115
  v_exp_f32 v24, v116
  v_cvt_pk_bf16_f32 v217, v26, v27
  v_exp_f32 v25, v117
  v_exp_f32 v26, v118
  v_cvt_pk_bf16_f32 v218, v24, v25
  v_exp_f32 v27, v119
  v_exp_f32 v24, v120
  v_cvt_pk_bf16_f32 v219, v26, v27
  v_exp_f32 v25, v121
  v_exp_f32 v26, v122
  v_cvt_pk_bf16_f32 v220, v24, v25
  v_exp_f32 v27, v123
  v_exp_f32 v24, v124
  v_cvt_pk_bf16_f32 v221, v26, v27
  v_exp_f32 v25, v125
  v_exp_f32 v26, v126
  v_cvt_pk_bf16_f32 v222, v24, v25
  v_exp_f32 v27, v127
  v_or3_b32 v15, v216, v217, v218
  v_cvt_pk_bf16_f32 v223, v26, v27
  s_nop 1
  s_branch L_backv0_11
L_rarev0_12:
  v_max3_f32 v24, v64, v65, v66
  v_max3_f32 v24, v24, v67, v68
  v_max3_f32 v24, v24, v69, v70
  v_max3_f32 v24, v24, v71, v72
  v_max3_f32 v24, v24, v73, v74
  v_max3_f32 v24, v24, v75, v76
  v_max3_f32 v24, v24, v77, v78
  v_max_f32 v24, v24, v79
  s_call_b64 s[64:65], L_rescale
  v_exp_f32 v24, v64
  v_exp_f32 v25, v65
  v_exp_f32 v26, v66
  v_cvt_pk_bf16_f32 v224, v24, v25
  v_exp_f32 v27, v67
  v_exp_f32 v24, v68
  v_cvt_pk_bf16_f32 v225, v26, v27
  v_exp_f32 v25, v69
  v_exp_f32 v26, v70
  v_cvt_pk_bf16_f32 v226, v24, v25
  v_exp_f32 v27, v71
  v_exp_f32 v24, v72
  v_cvt_pk_bf16_f32 v227, v26, v27
  v_exp_f32 v25, v73
  v_exp_f32 v26, v74
  v_cvt_pk_bf16_f32 v228, v24, v25
  v_exp_f32 v27, v75
  v_exp_f32 v24, v76
  v_cvt_pk_bf16_f32 v229, v26, v27
  v_exp_f32 v25, v77
  v_exp_f32 v26, v78
  v_cvt_pk_bf16_f32 v230, v24, v25
  v_exp_f32 v27, v79
  v_or3_b32 v15, v224, v225, v226
  v_cvt_pk_bf16_f32 v231, v26, v27
  s_nop 1
  s_branch L_backv0_12
L_rarev0_13:
  v_max3_f32 v24, v80, v81, v82
  v_max3_f32 v24, v24, v83, v84
  v_max3_f32 v24, v24, v85, v86
  v_max3_f32 v24, v24, v87, v88
  v_max3_f32 v24, v24, v89, v90
  v_max3_f32 v24, v24, v91, v92
  v_max3_f32 v24, v24, v93, v94
  v_max_f32 v24, v24, v95
  s_call_b64 s[64:65], L_rescale
  v_exp_f32 v24, v80
  v_exp_f32 v25, v81
  v_exp_f32 v26, v82
  v_cvt_pk_bf16_f32 v232, v24, v25
  v_exp_f32 v27, v83
  v_exp_f32 v24, v84
  v_cvt_pk_bf16_f32 v233, v26, v27
  v_exp_f32 v25, v85
  v_exp_f32 v26, v86
  v_cvt_pk_bf16_f32 v234, v24, v25
  v_exp_f32 v27, v87
  v_exp_f32 v24, v88
  v_cvt_pk_bf16_f32 v235, v26, v27
  v_exp_f32 v25, v89
  v_exp_f32 v26, v90
  v_cvt_pk_bf16_f32 v236, v24, v25
  v_exp_f32 v27, v91
  v_exp_f32 v24, v92
  v_cvt_pk_bf16_f32 v237, v26, v27
  v_exp_f32 v25, v93
  v_exp_f32 v26, v94
  v_cvt_pk_bf16_f32 v238, v24, v25
  v_exp_f32 v27, v95
  v_or3_b32 v15, v232, v233, v234
  v_cvt_pk_bf16_f32 v239, v26, v27
  s_nop 1
  s_branch L_backv0_13
L_rarev0_14:
  v_max3_f32 v24, v112, v113, v114
  v_max3_f32 v24, v24, v115, v116
  v_max3_f32 v24, v24, v117, v118
  v_max3_f32 v24, v24, v119, v120
  v_max3_f32 v24, v24, v121, v122
  v_max3_f32 v24, v24, v123, v124
  v_max3_f32 v24, v24, v125, v126
  v_max_f32 v24, v24, v127
  s_call_b64 s[64:65], L_rescale
  v_exp_f32 v24, v112
  v_exp_f32 v25, v113
  v_exp_f32 v26, v114
  v_cvt_pk_bf16_f32 v240, v24, v25
  v_exp_f32 v27, v115
  v_exp_f32 v24, v116
  v_cvt_pk_bf16_f32 v241, v26, v27
  v_exp_f32 v25, v117
  v_exp_f32 v26, v118
  v_cvt_pk_bf16_f32 v242, v24, v25
  v_exp_f32 v27, v119
  v_exp_f32 v24, v120
  v_cvt_pk_bf16_f32 v243, v26, v27
  v_exp_f32 v25, v121
  v_exp_f32 v26, v122
  v_cvt_pk_bf16_f32 v244, v24, v25
  v_exp_f32 v27, v123
  v_exp_f32 v24, v124
  v_cvt_pk_bf16_f32 v245, v26, v27
  v_exp_f32 v25, v125
  v_exp_f32 v26, v126
  v_cvt_pk_bf16_f32 v246, v24, v25
  v_exp_f32 v27, v127
  v_or3_b32 v15, v240, v241, v242
  v_cvt_pk_bf16_f32 v247, v26, v27
  s_nop 1
  s_branch L_backv0_14
L_rarev1_1:
  v_max3_f32 v24, v80, v81, v82
  v_max3_f32 v24, v24, v83, v84
  v_max3_f32 v24, v24, v85, v86
  v_max3_f32 v24, v24, v87, v88
  v_max3_f32 v24, v24, v89, v90
  v_max3_f32 v24, v24, v91, v92
  v_max3_f32 v24, v24, v93, v94
  v_max_f32 v24, v24, v95
  s_call_b64 s[64:65], L_rescale
  v_exp_f32 v24, v80
  v_exp_f32 v25, v81
  v_exp_f32 v26, v82
  v_cvt_pk_bf16_f32 v136, v24, v25
  v_exp_f32 v27, v83
  v_exp_f32 v24, v84
  v_cvt_pk_bf16_f32 v137, v26, v27
  v_exp_f32 v25, v85
  v_exp_f32 v26, v86
  v_cvt_pk_bf16_f32 v138, v24, v25
  v_exp_f32 v27, v87
  v_exp_f32 v24, v88
  v_cvt_pk_bf16_f32 v139, v26, v27
  v_exp_f32 v25, v89
  v_exp_f32 v26, v90
  v_cvt_pk_bf16_f32 v140, v24, v25
  v_exp_f32 v27, v91
  v_exp_f32 v24, v92
  v_cvt_pk_bf16_f32 v141, v26, v27
  v_exp_f32 v25, v93
  v_exp_f32 v26, v94
  v_cvt_pk_bf16_f32 v142, v24, v25
  v_exp_f32 v27, v95
  v_or3_b32 v15, v136, v137, v138
  v_cvt_pk_bf16_f32 v143, v26, v27
  s_nop 1
  s_branch L_backv1_1
L_rarev1_2:
  v_max3_f32 v24, v112, v113, v114
  v_max3_f32 v24, v24, v115, v116
  v_max3_f32 v24, v24, v117, v118
  v_max3_f32 v24, v24, v119, v120
  v_max3_f32 v24, v24, v121, v122
  v_max3_f32 v24, v24, v123, v124
  v_max3_f32 v24, v24, v125, v126
  v_max_f32 v24, v24, v127
  s_call_b64 s[64:65], L_rescale
  v_exp_f32 v24, v112
  v_exp_f32 v25, v113
  v_exp_f32 v26, v114
  v_cvt_pk_bf16_f32 v144, v24, v25
  v_exp_f32 v27, v115
  v_exp_f32 v24, v116
  v_cvt_pk_bf16_f32 v145, v26, v27
  v_exp_f32 v25, v117
  v_exp_f32 v26, v118
  v_cvt_pk_bf16_f32 v146, v24, v25
  v_exp_f32 v27, v119
  v_exp_f32 v24, v120
  v_cvt_pk_bf16_f32 v147, v26, v27
  v_exp_f32 v25, v121
  v_exp_f32 v26, v122
  v_cvt_pk_bf16_f32 v148, v24, v25
  v_exp_f32 v27, v123
  v_exp_f32 v24, v124
  v_cvt_pk_bf16_f32 v149, v26, v27
  v_exp_f32 v25, v125
  v_exp_f32 v26, v126
  v_cvt_pk_bf16_f32 v150, v24, v25
  v_exp_f32 v27, v127
  v_or3_b32 v15, v144, v145, v146
  v_cvt_pk_bf16_f32 v151, v26, v27
  s_nop 1
  s_branch L_backv1_2
L_rarev1_3:
  v_max3_f32 v24, v64, v65, v66
  v_max3_f32 v24, v24, v67, v68
  v_max3_f32 v24, v24, v69, v70
  v_max3_f32 v24, v24, v71, v72
  v_max3_f32 v24, v24, v73, v74
  v_max3_f32 v24, v24, v75, v76
  v_max3_f32 v24, v24, v77, v78
  v_max_f32 v24, v24, v79
  s_call_b64 s[64:65], L_rescale
  v_exp_f32 v24, v64
  v_exp_f32 v25, v65
  v_exp_f32 v26, v66
  v_cvt_pk_bf16_f32 v152, v24, v25
  v_exp_f32 v27, v67
  v_exp_f32 v24, v68
  v_cvt_pk_bf16_f32 v153, v26, v27
  v_exp_f32 v25, v69
  v_exp_f32 v26, v70
  v_cvt_pk_bf16_f32 v154, v24, v25
  v_exp_f32 v27, v71
  v_exp_f32 v24, v72
  v_cvt_pk_bf16_f32 v155, v26, v27
  v_exp_f32 v25, v73
  v_exp_f32 v26, v74
  v_cvt_pk_bf16_f32 v156, v24, v25
  v_exp_f32 v27, v75
  v_exp_f32 v24, v76
  v_cvt_pk_bf16_f32 v157, v26, v27
  v_exp_f32 v25, v77
  v_exp_f32 v26, v78
  v_cvt_pk_bf16_f32 v158, v24, v25
  v_exp_f32 v27, v79
  v_or3_b32 v15, v152, v153, v154
  v_cvt_pk_bf16_f32 v159, v26, v27
  s_nop 1
  s_branch L_backv1_3
L_rarev1_4:
  v_max3_f32 v24, v80, v81, v82
  v_max3_f32 v24, v24, v83, v84
  v_max3_f32 v24, v24, v85, v86
  v_max3_f32 v24, v24, v87, v88
  v_max3_f32 v24, v24, v89, v90
  v_max3_f32 v24, v24, v91, v92
  v_max3_f32 v24, v24, v93, v94
  v_max_f32 v24, v24, v95
  s_call_b64 s[64:65], L_rescale
  v_exp_f32 v24, v80
  v_exp_f32 v25, v81
  v_exp_f32 v26, v82
  v_cvt_pk_bf16_f32 v160, v24, v25
  v_exp_f32 v27, v83
  v_exp_f32 v24, v84
  v_cvt_pk_bf16_f32 v161, v26, v27
  v_exp_f32 v25, v85
  v_exp_f32 v26, v86
  v_cvt_pk_bf16_f32 v162, v24, v25
  v_exp_f32 v27, v87
  v_exp_f32 v24, v88
  v_cvt_pk_bf16_f32 v163, v26, v27
  v_exp_f32 v25, v89
  v_exp_f32 v26, v90
  v_cvt_pk_bf16_f32 v164, v24, v25
  v_exp_f32 v27, v91
  v_exp_f32 v24, v92
  v_cvt_pk_bf16_f32 v165, v26, v27
  v_exp_f32 v25, v93
  v_exp_f32 v26, v94
  v_cvt_pk_bf16_f32 v166, v24, v25
  v_exp_f32 v27, v95
  v_or3_b32 v15, v160, v161, v162
  v_cvt_pk_bf16_f32 v167, v26, v27
  s_nop 1
  s_branch L_backv1_4
L_rarev1_5:
  v_max3_f32 v24, v112, v113, v114
  v_max3_f32 v24, v24, v115, v116
  v_max3_f32 v24, v24, v117, v118
  v_max3_f32 v24, v24, v119, v120
  v_max3_f32 v24, v24, v121, v122
  v_max3_f32 v24, v24, v123, v124
  v_max3_f32 v24, v24, v125, v126
  v_max_f32 v24, v24, v127
  s_call_b64 s[64:65], L_rescale
  v_exp_f32 v24, v112
  v_exp_f32 v25, v113
  v_exp_f32 v26, v114
  v_cvt_pk_bf16_f32 v168, v24, v25
  v_exp_f32 v27, v115
  v_exp_f32 v24, v116
  v_cvt_pk_bf16_f32 v169, v26, v27
  v_exp_f32 v25, v117
  v_exp_f32 v26, v118
  v_cvt_pk_bf16_f32 v170, v24, v25
  v_exp_f32 v27, v119
  v_exp_f32 v24, v120
  v_cvt_pk_bf16_f32 v171, v26, v27
  v_exp_f32 v25, v121
  v_exp_f32 v26, v122
  v_cvt_pk_bf16_f32 v172, v24, v25
  v_exp_f32 v27, v123
  v_exp_f32 v24, v124
  v_cvt_pk_bf16_f32 v173, v26, v27
  v_exp_f32 v25, v125
  v_exp_f32 v26, v126
  v_cvt_pk_bf16_f32 v174, v24, v25
  v_exp_f32 v27, v127
  v_or3_b32 v15, v168, v169, v170
  v_cvt_pk_bf16_f32 v175, v26, v27
  s_nop 1
  s_branch L_backv1_5
L_rarev1_6:
  v_max3_f32 v24, v64, v65, v66
  v_max3_f32 v24, v24, v67, v68
  v_max3_f32 v24, v24, v69, v70
  v_max3_f32 v24, v24, v71, v72
  v_max3_f32 v24, v24, v73, v74
  v_max3_f32 v24, v24, v75, v76
  v_max3_f32 v24, v24, v77, v78
  v_max_f32 v24, v24, v79
  s_call_b64 s[64:65], L_rescale
  v_exp_f32 v24, v64
  v_exp_f32 v25, v65
  v_exp_f32 v26, v66
  v_cvt_pk_bf16_f32 v176, v24, v25
  v_exp_f32 v27, v67
  v_exp_f32 v24, v68
  v_cvt_pk_bf16_f32 v177, v26, v27
  v_exp_f32 v25, v69
  v_exp_f32 v26, v70
  v_cvt_pk_bf16_f32 v178, v24, v25
  v_exp_f32 v27, v71
  v_exp_f32 v24, v72
  v_cvt_pk_bf16_f32 v179, v26, v27
  v_exp_f32 v25, v73
  v_exp_f32 v26, v74
  v_cvt_pk_bf16_f32 v180, v24, v25
  v_exp_f32 v27, v75
  v_exp_f32 v24, v76
  v_cvt_pk_bf16_f32 v181, v26, v27
  v_exp_f32 v25, v77
  v_exp_f32 v26, v78
  v_cvt_pk_bf16_f32 v182, v24, v25
  v_exp_f32 v27, v79
  v_or3_b32 v15, v176, v177, v178
  v_cvt_pk_bf16_f32 v183, v26, v27
  s_nop 1
  s_branch L_backv1_6
L_rarev1_7:
  v_max3_f32 v24, v80, v81, v82
  v_max3_f32 v24, v24, v83, v84
  v_max3_f32 v24, v24, v85, v86
  v_max3_f32 v24, v24, v87, v88
  v_max3_f32 v24, v24, v89, v90
  v_max3_f32 v24, v24, v91, v92
  v_max3_f32 v24, v24, v93, v94
  v_max_f32 v24, v24, v95
  s_call_b64 s[64:65], L_rescale
  v_exp_f32 v24, v80
  v_exp_f32 v25, v81
  v_exp_f32 v26, v82
  v_cvt_pk_bf16_f32 v184, v24, v25
  v_exp_f32 v27, v83
  v_exp_f32 v24, v84
  v_cvt_pk_bf16_f32 v185, v26, v27
  v_exp_f32 v25, v85
  v_exp_f32 v26, v86
  v_cvt_pk_bf16_f32 v186, v24, v25
  v_exp_f32 v27, v87
  v_exp_f32 v24, v88
  v_cvt_pk_bf16_f32 v187, v26, v27
  v_exp_f32 v25, v89
  v_exp_f32 v26, v90
  v_cvt_pk_bf16_f32 v188, v24, v25
  v_exp_f32 v27, v91
  v_exp_f32 v24, v92
  v_cvt_pk_bf16_f32 v189, v26, v27
  v_exp_f32 v25, v93
  v_exp_f32 v26, v94
  v_cvt_pk_bf16_f32 v190, v24, v25
  v_exp_f32 v27, v95
  v_or3_b32 v15, v184, v185, v186
  v_cvt_pk_bf16_f32 v191, v26, v27
  s_nop 1
  s_branch L_backv1_7
L_rarev1_8:
  v_max3_f32 v24, v112, v113, v114
  v_max3_f32 v24, v24, v115, v116
  v_max3_f32 v24, v24, v117, v118
  v_max3_f32 v24, v24, v119, v120
  v_max3_f32 v24, v24, v121, v122
  v_max3_f32 v24, v24, v123, v124
  v_max3_f32 v24, v24, v125, v126
  v_max_f32 v24, v24, v127
  s_call_b64 s[64:65], L_rescale
  v_exp_f32 v24, v112
  v_exp_f32 v25, v113
  v_exp_f32 v26, v114
  v_cvt_pk_bf16_f32 v192, v24, v25
  v_exp_f32 v27, v115
  v_exp_f32 v24, v116
  v_cvt_pk_bf16_f32 v193, v26, v27
  v_exp_f32 v25, v117
  v_exp_f32 v26, v118
  v_cvt_pk_bf16_f32 v194, v24, v25
  v_exp_f32 v27, v119
  v_exp_f32 v24, v120
  v_cvt_pk_bf16_f32 v195, v26, v27
  v_exp_f32 v25, v121
  v_exp_f32 v26, v122
  v_cvt_pk_bf16_f32 v196, v24, v25
  v_exp_f32 v27, v123
  v_exp_f32 v24, v124
  v_cvt_pk_bf16_f32 v197, v26, v27
  v_exp_f32 v25, v125
  v_exp_f32 v26, v126
  v_cvt_pk_bf16_f32 v198, v24, v25
  v_exp_f32 v27, v127
  v_or3_b32 v15, v192, v193, v194
  v_cvt_pk_bf16_f32 v199, v26, v27
  s_nop 1
  s_branch L_backv1_8
L_rarev1_9:
  v_max3_f32 v24, v64, v65, v66
  v_max3_f32 v24, v24, v67, v68
  v_max3_f32 v24, v24, v69, v70
  v_max3_f32 v24, v24, v71, v72
  v_max3_f32 v24, v24, v73, v74
  v_max3_f32 v24, v24, v75, v76
  v_max3_f32 v24, v24, v77, v78
  v_max_f32 v24, v24, v79
  s_call_b64 s[64:65], L_rescale
  v_exp_f32 v24, v64
  v_exp_f32 v25, v65
  v_exp_f32 v26, v66
  v_cvt_pk_bf16_f32 v200, v24, v25
  v_exp_f32 v27, v67
  v_exp_f32 v24, v68
  v_cvt_pk_bf16_f32 v201, v26, v27
  v_exp_f32 v25, v69
  v_exp_f32 v26, v70
  v_cvt_pk_bf16_f32 v202, v24, v25
  v_exp_f32 v27, v71
  v_exp_f32 v24, v72
  v_cvt_pk_bf16_f32 v203, v26, v27
  v_exp_f32 v25, v73
  v_exp_f32 v26, v74
  v_cvt_pk_bf16_f32 v204, v24, v25
  v_exp_f32 v27, v75
  v_exp_f32 v24, v76
  v_cvt_pk_bf16_f32 v205, v26, v27
  v_exp_f32 v25, v77
  v_exp_f32 v26, v78
  v_cvt_pk_bf16_f32 v206, v24, v25
  v_exp_f32 v27, v79
  v_or3_b32 v15, v200, v201, v202
  v_cvt_pk_bf16_f32 v207, v26, v27
  s_nop 1
  s_branch L_backv1_9
L_rarev1_10:
  v_max3_f32 v24, v80, v81, v82
  v_max3_f32 v24, v24, v83, v84
  v_max3_f32 v24, v24, v85, v86
  v_max3_f32 v24, v24, v87, v88
  v_max3_f32 v24, v24, v89, v90
  v_max3_f32 v24, v24, v91, v92
  v_max3_f32 v24, v24, v93, v94
  v_max_f32 v24, v24, v95
  s_call_b64 s[64:65], L_rescale
  v_exp_f32 v24, v80
  v_exp_f32 v25, v81
  v_exp_f32 v26, v82
  v_cvt_pk_bf16_f32 v208, v24, v25
  v_exp_f32 v27, v83
  v_exp_f32 v24, v84
  v_cvt_pk_bf16_f32 v209, v26, v27
  v_exp_f32 v25, v85
  v_exp_f32 v26, v86
  v_cvt_pk_bf16_f32 v210, v24, v25
  v_exp_f32 v27, v87
  v_exp_f32 v24, v88
  v_cvt_pk_bf16_f32 v211, v26, v27
  v_exp_f32 v25, v89
  v_exp_f32 v26, v90
  v_cvt_pk_bf16_f32 v212, v24, v25
  v_exp_f32 v27, v91
  v_exp_f32 v24, v92
  v_cvt_pk_bf16_f32 v213, v26, v27
  v_exp_f32 v25, v93
  v_exp_f32 v26, v94
  v_cvt_pk_bf16_f32 v214, v24, v25
  v_exp_f32 v27, v95
  v_or3_b32 v15, v208, v209, v210
  v_cvt_pk_bf16_f32 v215, v26, v27
  s_nop 1
  s_branch L_backv1_10
L_rarev1_11:
  v_max3_f32 v24, v112, v113, v114
  v_max3_f32 v24, v24, v115, v116
  v_max3_f32 v24, v24, v117, v118
  v_max3_f32 v24, v24, v119, v120
  v_max3_f32 v24, v24, v121, v122
  v_max3_f32 v24, v24, v123, v124
  v_max3_f32 v24, v24, v125, v126
  v_max_f32 v24, v24, v127
  s_call_b64 s[64:65], L_rescale
  v_exp_f32 v24, v112
  v_exp_f32 v25, v113
  v_exp_f32 v26, v114
  v_cvt_pk_bf16_f32 v216, v24, v25
  v_exp_f32 v27, v115
  v_exp_f32 v24, v116
  v_cvt_pk_bf16_f32 v217, v26, v27
  v_exp_f32 v25, v117
  v_exp_f32 v26, v118
  v_cvt_pk_bf16_f32 v218, v24, v25
  v_exp_f32 v27, v119
  v_exp_f32 v24, v120
  v_cvt_pk_bf16_f32 v219, v26, v27
  v_exp_f32 v25, v121
  v_exp_f32 v26, v122
  v_cvt_pk_bf16_f32 v220, v24, v25
  v_exp_f32 v27, v123
  v_exp_f32 v24, v124
  v_cvt_pk_bf16_f32 v221, v26, v27
  v_exp_f32 v25, v125
  v_exp_f32 v26, v126
  v_cvt_pk_bf16_f32 v222, v24, v25
  v_exp_f32 v27, v127
  v_or3_b32 v15, v216, v217, v218
  v_cvt_pk_bf16_f32 v223, v26, v27
  s_nop 1
  s_branch L_backv1_11
L_rarev1_12:
  v_max3_f32 v24, v64, v65, v66
  v_max3_f32 v24, v24, v67, v68
  v_max3_f32 v24, v24, v69, v70
  v_max3_f32 v24, v24, v71, v72
  v_max3_f32 v24, v24, v73, v74
  v_max3_f32 v24, v24, v75, v76
  v_max3_f32 v24, v24, v77, v78
  v_max_f32 v24, v24, v79
  s_call_b64 s[64:65], L_rescale
  v_exp_f32 v24, v64
  v_exp_f32 v25, v65
  v_exp_f32 v26, v66
  v_cvt_pk_bf16_f32 v224, v24, v25
  v_exp_f32 v27, v67
  v_exp_f32 v24, v68
  v_cvt_pk_bf16_f32 v225, v26, v27
  v_exp_f32 v25, v69
  v_exp_f32 v26, v70
  v_cvt_pk_bf16_f32 v226, v24, v25
  v_exp_f32 v27, v71
  v_exp_f32 v24, v72
  v_cvt_pk_bf16_f32 v227, v26, v27
  v_exp_f32 v25, v73
  v_exp_f32 v26, v74
  v_cvt_pk_bf16_f32 v228, v24, v25
  v_exp_f32 v27, v75
  v_exp_f32 v24, v76
  v_cvt_pk_bf16_f32 v229, v26, v27
  v_exp_f32 v25, v77
  v_exp_f32 v26, v78
  v_cvt_pk_bf16_f32 v230, v24, v25
  v_exp_f32 v27, v79
  v_or3_b32 v15, v224, v225, v226
  v_cvt_pk_bf16_f32 v231, v26, v27
  s_nop 1
  s_branch L_backv1_12
L_rarev1_13:
  v_max3_f32 v24, v80, v81, v82
  v_max3_f32 v24, v24, v83, v84
  v_max3_f32 v24, v24, v85, v86
  v_max3_f32 v24, v24, v87, v88
  v_max3_f32 v24, v24, v89, v90
  v_max3_f32 v24, v24, v91, v92
  v_max3_f32 v24, v24, v93, v94
  v_max_f32 v24, v24, v95
  s_call_b64 s[64:65], L_rescale
  v_exp_f32 v24, v80
  v_exp_f32 v25, v81
  v_exp_f32 v26, v82
  v_cvt_pk_bf16_f32 v232, v24, v25
  v_exp_f32 v27, v83
  v_exp_f32 v24, v84
  v_cvt_pk_bf16_f32 v233, v26, v27
  v_exp_f32 v25, v85
  v_exp_f32 v26, v86
  v_cvt_pk_bf16_f32 v234, v24, v25
  v_exp_f32 v27, v87
  v_exp_f32 v24, v88
  v_cvt_pk_bf16_f32 v235, v26, v27
  v_exp_f32 v25, v89
  v_exp_f32 v26, v90
  v_cvt_pk_bf16_f32 v236, v24, v25
  v_exp_f32 v27, v91
  v_exp_f32 v24, v92
  v_cvt_pk_bf16_f32 v237, v26, v27
  v_exp_f32 v25, v93
  v_exp_f32 v26, v94
  v_cvt_pk_bf16_f32 v238, v24, v25
  v_exp_f32 v27, v95
  v_or3_b32 v15, v232, v233, v234
  v_cvt_pk_bf16_f32 v239, v26, v27
  s_nop 1
  s_branch L_backv1_13
L_rarev1_14:
  v_max3_f32 v24, v112, v113, v114
  v_max3_f32 v24, v24, v115, v116
  v_max3_f32 v24, v24, v117, v118
  v_max3_f32 v24, v24, v119, v120
  v_max3_f32 v24, v24, v121, v122
  v_max3_f32 v24, v24, v123, v124
  v_max3_f32 v24, v24, v125, v126
  v_max_f32 v24, v24, v127
  s_call_b64 s[64:65], L_rescale
  v_exp_f32 v24, v112
  v_exp_f32 v25, v113
  v_exp_f32 v26, v114
  v_cvt_pk_bf16_f32 v240, v24, v25
  v_exp_f32 v27, v115
  v_exp_f32 v24, v116
  v_cvt_pk_bf16_f32 v241, v26, v27
  v_exp_f32 v25, v117
  v_exp_f32 v26, v118
  v_cvt_pk_bf16_f32 v242, v24, v25
  v_exp_f32 v27, v119
  v_exp_f32 v24, v120
  v_cvt_pk_bf16_f32 v243, v26, v27
  v_exp_f32 v25, v121
  v_exp_f32 v26, v122
  v_cvt_pk_bf16_f32 v244, v24, v25
  v_exp_f32 v27, v123
  v_exp_f32 v24, v124
  v_cvt_pk_bf16_f32 v245, v26, v27
  v_exp_f32 v25, v125
  v_exp_f32 v26, v126
  v_cvt_pk_bf16_f32 v246, v24, v25
  v_exp_f32 v27, v127
  v_or3_b32 v15, v240, v241, v242
  v_cvt_pk_bf16_f32 v247, v26, v27
  s_nop 1
  s_branch L_backv1_14
L_rarec_15:
  v_max3_f32 v24, v64, v65, v66
  v_max3_f32 v24, v24, v67, v68
  v_max3_f32 v24, v24, v69, v70
  v_max3_f32 v24, v24, v71, v72
  v_max3_f32 v24, v24, v73, v74
  v_max3_f32 v24, v24, v75, v76
  v_max3_f32 v24, v24, v77, v78
  v_max_f32 v24, v24, v79
  s_call_b64 s[64:65], L_rescale15
  v_exp_f32 v24, v64
  v_exp_f32 v25, v65
  v_exp_f32 v26, v66
  v_cvt_pk_bf16_f32 v248, v24, v25
  v_exp_f32 v27, v67
  v_exp_f32 v24, v68
  v_cvt_pk_bf16_f32 v249, v26, v27
  v_exp_f32 v25, v69
  v_exp_f32 v26, v70
  v_cvt_pk_bf16_f32 v250, v24, v25
  v_exp_f32 v27, v71
  v_exp_f32 v24, v72
  v_cvt_pk_bf16_f32 v251, v26, v27
  v_exp_f32 v25, v73
  v_exp_f32 v26, v74
  v_cvt_pk_bf16_f32 v252, v24, v25
  v_exp_f32 v27, v75
  v_exp_f32 v24, v76
  v_cvt_pk_bf16_f32 v253, v26, v27
  v_exp_f32 v25, v77
  v_exp_f32 v26, v78
  v_cvt_pk_bf16_f32 v254, v24, v25
  v_exp_f32 v27, v79
  v_or3_b32 v15, v248, v249, v250
  v_cvt_pk_bf16_f32 v255, v26, v27
  s_nop 1
  s_branch L_backc_15
L_rescale:
  s_nop 15
  s_nop 15
  v_mov_b32 v25, v24
  s_nop 1
  v_permlane32_swap_b32 v24, v25
  s_nop 1
  v_max_f32 v24, v24, v25
  v_add_f32 v24, 0x41a00000, v24
  v_ceil_f32 v24, v24
  v_max_f32 v24, 0, v24
  v_min_f32 v25, 0x43800000, v24
  v_cvt_i32_f32 v25, v25
  v_sub_u32 v25, 0, v25
  v_sub_f32 v64, v64, v24
  v_sub_f32 v65, v65, v24
  v_sub_f32 v66, v66, v24
  v_sub_f32 v67, v67, v24
  v_sub_f32 v68, v68, v24
  v_sub_f32 v69, v69, v24
  v_sub_f32 v70, v70, v24
  v_sub_f32 v71, v71, v24
  v_sub_f32 v72, v72, v24
  v_sub_f32 v73, v73, v24
  v_sub_f32 v74, v74, v24
  v_sub_f32 v75, v75, v24
  v_sub_f32 v76, v76, v24
  v_sub_f32 v77, v77, v24
  v_sub_f32 v78, v78, v24
  v_sub_f32 v79, v79, v24
  v_sub_f32 v80, v80, v24
  v_sub_f32 v81, v81, v24
  v_sub_f32 v82, v82, v24
  v_sub_f32 v83, v83, v24
  v_sub_f32 v84, v84, v24
  v_sub_f32 v85, v85, v24
  v_sub_f32 v86, v86, v24
  v_sub_f32 v87, v87, v24
  v_sub_f32 v88, v88, v24
  v_sub_f32 v89, v89, v24
  v_sub_f32 v90, v90, v24
  v_sub_f32 v91, v91, v24
  v_sub_f32 v92, v92, v24
  v_sub_f32 v93, v93, v24
  v_sub_f32 v94, v94, v24
  v_sub_f32 v95, v95, v24
  v_sub_f32 v96, v96, v24
  v_sub_f32 v97, v97, v24
  v_sub_f32 v98, v98, v24
  v_sub_f32 v99, v99, v24
  v_sub_f32 v100, v100, v24
  v_sub_f32 v101, v101, v24
  v_sub_f32 v102, v102, v24
  v_sub_f32 v103, v103, v24
  v_sub_f32 v104, v104, v24
  v_sub_f32 v105, v105, v24
  v_sub_f32 v106, v106, v24
  v_sub_f32 v107, v107, v24
  v_sub_f32 v108, v108, v24
  v_sub_f32 v109, v109, v24
  v_sub_f32 v110, v110, v24
  v_sub_f32 v111, v111, v24
  v_sub_f32 v112, v112, v24
  v_sub_f32 v113, v113, v24
  v_sub_f32 v114, v114, v24
  v_sub_f32 v115, v115, v24
  v_sub_f32 v116, v116, v24
  v_sub_f32 v117, v117, v24
  v_sub_f32 v118, v118, v24
  v_sub_f32 v119, v119, v24
  v_sub_f32 v120, v120, v24
  v_sub_f32 v121, v121, v24
  v_sub_f32 v122, v122, v24
  v_sub_f32 v123, v123, v24
  v_sub_f32 v124, v124, v24
  v_sub_f32 v125, v125, v24
  v_sub_f32 v126, v126, v24
  v_sub_f32 v127, v127, v24
  s_branch L_rescaleP
L_rescale15:
  s_nop 15
  s_nop 15
  v_mov_b32 v25, v24
  s_nop 1
  v_permlane32_swap_b32 v24, v25
  s_nop 1
  v_max_f32 v24, v24, v25
  v_add_f32 v24, 0x41a00000, v24
  v_ceil_f32 v24, v24
  v_max_f32 v24, 0, v24
  v_min_f32 v25, 0x43800000, v24
  v_cvt_i32_f32 v25, v25
  v_sub_u32 v25, 0, v25
  v_sub_f32 v64, v64, v24
  v_sub_f32 v65, v65, v24
  v_sub_f32 v66, v66, v24
  v_sub_f32 v67, v67, v24
  v_sub_f32 v68, v68, v24
  v_sub_f32 v69, v69, v24
  v_sub_f32 v70, v70, v24
  v_sub_f32 v71, v71, v24
  v_sub_f32 v72, v72, v24
  v_sub_f32 v73, v73, v24
  v_sub_f32 v74, v74, v24
  v_sub_f32 v75, v75, v24
  v_sub_f32 v76, v76, v24
  v_sub_f32 v77, v77, v24
  v_sub_f32 v78, v78, v24
  v_sub_f32 v79, v79, v24
  v_ldexp_f32 v32, v32, v25
  v_ldexp_f32 v33, v33, v25
  v_ldexp_f32 v34, v34, v25
  v_ldexp_f32 v35, v35, v25
  v_ldexp_f32 v36, v36, v25
  v_ldexp_f32 v37, v37, v25
  v_ldexp_f32 v38, v38, v25
  v_ldexp_f32 v39, v39, v25
  v_ldexp_f32 v40, v40, v25
  v_ldexp_f32 v41, v41, v25
  v_ldexp_f32 v42, v42, v25
  v_ldexp_f32 v43, v43, v25
  v_ldexp_f32 v44, v44, v25
  v_ldexp_f32 v45, v45, v25
  v_ldexp_f32 v46, v46, v25
  v_ldexp_f32 v47, v47, v25
  v_ldexp_f32 v48, v48, v25
  v_ldexp_f32 v49, v49, v25
  v_ldexp_f32 v50, v50, v25
  v_ldexp_f32 v51, v51, v25
  v_ldexp_f32 v52, v52, v25
  v_ldexp_f32 v53, v53, v25
  v_ldexp_f32 v54, v54, v25
  v_ldexp_f32 v55, v55, v25
  v_ldexp_f32 v56, v56, v25
  v_ldexp_f32 v57, v57, v25
  v_ldexp_f32 v58, v58, v25
  v_ldexp_f32 v59, v59, v25
  v_ldexp_f32 v60, v60, v25
  v_ldexp_f32 v61, v61, v25
  v_ldexp_f32 v62, v62, v25
  v_ldexp_f32 v63, v63, v25
  v_ldexp_f32 v112, v112, v25
  v_ldexp_f32 v113, v113, v25
  v_ldexp_f32 v114, v114, v25
  v_ldexp_f32 v115, v115, v25
L_rescaleP:
  v_lshlrev_b32 v26, 16, v128
  v_and_b32 v27, 0xffff0000, v128
  v_ldexp_f32 v26, v26, v25
  v_ldexp_f32 v27, v27, v25
  v_cvt_pk_bf16_f32 v128, v26, v27
  v_lshlrev_b32 v26, 16, v129
  v_and_b32 v27, 0xffff0000, v129
  v_ldexp_f32 v26, v26, v25
  v_ldexp_f32 v27, v27, v25
  v_cvt_pk_bf16_f32 v129, v26, v27
  v_lshlrev_b32 v26, 16, v130
  v_and_b32 v27, 0xffff0000, v130
  v_ldexp_f32 v26, v26, v25
  v_ldexp_f32 v27, v27, v25
  v_cvt_pk_bf16_f32 v130, v26, v27
  v_lshlrev_b32 v26, 16, v131
  v_and_b32 v27, 0xffff0000, v131
  v_ldexp_f32 v26, v26, v25
  v_ldexp_f32 v27, v27, v25
  v_cvt_pk_bf16_f32 v131, v26, v27
  v_lshlrev_b32 v26, 16, v132
  v_and_b32 v27, 0xffff0000, v132
  v_ldexp_f32 v26, v26, v25
  v_ldexp_f32 v27, v27, v25
  v_cvt_pk_bf16_f32 v132, v26, v27
  v_lshlrev_b32 v26, 16, v133
  v_and_b32 v27, 0xffff0000, v133
  v_ldexp_f32 v26, v26, v25
  v_ldexp_f32 v27, v27, v25
  v_cvt_pk_bf16_f32 v133, v26, v27
  v_lshlrev_b32 v26, 16, v134
  v_and_b32 v27, 0xffff0000, v134
  v_ldexp_f32 v26, v26, v25
  v_ldexp_f32 v27, v27, v25
  v_cvt_pk_bf16_f32 v134, v26, v27
  v_lshlrev_b32 v26, 16, v135
  v_and_b32 v27, 0xffff0000, v135
  v_ldexp_f32 v26, v26, v25
  v_ldexp_f32 v27, v27, v25
  v_cvt_pk_bf16_f32 v135, v26, v27
  v_lshlrev_b32 v26, 16, v136
  v_and_b32 v27, 0xffff0000, v136
  v_ldexp_f32 v26, v26, v25
  v_ldexp_f32 v27, v27, v25
  v_cvt_pk_bf16_f32 v136, v26, v27
  v_lshlrev_b32 v26, 16, v137
  v_and_b32 v27, 0xffff0000, v137
  v_ldexp_f32 v26, v26, v25
  v_ldexp_f32 v27, v27, v25
  v_cvt_pk_bf16_f32 v137, v26, v27
  v_lshlrev_b32 v26, 16, v138
  v_and_b32 v27, 0xffff0000, v138
  v_ldexp_f32 v26, v26, v25
  v_ldexp_f32 v27, v27, v25
  v_cvt_pk_bf16_f32 v138, v26, v27
  v_lshlrev_b32 v26, 16, v139
  v_and_b32 v27, 0xffff0000, v139
  v_ldexp_f32 v26, v26, v25
  v_ldexp_f32 v27, v27, v25
  v_cvt_pk_bf16_f32 v139, v26, v27
  v_lshlrev_b32 v26, 16, v140
  v_and_b32 v27, 0xffff0000, v140
  v_ldexp_f32 v26, v26, v25
  v_ldexp_f32 v27, v27, v25
  v_cvt_pk_bf16_f32 v140, v26, v27
  v_lshlrev_b32 v26, 16, v141
  v_and_b32 v27, 0xffff0000, v141
  v_ldexp_f32 v26, v26, v25
  v_ldexp_f32 v27, v27, v25
  v_cvt_pk_bf16_f32 v141, v26, v27
  v_lshlrev_b32 v26, 16, v142
  v_and_b32 v27, 0xffff0000, v142
  v_ldexp_f32 v26, v26, v25
  v_ldexp_f32 v27, v27, v25
  v_cvt_pk_bf16_f32 v142, v26, v27
  v_lshlrev_b32 v26, 16, v143
  v_and_b32 v27, 0xffff0000, v143
  v_ldexp_f32 v26, v26, v25
  v_ldexp_f32 v27, v27, v25
  v_cvt_pk_bf16_f32 v143, v26, v27
  v_lshlrev_b32 v26, 16, v144
  v_and_b32 v27, 0xffff0000, v144
  v_ldexp_f32 v26, v26, v25
  v_ldexp_f32 v27, v27, v25
  v_cvt_pk_bf16_f32 v144, v26, v27
  v_lshlrev_b32 v26, 16, v145
  v_and_b32 v27, 0xffff0000, v145
  v_ldexp_f32 v26, v26, v25
  v_ldexp_f32 v27, v27, v25
  v_cvt_pk_bf16_f32 v145, v26, v27
  v_lshlrev_b32 v26, 16, v146
  v_and_b32 v27, 0xffff0000, v146
  v_ldexp_f32 v26, v26, v25
  v_ldexp_f32 v27, v27, v25
  v_cvt_pk_bf16_f32 v146, v26, v27
  v_lshlrev_b32 v26, 16, v147
  v_and_b32 v27, 0xffff0000, v147
  v_ldexp_f32 v26, v26, v25
  v_ldexp_f32 v27, v27, v25
  v_cvt_pk_bf16_f32 v147, v26, v27
  v_lshlrev_b32 v26, 16, v148
  v_and_b32 v27, 0xffff0000, v148
  v_ldexp_f32 v26, v26, v25
  v_ldexp_f32 v27, v27, v25
  v_cvt_pk_bf16_f32 v148, v26, v27
  v_lshlrev_b32 v26, 16, v149
  v_and_b32 v27, 0xffff0000, v149
  v_ldexp_f32 v26, v26, v25
  v_ldexp_f32 v27, v27, v25
  v_cvt_pk_bf16_f32 v149, v26, v27
  v_lshlrev_b32 v26, 16, v150
  v_and_b32 v27, 0xffff0000, v150
  v_ldexp_f32 v26, v26, v25
  v_ldexp_f32 v27, v27, v25
  v_cvt_pk_bf16_f32 v150, v26, v27
  v_lshlrev_b32 v26, 16, v151
  v_and_b32 v27, 0xffff0000, v151
  v_ldexp_f32 v26, v26, v25
  v_ldexp_f32 v27, v27, v25
  v_cvt_pk_bf16_f32 v151, v26, v27
  v_lshlrev_b32 v26, 16, v152
  v_and_b32 v27, 0xffff0000, v152
  v_ldexp_f32 v26, v26, v25
  v_ldexp_f32 v27, v27, v25
  v_cvt_pk_bf16_f32 v152, v26, v27
  v_lshlrev_b32 v26, 16, v153
  v_and_b32 v27, 0xffff0000, v153
  v_ldexp_f32 v26, v26, v25
  v_ldexp_f32 v27, v27, v25
  v_cvt_pk_bf16_f32 v153, v26, v27
  v_lshlrev_b32 v26, 16, v154
  v_and_b32 v27, 0xffff0000, v154
  v_ldexp_f32 v26, v26, v25
  v_ldexp_f32 v27, v27, v25
  v_cvt_pk_bf16_f32 v154, v26, v27
  v_lshlrev_b32 v26, 16, v155
  v_and_b32 v27, 0xffff0000, v155
  v_ldexp_f32 v26, v26, v25
  v_ldexp_f32 v27, v27, v25
  v_cvt_pk_bf16_f32 v155, v26, v27
  v_lshlrev_b32 v26, 16, v156
  v_and_b32 v27, 0xffff0000, v156
  v_ldexp_f32 v26, v26, v25
  v_ldexp_f32 v27, v27, v25
  v_cvt_pk_bf16_f32 v156, v26, v27
  v_lshlrev_b32 v26, 16, v157
  v_and_b32 v27, 0xffff0000, v157
  v_ldexp_f32 v26, v26, v25
  v_ldexp_f32 v27, v27, v25
  v_cvt_pk_bf16_f32 v157, v26, v27
  v_lshlrev_b32 v26, 16, v158
  v_and_b32 v27, 0xffff0000, v158
  v_ldexp_f32 v26, v26, v25
  v_ldexp_f32 v27, v27, v25
  v_cvt_pk_bf16_f32 v158, v26, v27
  v_lshlrev_b32 v26, 16, v159
  v_and_b32 v27, 0xffff0000, v159
  v_ldexp_f32 v26, v26, v25
  v_ldexp_f32 v27, v27, v25
  v_cvt_pk_bf16_f32 v159, v26, v27
  v_lshlrev_b32 v26, 16, v160
  v_and_b32 v27, 0xffff0000, v160
  v_ldexp_f32 v26, v26, v25
  v_ldexp_f32 v27, v27, v25
  v_cvt_pk_bf16_f32 v160, v26, v27
  v_lshlrev_b32 v26, 16, v161
  v_and_b32 v27, 0xffff0000, v161
  v_ldexp_f32 v26, v26, v25
  v_ldexp_f32 v27, v27, v25
  v_cvt_pk_bf16_f32 v161, v26, v27
  v_lshlrev_b32 v26, 16, v162
  v_and_b32 v27, 0xffff0000, v162
  v_ldexp_f32 v26, v26, v25
  v_ldexp_f32 v27, v27, v25
  v_cvt_pk_bf16_f32 v162, v26, v27
  v_lshlrev_b32 v26, 16, v163
  v_and_b32 v27, 0xffff0000, v163
  v_ldexp_f32 v26, v26, v25
  v_ldexp_f32 v27, v27, v25
  v_cvt_pk_bf16_f32 v163, v26, v27
  v_lshlrev_b32 v26, 16, v164
  v_and_b32 v27, 0xffff0000, v164
  v_ldexp_f32 v26, v26, v25
  v_ldexp_f32 v27, v27, v25
  v_cvt_pk_bf16_f32 v164, v26, v27
  v_lshlrev_b32 v26, 16, v165
  v_and_b32 v27, 0xffff0000, v165
  v_ldexp_f32 v26, v26, v25
  v_ldexp_f32 v27, v27, v25
  v_cvt_pk_bf16_f32 v165, v26, v27
  v_lshlrev_b32 v26, 16, v166
  v_and_b32 v27, 0xffff0000, v166
  v_ldexp_f32 v26, v26, v25
  v_ldexp_f32 v27, v27, v25
  v_cvt_pk_bf16_f32 v166, v26, v27
  v_lshlrev_b32 v26, 16, v167
  v_and_b32 v27, 0xffff0000, v167
  v_ldexp_f32 v26, v26, v25
  v_ldexp_f32 v27, v27, v25
  v_cvt_pk_bf16_f32 v167, v26, v27
  v_lshlrev_b32 v26, 16, v168
  v_and_b32 v27, 0xffff0000, v168
  v_ldexp_f32 v26, v26, v25
  v_ldexp_f32 v27, v27, v25
  v_cvt_pk_bf16_f32 v168, v26, v27
  v_lshlrev_b32 v26, 16, v169
  v_and_b32 v27, 0xffff0000, v169
  v_ldexp_f32 v26, v26, v25
  v_ldexp_f32 v27, v27, v25
  v_cvt_pk_bf16_f32 v169, v26, v27
  v_lshlrev_b32 v26, 16, v170
  v_and_b32 v27, 0xffff0000, v170
  v_ldexp_f32 v26, v26, v25
  v_ldexp_f32 v27, v27, v25
  v_cvt_pk_bf16_f32 v170, v26, v27
  v_lshlrev_b32 v26, 16, v171
  v_and_b32 v27, 0xffff0000, v171
  v_ldexp_f32 v26, v26, v25
  v_ldexp_f32 v27, v27, v25
  v_cvt_pk_bf16_f32 v171, v26, v27
  v_lshlrev_b32 v26, 16, v172
  v_and_b32 v27, 0xffff0000, v172
  v_ldexp_f32 v26, v26, v25
  v_ldexp_f32 v27, v27, v25
  v_cvt_pk_bf16_f32 v172, v26, v27
  v_lshlrev_b32 v26, 16, v173
  v_and_b32 v27, 0xffff0000, v173
  v_ldexp_f32 v26, v26, v25
  v_ldexp_f32 v27, v27, v25
  v_cvt_pk_bf16_f32 v173, v26, v27
  v_lshlrev_b32 v26, 16, v174
  v_and_b32 v27, 0xffff0000, v174
  v_ldexp_f32 v26, v26, v25
  v_ldexp_f32 v27, v27, v25
  v_cvt_pk_bf16_f32 v174, v26, v27
  v_lshlrev_b32 v26, 16, v175
  v_and_b32 v27, 0xffff0000, v175
  v_ldexp_f32 v26, v26, v25
  v_ldexp_f32 v27, v27, v25
  v_cvt_pk_bf16_f32 v175, v26, v27
  v_lshlrev_b32 v26, 16, v176
  v_and_b32 v27, 0xffff0000, v176
  v_ldexp_f32 v26, v26, v25
  v_ldexp_f32 v27, v27, v25
  v_cvt_pk_bf16_f32 v176, v26, v27
  v_lshlrev_b32 v26, 16, v177
  v_and_b32 v27, 0xffff0000, v177
  v_ldexp_f32 v26, v26, v25
  v_ldexp_f32 v27, v27, v25
  v_cvt_pk_bf16_f32 v177, v26, v27
  v_lshlrev_b32 v26, 16, v178
  v_and_b32 v27, 0xffff0000, v178
  v_ldexp_f32 v26, v26, v25
  v_ldexp_f32 v27, v27, v25
  v_cvt_pk_bf16_f32 v178, v26, v27
  v_lshlrev_b32 v26, 16, v179
  v_and_b32 v27, 0xffff0000, v179
  v_ldexp_f32 v26, v26, v25
  v_ldexp_f32 v27, v27, v25
  v_cvt_pk_bf16_f32 v179, v26, v27
  v_lshlrev_b32 v26, 16, v180
  v_and_b32 v27, 0xffff0000, v180
  v_ldexp_f32 v26, v26, v25
  v_ldexp_f32 v27, v27, v25
  v_cvt_pk_bf16_f32 v180, v26, v27
  v_lshlrev_b32 v26, 16, v181
  v_and_b32 v27, 0xffff0000, v181
  v_ldexp_f32 v26, v26, v25
  v_ldexp_f32 v27, v27, v25
  v_cvt_pk_bf16_f32 v181, v26, v27
  v_lshlrev_b32 v26, 16, v182
  v_and_b32 v27, 0xffff0000, v182
  v_ldexp_f32 v26, v26, v25
  v_ldexp_f32 v27, v27, v25
  v_cvt_pk_bf16_f32 v182, v26, v27
  v_lshlrev_b32 v26, 16, v183
  v_and_b32 v27, 0xffff0000, v183
  v_ldexp_f32 v26, v26, v25
  v_ldexp_f32 v27, v27, v25
  v_cvt_pk_bf16_f32 v183, v26, v27
  v_lshlrev_b32 v26, 16, v184
  v_and_b32 v27, 0xffff0000, v184
  v_ldexp_f32 v26, v26, v25
  v_ldexp_f32 v27, v27, v25
  v_cvt_pk_bf16_f32 v184, v26, v27
  v_lshlrev_b32 v26, 16, v185
  v_and_b32 v27, 0xffff0000, v185
  v_ldexp_f32 v26, v26, v25
  v_ldexp_f32 v27, v27, v25
  v_cvt_pk_bf16_f32 v185, v26, v27
  v_lshlrev_b32 v26, 16, v186
  v_and_b32 v27, 0xffff0000, v186
  v_ldexp_f32 v26, v26, v25
  v_ldexp_f32 v27, v27, v25
  v_cvt_pk_bf16_f32 v186, v26, v27
  v_lshlrev_b32 v26, 16, v187
  v_and_b32 v27, 0xffff0000, v187
  v_ldexp_f32 v26, v26, v25
  v_ldexp_f32 v27, v27, v25
  v_cvt_pk_bf16_f32 v187, v26, v27
  v_lshlrev_b32 v26, 16, v188
  v_and_b32 v27, 0xffff0000, v188
  v_ldexp_f32 v26, v26, v25
  v_ldexp_f32 v27, v27, v25
  v_cvt_pk_bf16_f32 v188, v26, v27
  v_lshlrev_b32 v26, 16, v189
  v_and_b32 v27, 0xffff0000, v189
  v_ldexp_f32 v26, v26, v25
  v_ldexp_f32 v27, v27, v25
  v_cvt_pk_bf16_f32 v189, v26, v27
  v_lshlrev_b32 v26, 16, v190
  v_and_b32 v27, 0xffff0000, v190
  v_ldexp_f32 v26, v26, v25
  v_ldexp_f32 v27, v27, v25
  v_cvt_pk_bf16_f32 v190, v26, v27
  v_lshlrev_b32 v26, 16, v191
  v_and_b32 v27, 0xffff0000, v191
  v_ldexp_f32 v26, v26, v25
  v_ldexp_f32 v27, v27, v25
  v_cvt_pk_bf16_f32 v191, v26, v27
  v_lshlrev_b32 v26, 16, v192
  v_and_b32 v27, 0xffff0000, v192
  v_ldexp_f32 v26, v26, v25
  v_ldexp_f32 v27, v27, v25
  v_cvt_pk_bf16_f32 v192, v26, v27
  v_lshlrev_b32 v26, 16, v193
  v_and_b32 v27, 0xffff0000, v193
  v_ldexp_f32 v26, v26, v25
  v_ldexp_f32 v27, v27, v25
  v_cvt_pk_bf16_f32 v193, v26, v27
  v_lshlrev_b32 v26, 16, v194
  v_and_b32 v27, 0xffff0000, v194
  v_ldexp_f32 v26, v26, v25
  v_ldexp_f32 v27, v27, v25
  v_cvt_pk_bf16_f32 v194, v26, v27
  v_lshlrev_b32 v26, 16, v195
  v_and_b32 v27, 0xffff0000, v195
  v_ldexp_f32 v26, v26, v25
  v_ldexp_f32 v27, v27, v25
  v_cvt_pk_bf16_f32 v195, v26, v27
  v_lshlrev_b32 v26, 16, v196
  v_and_b32 v27, 0xffff0000, v196
  v_ldexp_f32 v26, v26, v25
  v_ldexp_f32 v27, v27, v25
  v_cvt_pk_bf16_f32 v196, v26, v27
  v_lshlrev_b32 v26, 16, v197
  v_and_b32 v27, 0xffff0000, v197
  v_ldexp_f32 v26, v26, v25
  v_ldexp_f32 v27, v27, v25
  v_cvt_pk_bf16_f32 v197, v26, v27
  v_lshlrev_b32 v26, 16, v198
  v_and_b32 v27, 0xffff0000, v198
  v_ldexp_f32 v26, v26, v25
  v_ldexp_f32 v27, v27, v25
  v_cvt_pk_bf16_f32 v198, v26, v27
  v_lshlrev_b32 v26, 16, v199
  v_and_b32 v27, 0xffff0000, v199
  v_ldexp_f32 v26, v26, v25
  v_ldexp_f32 v27, v27, v25
  v_cvt_pk_bf16_f32 v199, v26, v27
  v_lshlrev_b32 v26, 16, v200
  v_and_b32 v27, 0xffff0000, v200
  v_ldexp_f32 v26, v26, v25
  v_ldexp_f32 v27, v27, v25
  v_cvt_pk_bf16_f32 v200, v26, v27
  v_lshlrev_b32 v26, 16, v201
  v_and_b32 v27, 0xffff0000, v201
  v_ldexp_f32 v26, v26, v25
  v_ldexp_f32 v27, v27, v25
  v_cvt_pk_bf16_f32 v201, v26, v27
  v_lshlrev_b32 v26, 16, v202
  v_and_b32 v27, 0xffff0000, v202
  v_ldexp_f32 v26, v26, v25
  v_ldexp_f32 v27, v27, v25
  v_cvt_pk_bf16_f32 v202, v26, v27
  v_lshlrev_b32 v26, 16, v203
  v_and_b32 v27, 0xffff0000, v203
  v_ldexp_f32 v26, v26, v25
  v_ldexp_f32 v27, v27, v25
  v_cvt_pk_bf16_f32 v203, v26, v27
  v_lshlrev_b32 v26, 16, v204
  v_and_b32 v27, 0xffff0000, v204
  v_ldexp_f32 v26, v26, v25
  v_ldexp_f32 v27, v27, v25
  v_cvt_pk_bf16_f32 v204, v26, v27
  v_lshlrev_b32 v26, 16, v205
  v_and_b32 v27, 0xffff0000, v205
  v_ldexp_f32 v26, v26, v25
  v_ldexp_f32 v27, v27, v25
  v_cvt_pk_bf16_f32 v205, v26, v27
  v_lshlrev_b32 v26, 16, v206
  v_and_b32 v27, 0xffff0000, v206
  v_ldexp_f32 v26, v26, v25
  v_ldexp_f32 v27, v27, v25
  v_cvt_pk_bf16_f32 v206, v26, v27
  v_lshlrev_b32 v26, 16, v207
  v_and_b32 v27, 0xffff0000, v207
  v_ldexp_f32 v26, v26, v25
  v_ldexp_f32 v27, v27, v25
  v_cvt_pk_bf16_f32 v207, v26, v27
  v_lshlrev_b32 v26, 16, v208
  v_and_b32 v27, 0xffff0000, v208
  v_ldexp_f32 v26, v26, v25
  v_ldexp_f32 v27, v27, v25
  v_cvt_pk_bf16_f32 v208, v26, v27
  v_lshlrev_b32 v26, 16, v209
  v_and_b32 v27, 0xffff0000, v209
  v_ldexp_f32 v26, v26, v25
  v_ldexp_f32 v27, v27, v25
  v_cvt_pk_bf16_f32 v209, v26, v27
  v_lshlrev_b32 v26, 16, v210
  v_and_b32 v27, 0xffff0000, v210
  v_ldexp_f32 v26, v26, v25
  v_ldexp_f32 v27, v27, v25
  v_cvt_pk_bf16_f32 v210, v26, v27
  v_lshlrev_b32 v26, 16, v211
  v_and_b32 v27, 0xffff0000, v211
  v_ldexp_f32 v26, v26, v25
  v_ldexp_f32 v27, v27, v25
  v_cvt_pk_bf16_f32 v211, v26, v27
  v_lshlrev_b32 v26, 16, v212
  v_and_b32 v27, 0xffff0000, v212
  v_ldexp_f32 v26, v26, v25
  v_ldexp_f32 v27, v27, v25
  v_cvt_pk_bf16_f32 v212, v26, v27
  v_lshlrev_b32 v26, 16, v213
  v_and_b32 v27, 0xffff0000, v213
  v_ldexp_f32 v26, v26, v25
  v_ldexp_f32 v27, v27, v25
  v_cvt_pk_bf16_f32 v213, v26, v27
  v_lshlrev_b32 v26, 16, v214
  v_and_b32 v27, 0xffff0000, v214
  v_ldexp_f32 v26, v26, v25
  v_ldexp_f32 v27, v27, v25
  v_cvt_pk_bf16_f32 v214, v26, v27
  v_lshlrev_b32 v26, 16, v215
  v_and_b32 v27, 0xffff0000, v215
  v_ldexp_f32 v26, v26, v25
  v_ldexp_f32 v27, v27, v25
  v_cvt_pk_bf16_f32 v215, v26, v27
  v_lshlrev_b32 v26, 16, v216
  v_and_b32 v27, 0xffff0000, v216
  v_ldexp_f32 v26, v26, v25
  v_ldexp_f32 v27, v27, v25
  v_cvt_pk_bf16_f32 v216, v26, v27
  v_lshlrev_b32 v26, 16, v217
  v_and_b32 v27, 0xffff0000, v217
  v_ldexp_f32 v26, v26, v25
  v_ldexp_f32 v27, v27, v25
  v_cvt_pk_bf16_f32 v217, v26, v27
  v_lshlrev_b32 v26, 16, v218
  v_and_b32 v27, 0xffff0000, v218
  v_ldexp_f32 v26, v26, v25
  v_ldexp_f32 v27, v27, v25
  v_cvt_pk_bf16_f32 v218, v26, v27
  v_lshlrev_b32 v26, 16, v219
  v_and_b32 v27, 0xffff0000, v219
  v_ldexp_f32 v26, v26, v25
  v_ldexp_f32 v27, v27, v25
  v_cvt_pk_bf16_f32 v219, v26, v27
  v_lshlrev_b32 v26, 16, v220
  v_and_b32 v27, 0xffff0000, v220
  v_ldexp_f32 v26, v26, v25
  v_ldexp_f32 v27, v27, v25
  v_cvt_pk_bf16_f32 v220, v26, v27
  v_lshlrev_b32 v26, 16, v221
  v_and_b32 v27, 0xffff0000, v221
  v_ldexp_f32 v26, v26, v25
  v_ldexp_f32 v27, v27, v25
  v_cvt_pk_bf16_f32 v221, v26, v27
  v_lshlrev_b32 v26, 16, v222
  v_and_b32 v27, 0xffff0000, v222
  v_ldexp_f32 v26, v26, v25
  v_ldexp_f32 v27, v27, v25
  v_cvt_pk_bf16_f32 v222, v26, v27
  v_lshlrev_b32 v26, 16, v223
  v_and_b32 v27, 0xffff0000, v223
  v_ldexp_f32 v26, v26, v25
  v_ldexp_f32 v27, v27, v25
  v_cvt_pk_bf16_f32 v223, v26, v27
  v_lshlrev_b32 v26, 16, v224
  v_and_b32 v27, 0xffff0000, v224
  v_ldexp_f32 v26, v26, v25
  v_ldexp_f32 v27, v27, v25
  v_cvt_pk_bf16_f32 v224, v26, v27
  v_lshlrev_b32 v26, 16, v225
  v_and_b32 v27, 0xffff0000, v225
  v_ldexp_f32 v26, v26, v25
  v_ldexp_f32 v27, v27, v25
  v_cvt_pk_bf16_f32 v225, v26, v27
  v_lshlrev_b32 v26, 16, v226
  v_and_b32 v27, 0xffff0000, v226
  v_ldexp_f32 v26, v26, v25
  v_ldexp_f32 v27, v27, v25
  v_cvt_pk_bf16_f32 v226, v26, v27
  v_lshlrev_b32 v26, 16, v227
  v_and_b32 v27, 0xffff0000, v227
  v_ldexp_f32 v26, v26, v25
  v_ldexp_f32 v27, v27, v25
  v_cvt_pk_bf16_f32 v227, v26, v27
  v_lshlrev_b32 v26, 16, v228
  v_and_b32 v27, 0xffff0000, v228
  v_ldexp_f32 v26, v26, v25
  v_ldexp_f32 v27, v27, v25
  v_cvt_pk_bf16_f32 v228, v26, v27
  v_lshlrev_b32 v26, 16, v229
  v_and_b32 v27, 0xffff0000, v229
  v_ldexp_f32 v26, v26, v25
  v_ldexp_f32 v27, v27, v25
  v_cvt_pk_bf16_f32 v229, v26, v27
  v_lshlrev_b32 v26, 16, v230
  v_and_b32 v27, 0xffff0000, v230
  v_ldexp_f32 v26, v26, v25
  v_ldexp_f32 v27, v27, v25
  v_cvt_pk_bf16_f32 v230, v26, v27
  v_lshlrev_b32 v26, 16, v231
  v_and_b32 v27, 0xffff0000, v231
  v_ldexp_f32 v26, v26, v25
  v_ldexp_f32 v27, v27, v25
  v_cvt_pk_bf16_f32 v231, v26, v27
  v_lshlrev_b32 v26, 16, v232
  v_and_b32 v27, 0xffff0000, v232
  v_ldexp_f32 v26, v26, v25
  v_ldexp_f32 v27, v27, v25
  v_cvt_pk_bf16_f32 v232, v26, v27
  v_lshlrev_b32 v26, 16, v233
  v_and_b32 v27, 0xffff0000, v233
  v_ldexp_f32 v26, v26, v25
  v_ldexp_f32 v27, v27, v25
  v_cvt_pk_bf16_f32 v233, v26, v27
  v_lshlrev_b32 v26, 16, v234
  v_and_b32 v27, 0xffff0000, v234
  v_ldexp_f32 v26, v26, v25
  v_ldexp_f32 v27, v27, v25
  v_cvt_pk_bf16_f32 v234, v26, v27
  v_lshlrev_b32 v26, 16, v235
  v_and_b32 v27, 0xffff0000, v235
  v_ldexp_f32 v26, v26, v25
  v_ldexp_f32 v27, v27, v25
  v_cvt_pk_bf16_f32 v235, v26, v27
  v_lshlrev_b32 v26, 16, v236
  v_and_b32 v27, 0xffff0000, v236
  v_ldexp_f32 v26, v26, v25
  v_ldexp_f32 v27, v27, v25
  v_cvt_pk_bf16_f32 v236, v26, v27
  v_lshlrev_b32 v26, 16, v237
  v_and_b32 v27, 0xffff0000, v237
  v_ldexp_f32 v26, v26, v25
  v_ldexp_f32 v27, v27, v25
  v_cvt_pk_bf16_f32 v237, v26, v27
  v_lshlrev_b32 v26, 16, v238
  v_and_b32 v27, 0xffff0000, v238
  v_ldexp_f32 v26, v26, v25
  v_ldexp_f32 v27, v27, v25
  v_cvt_pk_bf16_f32 v238, v26, v27
  v_lshlrev_b32 v26, 16, v239
  v_and_b32 v27, 0xffff0000, v239
  v_ldexp_f32 v26, v26, v25
  v_ldexp_f32 v27, v27, v25
  v_cvt_pk_bf16_f32 v239, v26, v27
  v_lshlrev_b32 v26, 16, v240
  v_and_b32 v27, 0xffff0000, v240
  v_ldexp_f32 v26, v26, v25
  v_ldexp_f32 v27, v27, v25
  v_cvt_pk_bf16_f32 v240, v26, v27
  v_lshlrev_b32 v26, 16, v241
  v_and_b32 v27, 0xffff0000, v241
  v_ldexp_f32 v26, v26, v25
  v_ldexp_f32 v27, v27, v25
  v_cvt_pk_bf16_f32 v241, v26, v27
  v_lshlrev_b32 v26, 16, v242
  v_and_b32 v27, 0xffff0000, v242
  v_ldexp_f32 v26, v26, v25
  v_ldexp_f32 v27, v27, v25
  v_cvt_pk_bf16_f32 v242, v26, v27
  v_lshlrev_b32 v26, 16, v243
  v_and_b32 v27, 0xffff0000, v243
  v_ldexp_f32 v26, v26, v25
  v_ldexp_f32 v27, v27, v25
  v_cvt_pk_bf16_f32 v243, v26, v27
  v_lshlrev_b32 v26, 16, v244
  v_and_b32 v27, 0xffff0000, v244
  v_ldexp_f32 v26, v26, v25
  v_ldexp_f32 v27, v27, v25
  v_cvt_pk_bf16_f32 v244, v26, v27
  v_lshlrev_b32 v26, 16, v245
  v_and_b32 v27, 0xffff0000, v245
  v_ldexp_f32 v26, v26, v25
  v_ldexp_f32 v27, v27, v25
  v_cvt_pk_bf16_f32 v245, v26, v27
  v_lshlrev_b32 v26, 16, v246
  v_and_b32 v27, 0xffff0000, v246
  v_ldexp_f32 v26, v26, v25
  v_ldexp_f32 v27, v27, v25
  v_cvt_pk_bf16_f32 v246, v26, v27
  v_lshlrev_b32 v26, 16, v247
  v_and_b32 v27, 0xffff0000, v247
  v_ldexp_f32 v26, v26, v25
  v_ldexp_f32 v27, v27, v25
  v_cvt_pk_bf16_f32 v247, v26, v27
  v_lshlrev_b32 v26, 16, v248
  v_and_b32 v27, 0xffff0000, v248
  v_ldexp_f32 v26, v26, v25
  v_ldexp_f32 v27, v27, v25
  v_cvt_pk_bf16_f32 v248, v26, v27
  v_lshlrev_b32 v26, 16, v249
  v_and_b32 v27, 0xffff0000, v249
  v_ldexp_f32 v26, v26, v25
  v_ldexp_f32 v27, v27, v25
  v_cvt_pk_bf16_f32 v249, v26, v27
  v_lshlrev_b32 v26, 16, v250
  v_and_b32 v27, 0xffff0000, v250
  v_ldexp_f32 v26, v26, v25
  v_ldexp_f32 v27, v27, v25
  v_cvt_pk_bf16_f32 v250, v26, v27
  v_lshlrev_b32 v26, 16, v251
  v_and_b32 v27, 0xffff0000, v251
  v_ldexp_f32 v26, v26, v25
  v_ldexp_f32 v27, v27, v25
  v_cvt_pk_bf16_f32 v251, v26, v27
  v_lshlrev_b32 v26, 16, v252
  v_and_b32 v27, 0xffff0000, v252
  v_ldexp_f32 v26, v26, v25
  v_ldexp_f32 v27, v27, v25
  v_cvt_pk_bf16_f32 v252, v26, v27
  v_lshlrev_b32 v26, 16, v253
  v_and_b32 v27, 0xffff0000, v253
  v_ldexp_f32 v26, v26, v25
  v_ldexp_f32 v27, v27, v25
  v_cvt_pk_bf16_f32 v253, v26, v27
  v_lshlrev_b32 v26, 16, v254
  v_and_b32 v27, 0xffff0000, v254
  v_ldexp_f32 v26, v26, v25
  v_ldexp_f32 v27, v27, v25
  v_cvt_pk_bf16_f32 v254, v26, v27
  v_lshlrev_b32 v26, 16, v255
  v_and_b32 v27, 0xffff0000, v255
  v_ldexp_f32 v26, v26, v25
  v_ldexp_f32 v27, v27, v25
  v_cvt_pk_bf16_f32 v255, v26, v27
  s_nop 1
  s_setpc_b64 s[64:65]
.section .rodata,"a"
.p2align 6
.amdhsa_kernel standalone__gqa_block_cached__near_ridge_kernel
  .amdhsa_next_free_vgpr 512
  .amdhsa_next_free_sgpr 102
  .amdhsa_accum_offset 256
  .amdhsa_group_segment_fixed_size 0
  .amdhsa_kernarg_size 64
  .amdhsa_user_sgpr_count 2
  .amdhsa_user_sgpr_kernarg_segment_ptr 1
  .amdhsa_system_sgpr_workgroup_id_x 1
.end_amdhsa_kernel
```
